```python
import torch

def _softmax(x, axis=-1):
    return torch.softmax(x, dim=axis)
def _gelu(x):
    return torch.nn.functional.gelu(x, approximate="tanh")
def _silu(x):
    return torch.nn.functional.silu(x)
def _sigmoid(x):
    return torch.sigmoid(x)
def _layernorm(x, axis=-1, eps=1e-5):
    m = x.mean(dim=axis, keepdim=True)
    v = x.var(dim=axis, keepdim=True, unbiased=False)
    return (x - m) / torch.sqrt(v + eps)
def _scatter_add(tgt, idx, src, axis=0):
    return tgt.clone().index_add_(axis, idx, src)
def _segment_sum(src, seg, n):
    out = torch.zeros((n,) + src.shape[1:], dtype=src.dtype)
    return out.index_add_(0, seg, src)
def _pad(x, pw):
    flat = tuple(v for pair in reversed(pw) for v in pair)
    return torch.nn.functional.pad(x, flat)

kernel_name = 'interleave_layers__ssm_conv_s4__dense_activation_relu__prompt'

def setup_inputs():

    _w = (lambda a: (lambda t: t.to(torch.bfloat16) if t.is_floating_point() else t)(torch.as_tensor(a)))
    def _A_setup():
        B, L, D, N = 1, 2048, 448, 256
        A_re = -(lambda _x: torch.exp(torch.as_tensor(_x)))((lambda *s: torch.randn(*s, dtype=torch.bfloat16) * 1.6)(D, N))
        A_im = torch.pi * (lambda *s: torch.randn(*s, dtype=torch.bfloat16) * 0.2)(D, N)
        B_re = (lambda *s: torch.randn(*s, dtype=torch.bfloat16) * 0.2)(D, N)
        B_im = (lambda *s: torch.randn(*s, dtype=torch.bfloat16) * 0.2)(D, N)
        C_re = (lambda *s: torch.randn(*s, dtype=torch.bfloat16) * 0.2)(D, N)
        C_im = (lambda *s: torch.randn(*s, dtype=torch.bfloat16) * 0.2)(D, N)
        log_dt = (lambda *s: torch.randn(*s, dtype=torch.bfloat16) * 0.2)(D) * 0.5 - 4.0
        Dskip = (lambda *s: torch.randn(*s, dtype=torch.bfloat16) * 0.2)(D)
        return {
            "u": _w((lambda *s: torch.randn(*s, dtype=torch.bfloat16) * 0.05)(B, L, D)),
            "A_re": _w(A_re),
            "A_im": _w(A_im),
            "B_re": _w(B_re),
            "B_im": _w(B_im),
            "C_re": _w(C_re),
            "C_im": _w(C_im),
            "log_dt": _w(log_dt),
            "Dskip": _w(Dskip),
        }
    _A_in = _A_setup()

    def _B_setup():
        B, S, D, Dff = 1, 2048, 448, 1792
        return {
            "x": _w((lambda *s: torch.randn(*s, dtype=torch.bfloat16) * 0.05)(B, S, D)),
            "w1": _w((lambda *s: torch.randn(*s, dtype=torch.bfloat16) * 0.05)(D, Dff)),
            "w2": _w((lambda *s: torch.randn(*s, dtype=torch.bfloat16) * 0.05)(Dff, D)),
        }
    _B_in = _B_setup()

    return {
        "A_u": _A_in["u"],
        "A_A_re": _A_in["A_re"],
        "A_A_im": _A_in["A_im"],
        "A_B_re": _A_in["B_re"],
        "A_B_im": _A_in["B_im"],
        "A_C_re": _A_in["C_re"],
        "A_C_im": _A_in["C_im"],
        "A_log_dt": _A_in["log_dt"],
        "A_Dskip": _A_in["Dskip"],
        "B_x": _B_in["x"],
        "B_w1": _B_in["w1"],
        "B_w2": _B_in["w2"],
    }

def reference(A_u, A_A_re, A_A_im, A_B_re, A_B_im, A_C_re, A_C_im, A_log_dt, A_Dskip, B_x, B_w1, B_w2):
    def _A_ref(u, A_re, A_im, B_re, B_im, C_re, C_im, log_dt, Dskip):
        Bsz, L, D = u.shape
        dt = torch.exp(log_dt)[:, None]
        A = A_re + 1j * A_im
        Bc = B_re + 1j * B_im
        Cc = C_re + 1j * C_im
        logdA = dt * A
        dB = dt * Bc
        l = (lambda x, dt: x.to(dt))(torch.arange(L), A_re.dtype)
        P = torch.exp(logdA[:, :, None] * l[None, None, :])
        K = torch.einsum("dn,dnl,dn->dl", Cc, P, dB).real
        L2 = 2 * L
        Kp = _pad(K, ((0, 0), (0, L)))
        up = (lambda x, *d: x.permute(*d))(u, 0, 2, 1)
        up = _pad(up, ((0, 0), (0, 0), (0, L)))
        Kf = (lambda x, axes=(-2,-1): torch.fft.rfft2(x.float(), dim=axes))(Kp[:, None, :], axes=(-2, -1))
        Uf = (lambda x, axes=(-2,-1): torch.fft.rfft2(x.float(), dim=axes))(up[:, :, None, :], axes=(-2, -1))
        Yf = Uf * Kf[None, :, :, :]
        y = (lambda x, s, axes=(-2,-1): torch.fft.irfft2(x, s=s, dim=axes).to(torch.bfloat16))(Yf, (1, L2), axes=(-2, -1))[:, :, 0, :L]
        y = (lambda x, *d: x.permute(*d))(y, 0, 2, 1) + u * Dskip[None, None, :]
        return y

    def _B_ref(x, w1, w2):
        h = torch.einsum("bsd,df->bsf", x, w1)
        zero = torch.zeros_like(h)
        h = torch.maximum(h, zero)
        return torch.einsum("bsf,fd->bsd", h, w2)

    x = A_u
    x = x + _A_ref(_layernorm(x, axis=-1), A_A_re, A_A_im, A_B_re, A_B_im, A_C_re, A_C_im, A_log_dt, A_Dskip)
    x = x + _B_ref(_layernorm(x, axis=-1), B_w1, B_w2)
    x = x + _A_ref(_layernorm(x, axis=-1), A_A_re, A_A_im, A_B_re, A_B_im, A_C_re, A_C_im, A_log_dt, A_Dskip)
    x = x + _B_ref(_layernorm(x, axis=-1), B_w1, B_w2)
    return x
```

```asm
; @launch grid=(256,1,1) block=(256,1,1) lds=163840
.amdgcn_target "amdgcn-amd-amdhsa--gfx950"
.text
.globl interleave_layers__ssm_conv_s4__dense_activation_relu__prompt_kernel
.p2align 8
.type interleave_layers__ssm_conv_s4__dense_activation_relu__prompt_kernel,@function
interleave_layers__ssm_conv_s4__dense_activation_relu__prompt_kernel:
    s_load_dwordx2 s[52:53], s[0:1], 80
    s_load_dwordx2 s[88:89], s[0:1], 0
    s_getpc_b64 s[48:49]
L_pcbase:
    s_lshr_b32 s36, s2, 3
    v_lshlrev_b32 v29, 4, v0
    v_lshl_add_u32 v28, s36, 8, v0
    v_lshlrev_b32 v28, 3, v28
    v_min_u32 v28, L_end-L_pcbase, v28
    global_load_dword v136, v28, s[48:49]
    s_cmp_lt_u32 s2, 32
    s_cbranch_scc1 L_helper
    s_cmp_ge_u32 s2, 256
    s_cbranch_scc1 L_end
    s_load_dwordx2 s[56:57], s[0:1], 88
    s_load_dwordx16 s[4:19], s[0:1], 0
    s_load_dwordx2 s[60:61], s[0:1], 112
    s_load_dwordx2 s[20:21], s[0:1], 64
    v_lshrrev_b32 v14, 6, v0
    v_lshrrev_b32 v40, 3, v0
    v_readfirstlane_b32 s34, v14
    v_lshl_add_u32 v40, v14, 3, v40
    v_and_b32 v42, 0x70, v29
    s_sub_u32 s36, s36, 4
    s_and_b32 s35, s2, 7
    s_sub_u32 s51, 7, s35
    s_mul_i32 s48, s51, 1792
    s_add_u32 s48, s48, s36
    v_mad_u32_u24 v146, v40, 28, s48
    v_lshl_add_u32 v146, v146, 7, v42
    s_mul_i32 s3, s34, 6208
    s_add_u32 m0, s3, 126720
    s_mov_b32 s54, 1605632
    s_mov_b32 s55, 0x20000
    s_movk_i32 s80, 27632
    s_waitcnt lgkmcnt(0)
    s_mul_i32 s37, s35, 28
    s_add_u32 s37, s37, s36
    s_lshl_b32 s48, s37, 10
    v_lshl_add_u32 v19, v0, 2, s48
    global_load_dword v30, v19, s[6:7] nt
    global_load_dword v31, v19, s[8:9] nt
    global_load_dword v32, v19, s[10:11] nt
    global_load_dword v33, v19, s[12:13] nt
    global_load_dword v34, v19, s[14:15] nt
    global_load_dword v35, v19, s[16:17] nt
    s_lshl_b32 s74, s37, 2
    s_load_dword s75, s[18:19], s74
    buffer_load_dwordx4 v146, s[52:55], 0 offen nt lds
    buffer_load_dwordx4 v146, s[52:55], s80 offen offset:1040 nt lds
    s_mul_i32 s48, s36, 37
    s_lshr_b32 s48, s48, 8
    s_mul_i32 s49, s48, 7
    s_sub_u32 s43, s36, s49
    s_lshl2_add_u32 s78, s35, s48
    s_mul_i32 s48, s78, 448
    s_add_u32 s48, s48, s43
    v_mad_u32_u24 v41, v40, 7, s48
    v_lshl_add_u32 v41, v41, 7, v42
    s_add_u32 m0, s3, 128784
    s_mov_b32 s58, s54
    s_mov_b32 s59, 0x20000
    s_movk_i32 s80, 6128
    buffer_load_dwordx4 v41, s[56:59], 0 offen nt lds
    buffer_load_dwordx4 v41, s[56:59], s80 offen offset:1040 nt lds
    s_add_u32 m0, s3, 130848
    s_mov_b32 s90, 1835008
    s_mov_b32 s91, 0x20000
    buffer_load_dwordx4 v41, s[88:91], 0 offen nt lds
    buffer_load_dwordx4 v41, s[88:91], s80 offen offset:1040 nt lds
    s_mov_b32 s62, 134217728
    s_mov_b32 s63, 0x20000
    buffer_load_dword v174, off, s[60:63], 0 sc1
    s_load_dword s76, s[20:21], s74
    s_load_dwordx2 s[28:29], s[0:1], 96
    s_mov_b32 s47, 0
    s_mul_i32 s68, s34, 7168
    s_mov_b32 s70, 0x3b124925
    s_mov_b32 s71, 0x3b124925
    s_mov_b32 s72, 0x3727c5ac
    s_mov_b32 s69, 0xffff0000
    s_mov_b32 s73, 0x3f803f80
    v_and_b32 v1, 63, v0
    v_lshlrev_b32 v3, 4, v1
    v_lshrrev_b32 v44, 4, v1
    v_lshrrev_b32 v16, 5, v1
    v_and_b32 v17, 31, v1
    v_lshlrev_b32 v2, 8, v16
    v_bfe_u32 v40, v1, 2, 2
    v_lshl_or_b32 v2, v40, 6, v2
    v_bfe_u32 v42, v1, 4, 1
    v_lshl_or_b32 v2, v42, 5, v2
    v_and_b32 v43, 3, v1
    v_lshl_or_b32 v2, v43, 3, v2
    s_lshl2_add_u32 s39, s43, s34
    s_mul_i32 s48, s43, 237568
    s_add_u32 s48, s48, 12582912
    s_lshl2_add_u32 s49, s78, s34
    s_lshl_b32 s99, s49, 11
    s_add_u32 s99, s99, s48
    s_mul_i32 s50, s49, 147
    s_lshr_b32 s50, s50, 11
    s_mul_i32 s48, s50, 1024
    s_add_u32 s99, s99, s48
    s_cmp_ge_u32 s49, 112
    s_cselect_b32 s99, s62, s99
    s_lshl_b32 s50, s50, 5
    s_and_b32 s50, s50, 0x60
    s_lshl2_add_u32 s49, s51, s34
    s_lshl_b32 s49, s49, 10
    s_mul_i32 s8, s36, 59392
    s_add_u32 s8, s8, s49
    s_add_u32 s8, s8, 10485760
    s_cmp_eq_u32 s35, 0
    s_cselect_b32 s8, s62, s8
    s_add_u32 s3, s3, 126720
    v_and_b32 v145, 0x1c0, v2
    v_add_u32 v145, v145, v2
    v_xor_b32 v146, s50, v145
    v_xor_b32 v147, 64, v146
    v_add_u32 v145, s3, v145
    v_add_u32 v146, s3, v146
    v_add_u32 v147, s3, v147
    v_mov_b32 v36, 0
    v_mov_b32 v37, 0
    v_mov_b32 v38, 0
    v_mov_b32 v39, 0
    s_lshr_b32 s40, s78, 1
    s_and_b32 s42, s78, 1
    s_mul_i32 s41, s42, 7
    s_add_u32 s41, s41, s43
    s_lshl_b32 s48, s41, 2
    s_add_u32 s48, s48, s34
    s_lshl_b32 s48, s48, 11
    s_mul_i32 s64, s78, 122880
    s_xor_b32 s65, s78, 1
    s_mul_i32 s65, s65, 122880
    s_mul_i32 s49, s34, 15360
    s_add_u32 s49, s49, s64
    s_mul_i32 s50, s42, 61440
    s_add_u32 s66, s49, s50
    s_sub_u32 s67, s49, s50
    s_add_u32 s67, s67, 61440
    s_mul_i32 s49, s48, 37
    s_lshr_b32 s49, s49, 19
    s_mul_i32 s49, s49, 1024
    s_add_u32 s49, s49, s48
    s_add_u32 s64, s64, s49
    s_add_u32 s65, s65, s49
    s_lshl_b32 s48, s40, 10
    s_add_u32 s48, s48, 131072
    s_lshl_b32 s49, s42, 7
    s_add_u32 s48, s48, s49
    s_lshl_b32 s49, s39, 2
    s_add_u32 s4, s48, s49
    s_mul_i32 s49, s34, 28
    s_add_u32 s5, s48, s49
    s_xor_b32 s6, s5, 128
    s_lshl_b32 s9, s78, 10
    s_add_u32 s9, s9, 98304
    s_cmp_eq_u32 s39, 0
    s_cselect_b32 s9, s9, s62
    s_lshl_b32 s48, s41, 2
    s_add_u32 s48, s48, s34
    s_mul_i32 s22, s48, 29696
    s_add_u32 s22, s22, 10485760
    s_mul_i32 s48, s43, 237568
    s_add_u32 s48, s48, 12582912
    s_mul_i32 s49, s34, 29696
    s_add_u32 s49, s49, s48
    s_mul_i32 s50, s42, 118784
    s_add_u32 s23, s49, s50
    s_sub_u32 s30, s49, s50
    s_add_u32 s30, s30, 118784
    s_lshr_b32 s48, s34, 1
    s_and_b32 s49, s34, 1
    s_lshl_b32 s49, s49, 8
    s_mul_i32 s50, s48, 8320
    s_add_u32 s50, s50, 145552
    s_sub_u32 s50, s50, s49
    v_lshlrev_b32 v45, 4, v44
    v_and_b32 v47, 15, v1
    v_and_b32 v46, 1, v1
    v_mul_u32_u24 v46, 4162, v46
    v_lshl_add_u32 v46, v47, 1, v46
    v_add_u32 v46, v45, v46
    v_sub_u32 v4, s50, v46
    v_subrev_u32 v5, 1024, v4
    v_subrev_u32 v6, 2048, v4
    v_subrev_u32 v7, 3072, v4
    s_mul_i32 s50, s48, 4608
    s_add_u32 s50, s50, 154960
    s_sub_u32 s50, s50, s49
    v_lshl_add_u32 v8, v47, 5, s50
    v_sub_u32 v8, v8, v45
    s_mul_i32 s50, s34, 4352
    s_add_u32 s50, s50, 114688
    v_mul_u32_u24 v9, 1088, v44
    v_lshl_add_u32 v9, v47, 4, v9
    v_add_u32 v9, s50, v9
    v_mul_u32_u24 v10, 1088, v43
    v_lshrrev_b32 v46, 2, v0
    v_lshl_add_u32 v10, v46, 4, v10
    v_add_u32 v10, 114688, v10
    s_lshl_b32 s50, s37, 7
    v_lshrrev_b32 v46, 3, v0
    v_mul_u32_u24 v11, 28928, v46
    v_and_b32 v46, 7, v0
    v_lshl_add_u32 v11, v46, 3, v11
    v_add_u32 v11, s50, v11
    v_lshlrev_b32 v12, 3, v0
    v_add_u32 v12, 155136, v12
    v_mov_b32 v0, v29
    v_mul_u32_u24 v46, 4608, v16
    v_lshl_add_u32 v46, v17, 4, v46
    v_add_u32 v46, 154624, v46
    s_lshl_b32 s48, s34, 5
    s_add_u32 s48, s48, 130848
    v_and_b32 v47, 1, v43
    v_mul_u32_u24 v47, 1040, v47
    v_lshrrev_b32 v50, 1, v43
    v_mul_u32_u24 v50, 6208, v50
    v_add_u32 v47, v47, v50
    v_lshl_add_u32 v47, v40, 7, v47
    v_lshl_add_u32 v47, v44, 3, v47
    v_add_u32 v172, s48, v47
    v_lshl_add_u32 v50, v44, 2, v43
    v_lshlrev_b32 v50, 6, v50
    v_lshl_add_u32 v173, v40, 4, v50
    s_mul_i32 s48, s78, 57856
    s_lshl_b32 s49, s39, 10
    s_add_u32 s48, s48, s49
    s_add_u32 s82, s48, 1048576
    s_add_u32 s83, s82, 28928
    s_waitcnt lgkmcnt(0)
    s_lshl_b32 s44, s76, 16
    s_and_b32 s45, s76, 0xffff0000
    ds_write_b128 v46, v[36:39]
    s_waitcnt vmcnt(7)
    s_lshl_b32 s48, s75, 16
    s_and_b32 s49, s75, 0xffff0000
    s_cmp_ge_u32 s34, 2
    s_cselect_b32 s48, s49, s48
    v_mov_b32 v40, s48
    v_mov_b32 v41, 0x3fb8aa3b
    v_mul_f32 v42, v40, v41
    v_fma_f32 v43, v40, v41, -v42
    v_fmamk_f32 v43, v40, 0x32a57060, v43
    v_exp_f32 v42, v42
    v_mul_f32 v43, 0x3f317218, v43
    v_fma_f32 v42, v42, v43, v42
    v_cvt_pk_bf16_f32 v42, v42, v42
    v_lshlrev_b32 v42, 16, v42
    v_mov_b32 v43, v42
    v_lshlrev_b32 v44, 16, v30
    v_and_b32 v45, s69, v30
    v_lshlrev_b32 v46, 16, v31
    v_and_b32 v47, s69, v31
    v_lshlrev_b32 v48, 16, v32
    v_and_b32 v49, s69, v32
    v_lshlrev_b32 v50, 16, v33
    v_and_b32 v51, s69, v33
    v_lshlrev_b32 v52, 16, v34
    v_and_b32 v53, s69, v34
    v_lshlrev_b32 v54, 16, v35
    v_and_b32 v55, s69, v35
    v_pk_mul_f32 v[44:45], v[44:45], v[42:43]
    v_pk_mul_f32 v[46:47], v[46:47], v[42:43]
    v_mul_f32 v44, v41, v44
    v_mul_f32 v45, v41, v45
    v_mul_f32 v46, 0.15915494, v46
    v_mul_f32 v47, 0.15915494, v47
    s_mul_i32 s48, s34, 31680
    v_lshl_add_u32 v18, v1, 3, s48
    v_lshl_add_u32 v31, v16, 4, s48
    v_mul_u32_u24 v28, 528, v17
    v_add_u32 v28, v28, v31
    v_lshrrev_b32 v32, 3, v17
    v_and_b32 v33, 3, v17
    v_lshl_add_u32 v32, v32, 2, v33
    v_mul_u32_u24 v32, 528, v32
    s_and_b32 s49, s34, 1
    s_mul_i32 s50, s49, 8448
    v_add3_u32 v19, v32, v31, s50
    s_mul_i32 s50, s49, 63360
    s_sub_u32 s50, 31680, s50
    v_add_u32 v29, s50, v19
    v_add_u32 v30, s50, v28
    v_mov_b32 v20, s73
    v_mov_b32 v21, 0
    ds_write_b64 v18, v[20:21] offset:0
    v_fract_f32 v58, v46
    v_fract_f32 v59, v47
    v_exp_f32 v56, v44
    v_exp_f32 v57, v45
    v_cos_f32 v60, v58
    v_cos_f32 v61, v59
    v_sin_f32 v62, v58
    v_sin_f32 v63, v59
    v_pk_mul_f32 v[60:61], v[60:61], v[56:57]
    v_pk_mul_f32 v[62:63], v[62:63], v[56:57]
    v_cvt_pk_bf16_f32 v22, v60, v61
    v_cvt_pk_bf16_f32 v23, -v62, -v63
    ds_write_b64 v18, v[22:23] offset:528
    v_mul_f32 v56, 0x41000000, v44
    v_mul_f32 v58, 0x41000000, v46
    v_mul_f32 v57, 0x41000000, v45
    v_mul_f32 v59, 0x41000000, v47
    v_fract_f32 v58, v58
    v_fract_f32 v59, v59
    v_exp_f32 v56, v56
    v_exp_f32 v57, v57
    v_cos_f32 v76, v58
    v_cos_f32 v77, v59
    v_sin_f32 v78, v58
    v_sin_f32 v79, v59
    v_pk_mul_f32 v[76:77], v[76:77], v[56:57]
    v_pk_mul_f32 v[78:79], v[78:79], v[56:57]
    v_cvt_pk_bf16_f32 v24, v76, v77
    v_cvt_pk_bf16_f32 v25, -v78, -v79
    ds_write_b64 v18, v[24:25] offset:4224
    v_mul_f32 v56, 0x43800000, v44
    v_mul_f32 v58, 0x43800000, v46
    v_mul_f32 v57, 0x43800000, v45
    v_mul_f32 v59, 0x43800000, v47
    v_fract_f32 v58, v58
    v_fract_f32 v59, v59
    v_exp_f32 v56, v56
    v_exp_f32 v57, v57
    v_cos_f32 v80, v58
    v_cos_f32 v81, v59
    v_sin_f32 v82, v58
    v_sin_f32 v83, v59
    v_pk_mul_f32 v[80:81], v[80:81], v[56:57]
    v_pk_mul_f32 v[82:83], v[82:83], v[56:57]
    v_cvt_pk_bf16_f32 v26, v80, v81
    v_cvt_pk_bf16_f32 v27, -v82, -v83
    ds_write_b64 v18, v[26:27] offset:8448
    v_pk_mul_f32 v[56:57], v[62:63], v[62:63]
    v_pk_mul_f32 v[58:59], v[62:63], v[60:61]
    v_pk_fma_f32 v[66:67], v[60:61], v[62:63], v[58:59]
    v_pk_fma_f32 v[64:65], v[60:61], v[60:61], v[56:57] neg_lo:[0,0,1] neg_hi:[0,0,1]
    v_cvt_pk_bf16_f32 v20, v64, v65
    v_cvt_pk_bf16_f32 v21, -v66, -v67
    ds_write_b64 v18, v[20:21] offset:1056
    v_pk_mul_f32 v[56:57], v[66:67], v[62:63]
    v_pk_mul_f32 v[58:59], v[66:67], v[60:61]
    v_pk_fma_f32 v[90:91], v[64:65], v[62:63], v[58:59]
    v_pk_fma_f32 v[88:89], v[64:65], v[60:61], v[56:57] neg_lo:[0,0,1] neg_hi:[0,0,1]
    v_cvt_pk_bf16_f32 v22, v88, v89
    v_cvt_pk_bf16_f32 v23, -v90, -v91
    ds_write_b64 v18, v[22:23] offset:1584
    v_pk_mul_f32 v[56:57], v[66:67], v[66:67]
    v_pk_mul_f32 v[58:59], v[66:67], v[64:65]
    v_pk_fma_f32 v[70:71], v[64:65], v[66:67], v[58:59]
    v_pk_fma_f32 v[68:69], v[64:65], v[64:65], v[56:57] neg_lo:[0,0,1] neg_hi:[0,0,1]
    v_cvt_pk_bf16_f32 v24, v68, v69
    v_cvt_pk_bf16_f32 v25, -v70, -v71
    ds_write_b64 v18, v[24:25] offset:2112
    v_pk_mul_f32 v[56:57], v[70:71], v[62:63]
    v_pk_mul_f32 v[58:59], v[70:71], v[60:61]
    v_pk_fma_f32 v[90:91], v[68:69], v[62:63], v[58:59]
    v_pk_fma_f32 v[88:89], v[68:69], v[60:61], v[56:57] neg_lo:[0,0,1] neg_hi:[0,0,1]
    v_cvt_pk_bf16_f32 v26, v88, v89
    v_cvt_pk_bf16_f32 v27, -v90, -v91
    ds_write_b64 v18, v[26:27] offset:2640
    s_waitcnt vmcnt(0)
    s_barrier
    v_readfirstlane_b32 s38, v174
    s_add_u32 s38, s38, 16
    s_and_b32 s38, s38, 0xfffffff0
    ds_read_b64_tr_b16 v[164:165], v172 offset:0
    ds_read_b64_tr_b16 v[166:167], v172 offset:512
    ds_read_b64_tr_b16 v[168:169], v172 offset:12416
    ds_read_b64_tr_b16 v[170:171], v172 offset:12928
    v_pk_mul_f32 v[56:57], v[70:71], v[66:67]
    v_pk_mul_f32 v[58:59], v[70:71], v[64:65]
    v_pk_fma_f32 v[74:75], v[68:69], v[66:67], v[58:59]
    v_pk_fma_f32 v[72:73], v[68:69], v[64:65], v[56:57] neg_lo:[0,0,1] neg_hi:[0,0,1]
    v_cvt_pk_bf16_f32 v20, v72, v73
    v_cvt_pk_bf16_f32 v21, -v74, -v75
    ds_write_b64 v18, v[20:21] offset:3168
    v_pk_mul_f32 v[56:57], v[74:75], v[62:63]
    v_pk_mul_f32 v[58:59], v[74:75], v[60:61]
    v_pk_fma_f32 v[90:91], v[72:73], v[62:63], v[58:59]
    v_pk_fma_f32 v[88:89], v[72:73], v[60:61], v[56:57] neg_lo:[0,0,1] neg_hi:[0,0,1]
    v_cvt_pk_bf16_f32 v22, v88, v89
    v_cvt_pk_bf16_f32 v23, -v90, -v91
    ds_write_b64 v18, v[22:23] offset:3696
    v_pk_mul_f32 v[56:57], v[82:83], v[66:67]
    v_pk_mul_f32 v[58:59], v[82:83], v[64:65]
    v_pk_fma_f32 v[90:91], v[80:81], v[66:67], v[58:59]
    v_pk_fma_f32 v[88:89], v[80:81], v[64:65], v[56:57] neg_lo:[0,0,1] neg_hi:[0,0,1]
    v_cvt_pk_bf16_f32 v24, v88, v89
    v_cvt_pk_bf16_f32 v25, -v90, -v91
    s_waitcnt lgkmcnt(13)
    ds_write_b64 v18, v[24:25] offset:8976
    v_pk_mul_f32 v[56:57], v[82:83], v[70:71]
    v_pk_mul_f32 v[58:59], v[82:83], v[68:69]
    v_pk_fma_f32 v[90:91], v[80:81], v[70:71], v[58:59]
    v_pk_fma_f32 v[88:89], v[80:81], v[68:69], v[56:57] neg_lo:[0,0,1] neg_hi:[0,0,1]
    v_cvt_pk_bf16_f32 v26, v88, v89
    v_cvt_pk_bf16_f32 v27, -v90, -v91
    ds_write_b64 v18, v[26:27] offset:9504
    v_pk_mul_f32 v[56:57], v[82:83], v[74:75]
    v_pk_mul_f32 v[58:59], v[82:83], v[72:73]
    v_pk_fma_f32 v[90:91], v[80:81], v[74:75], v[58:59]
    v_pk_fma_f32 v[88:89], v[80:81], v[72:73], v[56:57] neg_lo:[0,0,1] neg_hi:[0,0,1]
    v_cvt_pk_bf16_f32 v20, v88, v89
    v_cvt_pk_bf16_f32 v21, -v90, -v91
    s_waitcnt lgkmcnt(13)
    ds_write_b64 v18, v[20:21] offset:10032
    v_pk_mul_f32 v[56:57], v[82:83], v[78:79]
    v_pk_mul_f32 v[58:59], v[82:83], v[76:77]
    v_pk_fma_f32 v[90:91], v[80:81], v[78:79], v[58:59]
    v_pk_fma_f32 v[88:89], v[80:81], v[76:77], v[56:57] neg_lo:[0,0,1] neg_hi:[0,0,1]
    v_cvt_pk_bf16_f32 v22, v88, v89
    v_cvt_pk_bf16_f32 v23, -v90, -v91
    ds_write_b64 v18, v[22:23] offset:10560
    s_waitcnt lgkmcnt(6)
    buffer_store_dwordx4 v[164:167], v173, s[60:63], s82 offen sc1
    v_pk_mul_f32 v[56:57], v[82:83], v[82:83]
    v_pk_mul_f32 v[58:59], v[82:83], v[80:81]
    v_pk_fma_f32 v[86:87], v[80:81], v[82:83], v[58:59]
    v_pk_fma_f32 v[84:85], v[80:81], v[80:81], v[56:57] neg_lo:[0,0,1] neg_hi:[0,0,1]
    v_cvt_pk_bf16_f32 v24, v84, v85
    v_cvt_pk_bf16_f32 v25, -v86, -v87
    ds_write_b64 v18, v[24:25] offset:4752
    v_pk_mul_f32 v[56:57], v[86:87], v[70:71]
    v_pk_mul_f32 v[58:59], v[86:87], v[68:69]
    v_pk_fma_f32 v[90:91], v[84:85], v[70:71], v[58:59]
    v_pk_fma_f32 v[88:89], v[84:85], v[68:69], v[56:57] neg_lo:[0,0,1] neg_hi:[0,0,1]
    v_cvt_pk_bf16_f32 v26, v88, v89
    v_cvt_pk_bf16_f32 v27, -v90, -v91
    ds_write_b64 v18, v[26:27] offset:5280
    buffer_store_dwordx4 v[168:171], v173, s[60:63], s83 offen sc1
    v_pk_mul_f32 v[56:57], v[86:87], v[78:79]
    v_pk_mul_f32 v[58:59], v[86:87], v[76:77]
    v_pk_fma_f32 v[90:91], v[84:85], v[78:79], v[58:59]
    v_pk_fma_f32 v[88:89], v[84:85], v[76:77], v[56:57] neg_lo:[0,0,1] neg_hi:[0,0,1]
    v_cvt_pk_bf16_f32 v20, v88, v89
    v_cvt_pk_bf16_f32 v21, -v90, -v91
    ds_write_b64 v18, v[20:21] offset:5808
    ds_read_b64_tr_b16 v[148:149], v145 offset:0
    ds_read_b64_tr_b16 v[150:151], v145 offset:1040
    ds_read_b64_tr_b16 v[152:153], v145 offset:64
    ds_read_b64_tr_b16 v[154:155], v145 offset:1104
    v_pk_mul_f32 v[56:57], v[86:87], v[82:83]
    v_pk_mul_f32 v[58:59], v[86:87], v[80:81]
    v_pk_fma_f32 v[86:87], v[84:85], v[82:83], v[58:59]
    v_pk_fma_f32 v[84:85], v[84:85], v[80:81], v[56:57] neg_lo:[0,0,1] neg_hi:[0,0,1]
    v_cvt_pk_bf16_f32 v22, v84, v85
    v_cvt_pk_bf16_f32 v23, -v86, -v87
    ds_write_b64 v18, v[22:23] offset:11088
    s_waitcnt lgkmcnt(1)
    buffer_store_dwordx4 v[148:151], v3, s[60:63], s8 offen sc1
    v_pk_mul_f32 v[56:57], v[86:87], v[70:71]
    v_pk_mul_f32 v[58:59], v[86:87], v[68:69]
    v_pk_fma_f32 v[90:91], v[84:85], v[70:71], v[58:59]
    v_pk_fma_f32 v[88:89], v[84:85], v[68:69], v[56:57] neg_lo:[0,0,1] neg_hi:[0,0,1]
    v_cvt_pk_bf16_f32 v24, v88, v89
    v_cvt_pk_bf16_f32 v25, -v90, -v91
    ds_write_b64 v18, v[24:25] offset:11616
    v_pk_mul_f32 v[56:57], v[86:87], v[78:79]
    v_pk_mul_f32 v[58:59], v[86:87], v[76:77]
    v_pk_fma_f32 v[90:91], v[84:85], v[78:79], v[58:59]
    v_pk_fma_f32 v[88:89], v[84:85], v[76:77], v[56:57] neg_lo:[0,0,1] neg_hi:[0,0,1]
    v_cvt_pk_bf16_f32 v26, v88, v89
    v_cvt_pk_bf16_f32 v27, -v90, -v91
    ds_write_b64 v18, v[26:27] offset:12144
    s_add_u32 s8, s8, 29696
    buffer_store_dwordx4 v[152:155], v3, s[60:63], s8 offen sc1
    v_pk_mul_f32 v[56:57], v[86:87], v[82:83]
    v_pk_mul_f32 v[58:59], v[86:87], v[80:81]
    v_pk_fma_f32 v[86:87], v[84:85], v[82:83], v[58:59]
    v_pk_fma_f32 v[84:85], v[84:85], v[80:81], v[56:57] neg_lo:[0,0,1] neg_hi:[0,0,1]
    v_cvt_pk_bf16_f32 v20, v84, v85
    v_cvt_pk_bf16_f32 v21, -v86, -v87
    ds_write_b64 v18, v[20:21] offset:6336
    ds_read_b64_tr_b16 v[248:249], v146 offset:2064
    ds_read_b64_tr_b16 v[250:251], v146 offset:3104
    ds_read_b64_tr_b16 v[252:253], v147 offset:2064
    ds_read_b64_tr_b16 v[254:255], v147 offset:3104
    v_pk_mul_f32 v[56:57], v[86:87], v[78:79]
    v_pk_mul_f32 v[58:59], v[86:87], v[76:77]
    v_pk_fma_f32 v[90:91], v[84:85], v[78:79], v[58:59]
    v_pk_fma_f32 v[88:89], v[84:85], v[76:77], v[56:57] neg_lo:[0,0,1] neg_hi:[0,0,1]
    v_cvt_pk_bf16_f32 v22, v88, v89
    v_cvt_pk_bf16_f32 v23, -v90, -v91
    ds_write_b64 v18, v[22:23] offset:6864
    s_waitcnt lgkmcnt(1)
    buffer_store_dwordx4 v[248:251], v3, s[60:63], s99 offen offset:0 sc1
    v_pk_mul_f32 v[56:57], v[86:87], v[82:83]
    v_pk_mul_f32 v[58:59], v[86:87], v[80:81]
    v_pk_fma_f32 v[86:87], v[84:85], v[82:83], v[58:59]
    v_pk_fma_f32 v[84:85], v[84:85], v[80:81], v[56:57] neg_lo:[0,0,1] neg_hi:[0,0,1]
    v_cvt_pk_bf16_f32 v24, v84, v85
    v_cvt_pk_bf16_f32 v25, -v86, -v87
    ds_write_b64 v18, v[24:25] offset:7392
    v_pk_mul_f32 v[56:57], v[86:87], v[78:79]
    v_pk_mul_f32 v[58:59], v[86:87], v[76:77]
    v_pk_fma_f32 v[90:91], v[84:85], v[78:79], v[58:59]
    v_pk_fma_f32 v[88:89], v[84:85], v[76:77], v[56:57] neg_lo:[0,0,1] neg_hi:[0,0,1]
    v_cvt_pk_bf16_f32 v26, v88, v89
    v_cvt_pk_bf16_f32 v27, -v90, -v91
    ds_write_b64 v18, v[26:27] offset:7920
    buffer_store_dwordx4 v[252:255], v3, s[60:63], s99 offen offset:1024 sc1
    v_pk_mul_f32 v[56:57], v[86:87], v[82:83]
    v_pk_mul_f32 v[58:59], v[86:87], v[80:81]
    v_pk_fma_f32 v[86:87], v[84:85], v[82:83], v[58:59]
    v_pk_fma_f32 v[84:85], v[84:85], v[80:81], v[56:57] neg_lo:[0,0,1] neg_hi:[0,0,1]
    v_cvt_pk_bf16_f32 v20, v84, v85
    v_cvt_pk_bf16_f32 v21, -v86, -v87
    ds_write_b64 v18, v[20:21] offset:12672
    v_pk_mul_f32 v[56:57], v[86:87], v[78:79]
    v_pk_mul_f32 v[58:59], v[86:87], v[76:77]
    v_pk_fma_f32 v[90:91], v[84:85], v[78:79], v[58:59]
    v_pk_fma_f32 v[88:89], v[84:85], v[76:77], v[56:57] neg_lo:[0,0,1] neg_hi:[0,0,1]
    v_cvt_pk_bf16_f32 v22, v88, v89
    v_cvt_pk_bf16_f32 v23, -v90, -v91
    ds_write_b64 v18, v[22:23] offset:13200
    v_pk_mul_f32 v[56:57], v[86:87], v[82:83]
    v_pk_mul_f32 v[58:59], v[86:87], v[80:81]
    v_pk_fma_f32 v[86:87], v[84:85], v[82:83], v[58:59]
    v_pk_fma_f32 v[84:85], v[84:85], v[80:81], v[56:57] neg_lo:[0,0,1] neg_hi:[0,0,1]
    v_cvt_pk_bf16_f32 v24, v84, v85
    v_cvt_pk_bf16_f32 v25, -v86, -v87
    ds_write_b64 v18, v[24:25] offset:13728
    v_pk_mul_f32 v[56:57], v[86:87], v[78:79]
    v_pk_mul_f32 v[58:59], v[86:87], v[76:77]
    v_pk_fma_f32 v[90:91], v[84:85], v[78:79], v[58:59]
    v_pk_fma_f32 v[88:89], v[84:85], v[76:77], v[56:57] neg_lo:[0,0,1] neg_hi:[0,0,1]
    v_cvt_pk_bf16_f32 v26, v88, v89
    v_cvt_pk_bf16_f32 v27, -v90, -v91
    ds_write_b64 v18, v[26:27] offset:14256
    v_pk_mul_f32 v[56:57], v[54:55], v[50:51]
    v_pk_mul_f32 v[58:59], v[54:55], v[48:49]
    v_pk_fma_f32 v[94:95], v[52:53], v[50:51], v[58:59]
    v_pk_fma_f32 v[92:93], v[52:53], v[48:49], v[56:57] neg_lo:[0,0,1] neg_hi:[0,0,1]
    v_pk_mul_f32 v[92:93], v[92:93], v[42:43]
    v_pk_mul_f32 v[94:95], v[94:95], v[42:43]
    v_cvt_pk_bf16_f32 v20, v92, v93
    v_cvt_pk_bf16_f32 v21, v94, v95
    ds_write_b64 v18, v[20:21] offset:14784
    v_pk_mul_f32 v[56:57], v[94:95], v[78:79]
    v_pk_mul_f32 v[58:59], v[94:95], v[76:77]
    v_pk_fma_f32 v[94:95], v[92:93], v[78:79], v[58:59]
    v_pk_fma_f32 v[92:93], v[92:93], v[76:77], v[56:57] neg_lo:[0,0,1] neg_hi:[0,0,1]
    v_cvt_pk_bf16_f32 v22, v92, v93
    v_cvt_pk_bf16_f32 v23, v94, v95
    ds_write_b64 v18, v[22:23] offset:15312
    v_pk_mul_f32 v[56:57], v[94:95], v[78:79]
    v_pk_mul_f32 v[58:59], v[94:95], v[76:77]
    v_pk_fma_f32 v[94:95], v[92:93], v[78:79], v[58:59]
    v_pk_fma_f32 v[92:93], v[92:93], v[76:77], v[56:57] neg_lo:[0,0,1] neg_hi:[0,0,1]
    v_cvt_pk_bf16_f32 v24, v92, v93
    v_cvt_pk_bf16_f32 v25, v94, v95
    ds_write_b64 v18, v[24:25] offset:15840
    v_pk_mul_f32 v[56:57], v[94:95], v[78:79]
    v_pk_mul_f32 v[58:59], v[94:95], v[76:77]
    v_pk_fma_f32 v[94:95], v[92:93], v[78:79], v[58:59]
    v_pk_fma_f32 v[92:93], v[92:93], v[76:77], v[56:57] neg_lo:[0,0,1] neg_hi:[0,0,1]
    v_cvt_pk_bf16_f32 v26, v92, v93
    v_cvt_pk_bf16_f32 v27, v94, v95
    ds_write_b64 v18, v[26:27] offset:16368
    v_pk_mul_f32 v[56:57], v[94:95], v[78:79]
    v_pk_mul_f32 v[58:59], v[94:95], v[76:77]
    v_pk_fma_f32 v[94:95], v[92:93], v[78:79], v[58:59]
    v_pk_fma_f32 v[92:93], v[92:93], v[76:77], v[56:57] neg_lo:[0,0,1] neg_hi:[0,0,1]
    v_cvt_pk_bf16_f32 v20, v92, v93
    v_cvt_pk_bf16_f32 v21, v94, v95
    ds_write_b64 v18, v[20:21] offset:16896
    ds_read_b128 a[112:115], v19 offset:0
    v_pk_mul_f32 v[56:57], v[94:95], v[78:79]
    v_pk_mul_f32 v[58:59], v[94:95], v[76:77]
    v_pk_fma_f32 v[94:95], v[92:93], v[78:79], v[58:59]
    v_pk_fma_f32 v[92:93], v[92:93], v[76:77], v[56:57] neg_lo:[0,0,1] neg_hi:[0,0,1]
    v_cvt_pk_bf16_f32 v22, v92, v93
    v_cvt_pk_bf16_f32 v23, v94, v95
    ds_write_b64 v18, v[22:23] offset:17424
    ds_read_b128 a[116:119], v19 offset:32
    v_pk_mul_f32 v[56:57], v[94:95], v[78:79]
    v_pk_mul_f32 v[58:59], v[94:95], v[76:77]
    v_pk_fma_f32 v[94:95], v[92:93], v[78:79], v[58:59]
    v_pk_fma_f32 v[92:93], v[92:93], v[76:77], v[56:57] neg_lo:[0,0,1] neg_hi:[0,0,1]
    v_cvt_pk_bf16_f32 v24, v92, v93
    v_cvt_pk_bf16_f32 v25, v94, v95
    s_waitcnt lgkmcnt(13)
    ds_write_b64 v18, v[24:25] offset:17952
    ds_read_b128 a[120:123], v19 offset:64
    v_pk_mul_f32 v[56:57], v[94:95], v[78:79]
    v_pk_mul_f32 v[58:59], v[94:95], v[76:77]
    v_pk_fma_f32 v[94:95], v[92:93], v[78:79], v[58:59]
    v_pk_fma_f32 v[92:93], v[92:93], v[76:77], v[56:57] neg_lo:[0,0,1] neg_hi:[0,0,1]
    v_cvt_pk_bf16_f32 v26, v92, v93
    v_cvt_pk_bf16_f32 v27, v94, v95
    s_waitcnt lgkmcnt(13)
    ds_write_b64 v18, v[26:27] offset:18480
    ds_read_b128 a[124:127], v19 offset:96
    v_pk_mul_f32 v[56:57], v[94:95], v[78:79]
    v_pk_mul_f32 v[58:59], v[94:95], v[76:77]
    v_pk_fma_f32 v[94:95], v[92:93], v[78:79], v[58:59]
    v_pk_fma_f32 v[92:93], v[92:93], v[76:77], v[56:57] neg_lo:[0,0,1] neg_hi:[0,0,1]
    v_cvt_pk_bf16_f32 v20, v92, v93
    v_cvt_pk_bf16_f32 v21, v94, v95
    s_waitcnt lgkmcnt(13)
    ds_write_b64 v18, v[20:21] offset:19008
    ds_read_b128 a[128:131], v19 offset:128
    v_pk_mul_f32 v[56:57], v[94:95], v[78:79]
    v_pk_mul_f32 v[58:59], v[94:95], v[76:77]
    v_pk_fma_f32 v[94:95], v[92:93], v[78:79], v[58:59]
    v_pk_fma_f32 v[92:93], v[92:93], v[76:77], v[56:57] neg_lo:[0,0,1] neg_hi:[0,0,1]
    v_cvt_pk_bf16_f32 v22, v92, v93
    v_cvt_pk_bf16_f32 v23, v94, v95
    s_waitcnt lgkmcnt(13)
    ds_write_b64 v18, v[22:23] offset:19536
    ds_read_b128 a[132:135], v19 offset:160
    v_pk_mul_f32 v[56:57], v[94:95], v[78:79]
    v_pk_mul_f32 v[58:59], v[94:95], v[76:77]
    v_pk_fma_f32 v[94:95], v[92:93], v[78:79], v[58:59]
    v_pk_fma_f32 v[92:93], v[92:93], v[76:77], v[56:57] neg_lo:[0,0,1] neg_hi:[0,0,1]
    v_cvt_pk_bf16_f32 v24, v92, v93
    v_cvt_pk_bf16_f32 v25, v94, v95
    s_waitcnt lgkmcnt(13)
    ds_write_b64 v18, v[24:25] offset:20064
    ds_read_b128 a[136:139], v19 offset:192
    v_pk_mul_f32 v[56:57], v[94:95], v[78:79]
    v_pk_mul_f32 v[58:59], v[94:95], v[76:77]
    v_pk_fma_f32 v[94:95], v[92:93], v[78:79], v[58:59]
    v_pk_fma_f32 v[92:93], v[92:93], v[76:77], v[56:57] neg_lo:[0,0,1] neg_hi:[0,0,1]
    v_cvt_pk_bf16_f32 v26, v92, v93
    v_cvt_pk_bf16_f32 v27, v94, v95
    s_waitcnt lgkmcnt(13)
    ds_write_b64 v18, v[26:27] offset:20592
    s_waitcnt vmcnt(0)
    s_barrier
    s_cmp_lg_u32 s34, 0
    s_cbranch_scc1 L1
    s_getreg_b32 s48, hwreg(HW_REG_XCC_ID, 0, 4)
    s_or_b32 s48, s48, s38
    s_lshl_b32 s49, s2, 4
    s_add_u32 s49, s49, 229376
    v_mov_b32 v13, s48
    v_lshlrev_b32 v14, 12, v1
    s_mov_b64 exec, 0xff
    buffer_store_dword v13, v14, s[60:63], s49 offen sc1
    s_mov_b64 exec, -1
L1:
    ds_read_b128 a[140:143], v19 offset:224
    v_pk_mul_f32 v[56:57], v[94:95], v[78:79]
    v_pk_mul_f32 v[58:59], v[94:95], v[76:77]
    v_pk_fma_f32 v[94:95], v[92:93], v[78:79], v[58:59]
    v_pk_fma_f32 v[92:93], v[92:93], v[76:77], v[56:57] neg_lo:[0,0,1] neg_hi:[0,0,1]
    v_cvt_pk_bf16_f32 v20, v92, v93
    v_cvt_pk_bf16_f32 v21, v94, v95
    s_waitcnt lgkmcnt(13)
    ds_write_b64 v18, v[20:21] offset:21120
    ds_read_b128 a[144:147], v19 offset:256
    v_pk_mul_f32 v[56:57], v[94:95], v[78:79]
    v_pk_mul_f32 v[58:59], v[94:95], v[76:77]
    v_pk_fma_f32 v[94:95], v[92:93], v[78:79], v[58:59]
    v_pk_fma_f32 v[92:93], v[92:93], v[76:77], v[56:57] neg_lo:[0,0,1] neg_hi:[0,0,1]
    v_cvt_pk_bf16_f32 v22, v92, v93
    v_cvt_pk_bf16_f32 v23, v94, v95
    s_waitcnt lgkmcnt(13)
    ds_write_b64 v18, v[22:23] offset:21648
    ds_read_b128 a[148:151], v19 offset:288
    v_pk_mul_f32 v[56:57], v[94:95], v[78:79]
    v_pk_mul_f32 v[58:59], v[94:95], v[76:77]
    v_pk_fma_f32 v[94:95], v[92:93], v[78:79], v[58:59]
    v_pk_fma_f32 v[92:93], v[92:93], v[76:77], v[56:57] neg_lo:[0,0,1] neg_hi:[0,0,1]
    v_cvt_pk_bf16_f32 v24, v92, v93
    v_cvt_pk_bf16_f32 v25, v94, v95
    s_waitcnt lgkmcnt(13)
    ds_write_b64 v18, v[24:25] offset:22176
    ds_read_b128 a[152:155], v19 offset:320
    v_pk_mul_f32 v[56:57], v[94:95], v[78:79]
    v_pk_mul_f32 v[58:59], v[94:95], v[76:77]
    v_pk_fma_f32 v[94:95], v[92:93], v[78:79], v[58:59]
    v_pk_fma_f32 v[92:93], v[92:93], v[76:77], v[56:57] neg_lo:[0,0,1] neg_hi:[0,0,1]
    v_cvt_pk_bf16_f32 v26, v92, v93
    v_cvt_pk_bf16_f32 v27, v94, v95
    s_waitcnt lgkmcnt(13)
    ds_write_b64 v18, v[26:27] offset:22704
    ds_read_b128 a[156:159], v19 offset:352
    v_pk_mul_f32 v[56:57], v[94:95], v[78:79]
    v_pk_mul_f32 v[58:59], v[94:95], v[76:77]
    v_pk_fma_f32 v[94:95], v[92:93], v[78:79], v[58:59]
    v_pk_fma_f32 v[92:93], v[92:93], v[76:77], v[56:57] neg_lo:[0,0,1] neg_hi:[0,0,1]
    v_cvt_pk_bf16_f32 v20, v92, v93
    v_cvt_pk_bf16_f32 v21, v94, v95
    s_waitcnt lgkmcnt(13)
    ds_write_b64 v18, v[20:21] offset:23232
    ds_read_b128 a[160:163], v19 offset:384
    v_pk_mul_f32 v[56:57], v[94:95], v[78:79]
    v_pk_mul_f32 v[58:59], v[94:95], v[76:77]
    v_pk_fma_f32 v[94:95], v[92:93], v[78:79], v[58:59]
    v_pk_fma_f32 v[92:93], v[92:93], v[76:77], v[56:57] neg_lo:[0,0,1] neg_hi:[0,0,1]
    v_cvt_pk_bf16_f32 v22, v92, v93
    v_cvt_pk_bf16_f32 v23, v94, v95
    s_waitcnt lgkmcnt(13)
    ds_write_b64 v18, v[22:23] offset:23760
    ds_read_b128 a[164:167], v19 offset:416
    v_pk_mul_f32 v[56:57], v[94:95], v[78:79]
    v_pk_mul_f32 v[58:59], v[94:95], v[76:77]
    v_pk_fma_f32 v[94:95], v[92:93], v[78:79], v[58:59]
    v_pk_fma_f32 v[92:93], v[92:93], v[76:77], v[56:57] neg_lo:[0,0,1] neg_hi:[0,0,1]
    v_cvt_pk_bf16_f32 v24, v92, v93
    v_cvt_pk_bf16_f32 v25, v94, v95
    s_waitcnt lgkmcnt(13)
    ds_write_b64 v18, v[24:25] offset:24288
    ds_read_b128 a[168:171], v19 offset:448
    v_pk_mul_f32 v[56:57], v[94:95], v[78:79]
    v_pk_mul_f32 v[58:59], v[94:95], v[76:77]
    v_pk_fma_f32 v[94:95], v[92:93], v[78:79], v[58:59]
    v_pk_fma_f32 v[92:93], v[92:93], v[76:77], v[56:57] neg_lo:[0,0,1] neg_hi:[0,0,1]
    v_cvt_pk_bf16_f32 v26, v92, v93
    v_cvt_pk_bf16_f32 v27, v94, v95
    s_waitcnt lgkmcnt(13)
    ds_write_b64 v18, v[26:27] offset:24816
    ds_read_b128 a[172:175], v19 offset:480
    v_pk_mul_f32 v[56:57], v[94:95], v[78:79]
    v_pk_mul_f32 v[58:59], v[94:95], v[76:77]
    v_pk_fma_f32 v[94:95], v[92:93], v[78:79], v[58:59]
    v_pk_fma_f32 v[92:93], v[92:93], v[76:77], v[56:57] neg_lo:[0,0,1] neg_hi:[0,0,1]
    v_cvt_pk_bf16_f32 v20, v92, v93
    v_cvt_pk_bf16_f32 v21, v94, v95
    s_waitcnt lgkmcnt(13)
    ds_write_b64 v18, v[20:21] offset:25344
    v_pk_mul_f32 v[56:57], v[94:95], v[78:79]
    v_pk_mul_f32 v[58:59], v[94:95], v[76:77]
    v_pk_fma_f32 v[94:95], v[92:93], v[78:79], v[58:59]
    v_pk_fma_f32 v[92:93], v[92:93], v[76:77], v[56:57] neg_lo:[0,0,1] neg_hi:[0,0,1]
    v_cvt_pk_bf16_f32 v22, v92, v93
    v_cvt_pk_bf16_f32 v23, v94, v95
    ds_write_b64 v18, v[22:23] offset:25872
    v_pk_mul_f32 v[56:57], v[94:95], v[78:79]
    v_pk_mul_f32 v[58:59], v[94:95], v[76:77]
    v_pk_fma_f32 v[94:95], v[92:93], v[78:79], v[58:59]
    v_pk_fma_f32 v[92:93], v[92:93], v[76:77], v[56:57] neg_lo:[0,0,1] neg_hi:[0,0,1]
    v_cvt_pk_bf16_f32 v24, v92, v93
    v_cvt_pk_bf16_f32 v25, v94, v95
    s_waitcnt lgkmcnt(13)
    ds_write_b64 v18, v[24:25] offset:26400
    v_pk_mul_f32 v[56:57], v[94:95], v[78:79]
    v_pk_mul_f32 v[58:59], v[94:95], v[76:77]
    v_pk_fma_f32 v[94:95], v[92:93], v[78:79], v[58:59]
    v_pk_fma_f32 v[92:93], v[92:93], v[76:77], v[56:57] neg_lo:[0,0,1] neg_hi:[0,0,1]
    v_cvt_pk_bf16_f32 v26, v92, v93
    v_cvt_pk_bf16_f32 v27, v94, v95
    ds_write_b64 v18, v[26:27] offset:26928
    v_pk_mul_f32 v[56:57], v[94:95], v[78:79]
    v_pk_mul_f32 v[58:59], v[94:95], v[76:77]
    v_pk_fma_f32 v[94:95], v[92:93], v[78:79], v[58:59]
    v_pk_fma_f32 v[92:93], v[92:93], v[76:77], v[56:57] neg_lo:[0,0,1] neg_hi:[0,0,1]
    v_cvt_pk_bf16_f32 v20, v92, v93
    v_cvt_pk_bf16_f32 v21, v94, v95
    s_waitcnt lgkmcnt(13)
    ds_write_b64 v18, v[20:21] offset:27456
    v_pk_mul_f32 v[56:57], v[94:95], v[78:79]
    v_pk_mul_f32 v[58:59], v[94:95], v[76:77]
    v_pk_fma_f32 v[94:95], v[92:93], v[78:79], v[58:59]
    v_pk_fma_f32 v[92:93], v[92:93], v[76:77], v[56:57] neg_lo:[0,0,1] neg_hi:[0,0,1]
    v_cvt_pk_bf16_f32 v22, v92, v93
    v_cvt_pk_bf16_f32 v23, v94, v95
    ds_write_b64 v18, v[22:23] offset:27984
    v_pk_mul_f32 v[56:57], v[94:95], v[78:79]
    v_pk_mul_f32 v[58:59], v[94:95], v[76:77]
    v_pk_fma_f32 v[94:95], v[92:93], v[78:79], v[58:59]
    v_pk_fma_f32 v[92:93], v[92:93], v[76:77], v[56:57] neg_lo:[0,0,1] neg_hi:[0,0,1]
    v_cvt_pk_bf16_f32 v24, v92, v93
    v_cvt_pk_bf16_f32 v25, v94, v95
    s_waitcnt lgkmcnt(13)
    ds_write_b64 v18, v[24:25] offset:28512
    v_pk_mul_f32 v[56:57], v[94:95], v[78:79]
    v_pk_mul_f32 v[58:59], v[94:95], v[76:77]
    v_pk_fma_f32 v[94:95], v[92:93], v[78:79], v[58:59]
    v_pk_fma_f32 v[92:93], v[92:93], v[76:77], v[56:57] neg_lo:[0,0,1] neg_hi:[0,0,1]
    v_cvt_pk_bf16_f32 v26, v92, v93
    v_cvt_pk_bf16_f32 v27, v94, v95
    ds_write_b64 v18, v[26:27] offset:29040
    v_pk_mul_f32 v[56:57], v[94:95], v[78:79]
    v_pk_mul_f32 v[58:59], v[94:95], v[76:77]
    v_pk_fma_f32 v[94:95], v[92:93], v[78:79], v[58:59]
    v_pk_fma_f32 v[92:93], v[92:93], v[76:77], v[56:57] neg_lo:[0,0,1] neg_hi:[0,0,1]
    v_cvt_pk_bf16_f32 v20, v92, v93
    v_cvt_pk_bf16_f32 v21, v94, v95
    s_waitcnt lgkmcnt(13)
    ds_write_b64 v18, v[20:21] offset:29568
    v_pk_mul_f32 v[56:57], v[94:95], v[78:79]
    v_pk_mul_f32 v[58:59], v[94:95], v[76:77]
    v_pk_fma_f32 v[94:95], v[92:93], v[78:79], v[58:59]
    v_pk_fma_f32 v[92:93], v[92:93], v[76:77], v[56:57] neg_lo:[0,0,1] neg_hi:[0,0,1]
    v_cvt_pk_bf16_f32 v22, v92, v93
    v_cvt_pk_bf16_f32 v23, v94, v95
    ds_write_b64 v18, v[22:23] offset:30096
    v_pk_mul_f32 v[56:57], v[94:95], v[78:79]
    v_pk_mul_f32 v[58:59], v[94:95], v[76:77]
    v_pk_fma_f32 v[94:95], v[92:93], v[78:79], v[58:59]
    v_pk_fma_f32 v[92:93], v[92:93], v[76:77], v[56:57] neg_lo:[0,0,1] neg_hi:[0,0,1]
    v_cvt_pk_bf16_f32 v24, v92, v93
    v_cvt_pk_bf16_f32 v25, v94, v95
    s_waitcnt lgkmcnt(13)
    ds_write_b64 v18, v[24:25] offset:30624
    v_pk_mul_f32 v[56:57], v[94:95], v[78:79]
    v_pk_mul_f32 v[58:59], v[94:95], v[76:77]
    v_pk_fma_f32 v[94:95], v[92:93], v[78:79], v[58:59]
    v_pk_fma_f32 v[92:93], v[92:93], v[76:77], v[56:57] neg_lo:[0,0,1] neg_hi:[0,0,1]
    v_cvt_pk_bf16_f32 v26, v92, v93
    v_cvt_pk_bf16_f32 v27, v94, v95
    ds_write_b64 v18, v[26:27] offset:31152
    s_lshl_b32 s80, s35, 12
    s_add_u32 s80, s80, 229376
    buffer_load_dword v118, v0, s[60:63], s80 offen sc1
    s_waitcnt lgkmcnt(13)
    ds_read_b128 a[176:179], v28 offset:14784
    ds_read_b128 a[180:183], v28 offset:14816
    s_waitcnt lgkmcnt(13)
    ds_read_b128 a[184:187], v28 offset:14848
    ds_read_b128 a[188:191], v28 offset:14880
    s_waitcnt lgkmcnt(13)
    ds_read_b128 a[192:195], v28 offset:14912
    ds_read_b128 a[196:199], v28 offset:14944
    s_waitcnt lgkmcnt(13)
    ds_read_b128 a[200:203], v28 offset:14976
    ds_read_b128 a[204:207], v28 offset:15008
    s_waitcnt lgkmcnt(7)
    v_mfma_f32_32x32x16_bf16 v[32:47], a[112:115], a[176:179], 0
    s_barrier
    ds_read_b128 a[208:211], v28 offset:15040
    ds_read_b128 a[212:215], v28 offset:15072
    s_waitcnt lgkmcnt(8)
    v_mfma_f32_32x32x16_bf16 v[32:47], a[116:119], a[180:183], v[32:47]
    ds_read_b128 a[216:219], v28 offset:15104
    ds_read_b128 a[220:223], v28 offset:15136
    s_waitcnt lgkmcnt(9)
    v_mfma_f32_32x32x16_bf16 v[32:47], a[120:123], a[184:187], v[32:47]
    ds_read_b128 a[176:179], v28 offset:15168
    ds_read_b128 a[180:183], v28 offset:15200
    s_waitcnt lgkmcnt(10)
    v_mfma_f32_32x32x16_bf16 v[32:47], a[124:127], a[188:191], v[32:47]
    ds_read_b128 a[184:187], v28 offset:15232
    ds_read_b128 a[188:191], v28 offset:15264
    s_waitcnt lgkmcnt(11)
    v_mfma_f32_32x32x16_bf16 v[32:47], a[128:131], a[192:195], v[32:47]
    ds_read_b128 a[112:115], v29 offset:0
    ds_read_b128 a[192:195], v30 offset:14784
    s_waitcnt lgkmcnt(12)
    v_mfma_f32_32x32x16_bf16 v[32:47], a[132:135], a[196:199], v[32:47]
    ds_read_b128 a[116:119], v29 offset:32
    ds_read_b128 a[196:199], v30 offset:14816
    s_waitcnt lgkmcnt(13)
    v_mfma_f32_32x32x16_bf16 v[32:47], a[136:139], a[200:203], v[32:47]
    ds_read_b128 a[120:123], v29 offset:64
    ds_read_b128 a[200:203], v30 offset:14848
    s_waitcnt lgkmcnt(14)
    v_mfma_f32_32x32x16_bf16 v[32:47], a[140:143], a[204:207], v[32:47]
    ds_read_b128 a[124:127], v29 offset:96
    s_waitcnt lgkmcnt(13)
    ds_read_b128 a[204:207], v30 offset:14880
    v_mfma_f32_32x32x16_bf16 v[32:47], a[144:147], a[208:211], v[32:47]
    ds_read_b128 a[128:131], v29 offset:128
    s_waitcnt lgkmcnt(13)
    ds_read_b128 a[208:211], v30 offset:14912
    v_mfma_f32_32x32x16_bf16 v[32:47], a[148:151], a[212:215], v[32:47]
    ds_read_b128 a[132:135], v29 offset:160
    s_waitcnt lgkmcnt(13)
    ds_read_b128 a[212:215], v30 offset:14944
    v_mfma_f32_32x32x16_bf16 v[32:47], a[152:155], a[216:219], v[32:47]
    ds_read_b128 a[136:139], v29 offset:192
    s_waitcnt lgkmcnt(13)
    ds_read_b128 a[216:219], v30 offset:14976
    v_mfma_f32_32x32x16_bf16 v[32:47], a[156:159], a[220:223], v[32:47]
    ds_read_b128 a[140:143], v29 offset:224
    s_waitcnt lgkmcnt(13)
    ds_read_b128 a[220:223], v30 offset:15008
    v_mfma_f32_32x32x16_bf16 v[32:47], a[160:163], a[176:179], v[32:47]
    ds_read_b128 a[144:147], v29 offset:256
    s_waitcnt lgkmcnt(13)
    ds_read_b128 a[176:179], v30 offset:15040
    v_mfma_f32_32x32x16_bf16 v[32:47], a[164:167], a[180:183], v[32:47]
    ds_read_b128 a[148:151], v29 offset:288
    s_waitcnt lgkmcnt(13)
    ds_read_b128 a[180:183], v30 offset:15072
    v_mfma_f32_32x32x16_bf16 v[32:47], a[168:171], a[184:187], v[32:47]
    ds_read_b128 a[152:155], v29 offset:320
    s_waitcnt lgkmcnt(13)
    ds_read_b128 a[184:187], v30 offset:15104
    v_mfma_f32_32x32x16_bf16 v[32:47], a[172:175], a[188:191], v[32:47]
    ds_read_b128 a[156:159], v29 offset:352
    s_waitcnt lgkmcnt(13)
    ds_read_b128 a[188:191], v30 offset:15136
    v_mfma_f32_32x32x16_bf16 v[32:47], a[112:115], a[192:195], v[32:47]
    ds_read_b128 a[160:163], v29 offset:384
    s_waitcnt lgkmcnt(13)
    ds_read_b128 a[192:195], v30 offset:15168
    v_mfma_f32_32x32x16_bf16 v[32:47], a[116:119], a[196:199], v[32:47]
    ds_read_b128 a[164:167], v29 offset:416
    s_waitcnt lgkmcnt(13)
    ds_read_b128 a[196:199], v30 offset:15200
    v_mfma_f32_32x32x16_bf16 v[32:47], a[120:123], a[200:203], v[32:47]
    ds_read_b128 a[168:171], v29 offset:448
    s_waitcnt lgkmcnt(13)
    ds_read_b128 a[200:203], v30 offset:15232
    v_mfma_f32_32x32x16_bf16 v[32:47], a[124:127], a[204:207], v[32:47]
    ds_read_b128 a[172:175], v29 offset:480
    s_waitcnt lgkmcnt(13)
    ds_read_b128 a[204:207], v30 offset:15264
    s_waitcnt vmcnt(0)
    s_branch L4
L2:
    buffer_load_dword v118, v0, s[60:63], s80 offen sc1
    s_waitcnt vmcnt(0)
L4:
    v_xor_b32 v118, s38, v118
    v_cmp_lt_u32 vcc, 15, v118
    s_cbranch_vccz L3
    s_add_u32 s47, s47, 1
    s_cmp_lt_u32 s47, 262144
    s_cbranch_scc1 L2
L3:
    s_barrier
    s_mov_b32 s86, 196608
    s_mov_b32 s87, 200704
    s_mov_b32 s96, 1048576
    buffer_load_dwordx4 v[96:99], v0, s[60:63], s86 offen sc1
    buffer_load_dwordx4 v[100:103], v0, s[60:63], s87 offen sc1
    buffer_load_dwordx2 v[104:105], v11, s[60:63], s96 offen sc1
    buffer_load_dwordx2 v[106:107], v11, s[60:63], s96 offen offset:64 sc1
    v_mfma_f32_32x32x16_bf16 v[32:47], a[128:131], a[208:211], v[32:47]
    s_sub_u32 s81, s36, s41
    s_add_u32 s81, s81, 4
    s_and_b32 s48, s78, 3
    v_add_u32 v116, s81, v1
    v_mov_b32 v117, s48
    v_cmp_gt_u32 vcc, 14, v1
    s_lshl_b32 s81, s35, 4
    s_add_u32 s81, s81, s80
    v_cndmask_b32 v116, v117, v116, vcc
    v_lshlrev_b32 v116, 7, v116
    buffer_load_dword v117, v116, s[60:63], s81 offen sc1
    v_mfma_f32_32x32x16_bf16 v[32:47], a[132:135], a[212:215], v[32:47]
    s_mov_b32 s86, 204800
    s_mov_b32 s87, 208896
    s_mov_b32 s96, 1974272
    buffer_load_dwordx4 v[124:127], v0, s[60:63], s86 offen sc1
    v_mfma_f32_32x32x16_bf16 v[32:47], a[136:139], a[216:219], v[32:47]
    buffer_load_dwordx4 v[128:131], v0, s[60:63], s87 offen sc1
    v_mfma_f32_32x32x16_bf16 v[32:47], a[140:143], a[220:223], v[32:47]
    buffer_load_dwordx2 v[132:133], v11, s[60:63], s96 offen sc1
    v_mfma_f32_32x32x16_bf16 v[32:47], a[144:147], a[176:179], v[32:47]
    buffer_load_dwordx2 v[134:135], v11, s[60:63], s96 offen offset:64 sc1
    s_waitcnt lgkmcnt(12)
    v_mfma_f32_32x32x16_bf16 v[32:47], a[148:151], a[180:183], v[32:47]
    s_waitcnt lgkmcnt(10)
    v_mfma_f32_32x32x16_bf16 v[32:47], a[152:155], a[184:187], v[32:47]
    s_waitcnt lgkmcnt(8)
    v_mfma_f32_32x32x16_bf16 v[32:47], a[156:159], a[188:191], v[32:47]
    buffer_load_dwordx4 v[144:147], v3, s[60:63], s22 offen offset:0 sc1
    s_waitcnt lgkmcnt(6)
    v_mfma_f32_32x32x16_bf16 v[32:47], a[160:163], a[192:195], v[32:47]
    s_waitcnt lgkmcnt(4)
    v_mfma_f32_32x32x16_bf16 v[32:47], a[164:167], a[196:199], v[32:47]
    s_waitcnt lgkmcnt(2)
    v_mfma_f32_32x32x16_bf16 v[32:47], a[168:171], a[200:203], v[32:47]
    buffer_load_dwordx4 v[148:151], v3, s[60:63], s22 offen offset:1024 sc1
    s_waitcnt lgkmcnt(0)
    v_mfma_f32_32x32x16_bf16 v[32:47], a[172:175], a[204:207], v[32:47]
    buffer_load_dwordx4 v[152:155], v3, s[60:63], s22 offen offset:2048 sc1
    buffer_load_dwordx4 v[156:159], v3, s[60:63], s22 offen offset:3072 sc1
    s_lshr_b32 s51, s34, 1
    s_mul_i32 s51, s51, 8320
    s_add_u32 s51, s51, 138480
    v_mul_u32_u24 v20, 4160, v16
    v_lshlrev_b32 v21, 4, v17
    v_sub_u32 v20, v20, v21
    v_add_u32 v20, s51, v20
    s_mov_b32 vcc_lo, 0
    s_mov_b32 vcc_hi, -1
    s_mov_b32 s92, 0
    s_mov_b32 s93, 0xaaaaaaaa
    s_mov_b32 s94, 0xaaaaaaaa
    s_mov_b32 s95, -1
    s_bitcmp1_b32 s34, 0
    s_cbranch_scc1 L5
    v_cndmask_b32 v52, v32, v33, vcc
    v_cndmask_b32 v53, v33, v34, vcc
    v_cndmask_b32 v54, v34, v35, vcc
    v_cndmask_b32 v55, v35, v36, vcc
    v_cndmask_b32 v56, v36, v37, vcc
    v_cndmask_b32 v57, v37, v38, vcc
    v_cndmask_b32 v58, v38, v39, vcc
    v_cndmask_b32 v59, v39, v40, vcc
    v_cvt_pk_bf16_f32 v64, v59, v58
    v_cvt_pk_bf16_f32 v65, v57, v56
    v_cvt_pk_bf16_f32 v66, v55, v54
    v_cvt_pk_bf16_f32 v67, v53, v52
    ds_write_b128 v20, v[64:67] offset:3584
    v_cndmask_b32 v48, v41, v42, vcc
    v_cndmask_b32 v49, v42, v43, vcc
    v_cvt_pk_bf16_f32 v68, v43, v43
    v_cvt_pk_bf16_f32 v69, v49, v42
    v_cvt_pk_bf16_f32 v70, v42, v48
    v_cvt_pk_bf16_f32 v71, v41, v41
    ds_write_b128 v20, v[68:71] offset:2560
    v_cndmask_b32 v50, v44, v45, s[92:93]
    v_cndmask_b32 v51, v44, v45, s[94:95]
    v_cvt_pk_bf16_f32 v72, v45, v45
    v_cvt_pk_bf16_f32 v73, v45, v51
    v_cvt_pk_bf16_f32 v74, v50, v44
    v_cvt_pk_bf16_f32 v75, v44, v44
    ds_write_b128 v20, v[72:75] offset:1536
    v_cndmask_b32 v50, v46, v47, s[92:93]
    v_cndmask_b32 v51, v46, v47, s[94:95]
    v_cvt_pk_bf16_f32 v76, v47, v47
    v_cvt_pk_bf16_f32 v77, v47, v51
    v_cvt_pk_bf16_f32 v78, v50, v46
    v_cvt_pk_bf16_f32 v79, v46, v46
    ds_write_b128 v20, v[76:79] offset:1024
    v_cvt_pk_bf16_f32 v24, v32, 0
    v_mov_b32 v25, 0
    v_mov_b32 v26, 0
    v_mov_b32 v27, 0
    s_mov_b32 s93, 1
    v_lshl_add_u32 v20, v21, 1, v20
    v_cndmask_b32 v24, v25, v24, s[92:93]
    s_mov_b32 exec_lo, 15
    s_mov_b32 exec_hi, 15
    ds_write_b128 v20, v[24:27] offset:3600
    s_mov_b64 exec, -1
    s_branch L6
L5:
    v_cndmask_b32 v52, v32, v33, vcc
    v_cndmask_b32 v53, v33, v34, vcc
    v_cndmask_b32 v54, v34, v35, vcc
    v_cndmask_b32 v55, v35, v36, vcc
    v_cvt_pk_bf16_f32 v64, v36, v55
    v_cvt_pk_bf16_f32 v65, v54, v34
    v_cvt_pk_bf16_f32 v66, v34, v53
    v_cvt_pk_bf16_f32 v67, v52, v32
    ds_write_b128 v20, v[64:67] offset:3072
    v_cndmask_b32 v48, v37, v38, vcc
    v_cndmask_b32 v49, v38, v39, vcc
    v_cvt_pk_bf16_f32 v68, v39, v39
    v_cvt_pk_bf16_f32 v69, v49, v38
    v_cvt_pk_bf16_f32 v70, v38, v48
    v_cvt_pk_bf16_f32 v71, v37, v37
    ds_write_b128 v20, v[68:71] offset:2048
    v_cndmask_b32 v50, v40, v41, s[92:93]
    v_cndmask_b32 v51, v40, v41, s[94:95]
    v_cvt_pk_bf16_f32 v72, v41, v41
    v_cvt_pk_bf16_f32 v73, v41, v51
    v_cvt_pk_bf16_f32 v74, v50, v40
    v_cvt_pk_bf16_f32 v75, v40, v40
    ds_write_b128 v20, v[72:75] offset:512
    v_cndmask_b32 v50, v42, v43, s[92:93]
    v_cndmask_b32 v51, v42, v43, s[94:95]
    v_cvt_pk_bf16_f32 v76, v43, v43
    v_cvt_pk_bf16_f32 v77, v43, v51
    v_cvt_pk_bf16_f32 v78, v50, v42
    v_cvt_pk_bf16_f32 v79, v42, v42
    ds_write_b128 v20, v[76:79] offset:0
L6:
    s_add_u32 s22, s22, 4096
    buffer_load_dwordx4 v[160:163], v3, s[60:63], s22 offen offset:0 sc1
    s_waitcnt lgkmcnt(0)
    s_barrier
    ds_read2_b32 v[16:17], v4 offset0:176 offset1:177
    ds_read2_b32 v[18:19], v4 offset0:178 offset1:179
    ds_read2_b32 v[20:21], v4 offset0:48 offset1:49
    ds_read2_b32 v[22:23], v4 offset0:50 offset1:51
    ds_read2_b32 v[24:25], v5 offset0:176 offset1:177
    ds_read2_b32 v[26:27], v5 offset0:178 offset1:179
    ds_read2_b32 v[28:29], v5 offset0:48 offset1:49
    ds_read2_b32 v[30:31], v5 offset0:50 offset1:51
    buffer_load_dwordx4 v[164:167], v3, s[60:63], s22 offen offset:1024 sc1
    ds_read2_b32 v[32:33], v4 offset0:160 offset1:161
    ds_read2_b32 v[34:35], v4 offset0:162 offset1:163
    ds_read2_b32 v[36:37], v4 offset0:32 offset1:33
    ds_read2_b32 v[38:39], v4 offset0:34 offset1:35
    ds_read2_b32 v[40:41], v5 offset0:160 offset1:161
    ds_read2_b32 v[42:43], v5 offset0:162 offset1:163
    ds_read2_b32 v[44:45], v5 offset0:32 offset1:33
    s_waitcnt lgkmcnt(13)
    ds_read2_b32 v[46:47], v5 offset0:34 offset1:35
    buffer_load_dwordx4 v[168:171], v3, s[60:63], s22 offen offset:2048 sc1
    ds_read2_b32 v[48:49], v4 offset0:144 offset1:145
    s_waitcnt lgkmcnt(13)
    ds_read2_b32 v[50:51], v4 offset0:146 offset1:147
    ds_read2_b32 v[52:53], v4 offset0:16 offset1:17
    s_waitcnt lgkmcnt(13)
    ds_read2_b32 v[54:55], v4 offset0:18 offset1:19
    ds_read2_b32 v[56:57], v5 offset0:144 offset1:145
    s_waitcnt lgkmcnt(13)
    ds_read2_b32 v[58:59], v5 offset0:146 offset1:147
    ds_read2_b32 v[60:61], v5 offset0:16 offset1:17
    s_waitcnt lgkmcnt(13)
    ds_read2_b32 v[62:63], v5 offset0:18 offset1:19
    buffer_load_dwordx4 v[172:175], v3, s[60:63], s22 offen offset:3072 sc1
    s_waitcnt vmcnt(13)
    v_lshlrev_b32 v108, 16, v104
    v_and_b32 v109, s69, v104
    v_lshlrev_b32 v110, 16, v105
    v_and_b32 v111, s69, v105
    v_lshlrev_b32 v112, 16, v106
    v_and_b32 v113, s69, v106
    v_lshlrev_b32 v114, 16, v107
    v_and_b32 v115, s69, v107
    v_fma_f32 v136, v108, v97, v96
    v_fma_f32 v137, v109, v99, v98
    v_fma_f32 v138, v110, v101, v100
    v_fma_f32 v139, v111, v103, v102
    v_cvt_pk_bf16_f32 v104, v136, v137
    v_cvt_pk_bf16_f32 v105, v138, v139
    ds_write_b64 v12, v[104:105] offset:0
    v_fma_f32 v140, v112, v97, v96
    v_fma_f32 v141, v113, v99, v98
    v_fma_f32 v142, v114, v101, v100
    v_fma_f32 v143, v115, v103, v102
    v_cvt_pk_bf16_f32 v106, v140, v141
    v_cvt_pk_bf16_f32 v107, v142, v143
    s_waitcnt lgkmcnt(13)
    ds_write_b64 v12, v[106:107] offset:4608
    s_waitcnt vmcnt(12)
    v_readfirstlane_b32 s48, v117
    s_nop 1
    v_cmp_ne_u32 vcc, s48, v117
    s_cmp_eq_u64 vcc, 0
    s_cselect_b32 s46, 1, 0
    s_lshl_b32 s48, s2, 2
    s_add_u32 s48, s48, s34
    s_cmp_lg_u32 s48, 128
    s_cbranch_scc1 L7
    v_mov_b32 v13, s38
    s_mov_b64 exec, 1
    buffer_store_dword v13, off, s[60:63], 0 sc1
    s_mov_b64 exec, -1
L7:
    s_waitcnt lgkmcnt(0)
    s_barrier
    ds_read_b128 v[80:83], v8 offset:192
    ds_read_b128 v[84:87], v8 offset:704
    ds_read_b128 v[88:91], v8 offset:1216
    ds_read_b128 v[92:95], v8 offset:1728
    ds_read_b128 v[96:99], v8 offset:128
    ds_read_b128 v[100:103], v8 offset:640
    ds_read_b128 v[104:107], v8 offset:1152
    s_waitcnt lgkmcnt(6)
    v_mfma_f32_16x16x32_bf16 a[224:227], v[16:19], v[80:83], 0
    s_add_u32 s22, s22, 4096
    buffer_load_dwordx4 v[176:179], v3, s[60:63], s22 offen offset:0 sc1
    s_waitcnt lgkmcnt(5)
    v_mfma_f32_16x16x32_bf16 a[228:231], v[16:19], v[84:87], 0
    v_fmac_f32 v108, s44, v136
    v_fmac_f32 v109, s44, v137
    v_mfma_f32_16x16x32_bf16 a[228:231], v[20:23], v[80:83], a[228:231]
    s_lshl_b32 s96, s35, 10
    s_add_u32 s96, s96, 180224
    v_and_b32 v13, 0x1f0, v3
    buffer_load_dword v14, v13, s[60:63], s96 offen sc1
    s_waitcnt lgkmcnt(4)
    v_mfma_f32_16x16x32_bf16 a[232:235], v[16:19], v[88:91], 0
    v_fmac_f32 v110, s44, v138
    v_fmac_f32 v111, s44, v139
    v_mfma_f32_16x16x32_bf16 a[232:235], v[20:23], v[84:87], a[232:235]
    v_fmac_f32 v112, s45, v140
    v_fmac_f32 v113, s45, v141
    v_mfma_f32_16x16x32_bf16 a[232:235], v[24:27], v[80:83], a[232:235]
    buffer_load_dwordx4 v[180:183], v3, s[60:63], s22 offen offset:1024 sc1
    v_fmac_f32 v114, s45, v142
    s_waitcnt lgkmcnt(3)
    v_mfma_f32_16x16x32_bf16 a[236:239], v[16:19], v[92:95], 0
    ds_read_b128 v[92:95], v8 offset:1664
    v_fmac_f32 v115, s45, v143
    v_mfma_f32_16x16x32_bf16 a[236:239], v[20:23], v[88:91], a[236:239]
    ds_read_b128 v[88:91], v8 offset:64
    v_mfma_f32_16x16x32_bf16 a[236:239], v[24:27], v[84:87], a[236:239]
    ds_read_b128 v[84:87], v8 offset:576
    v_mfma_f32_16x16x32_bf16 a[236:239], v[28:31], v[80:83], a[236:239]
    ds_read_b128 v[80:83], v8 offset:1088
    s_waitcnt lgkmcnt(6)
    v_mfma_f32_16x16x32_bf16 a[224:227], v[32:35], v[96:99], a[224:227]
    buffer_load_dwordx4 v[184:187], v3, s[60:63], s22 offen offset:2048 sc1
    s_waitcnt lgkmcnt(5)
    v_mfma_f32_16x16x32_bf16 a[228:231], v[32:35], v[100:103], a[228:231]
    v_mfma_f32_16x16x32_bf16 a[228:231], v[36:39], v[96:99], a[228:231]
    s_waitcnt lgkmcnt(4)
    v_mfma_f32_16x16x32_bf16 a[232:235], v[32:35], v[104:107], a[232:235]
    v_mfma_f32_16x16x32_bf16 a[232:235], v[36:39], v[100:103], a[232:235]
    v_mfma_f32_16x16x32_bf16 a[232:235], v[40:43], v[96:99], a[232:235]
    s_waitcnt lgkmcnt(3)
    v_mfma_f32_16x16x32_bf16 a[236:239], v[32:35], v[92:95], a[236:239]
    ds_read_b128 v[92:95], v8 offset:1600
    buffer_load_dwordx4 v[188:191], v3, s[60:63], s22 offen offset:3072 sc1
    v_mfma_f32_16x16x32_bf16 a[236:239], v[36:39], v[104:107], a[236:239]
    ds_read2_b32 v[64:65], v4 offset0:128 offset1:129
    v_mfma_f32_16x16x32_bf16 a[236:239], v[40:43], v[100:103], a[236:239]
    ds_read2_b32 v[66:67], v4 offset0:130 offset1:131
    v_mfma_f32_16x16x32_bf16 a[236:239], v[44:47], v[96:99], a[236:239]
    ds_read_b128 v[104:107], v8 offset:0
    s_waitcnt lgkmcnt(6)
    v_mfma_f32_16x16x32_bf16 a[224:227], v[48:51], v[88:91], a[224:227]
    ds_read_b128 v[100:103], v8 offset:512
    s_waitcnt lgkmcnt(6)
    v_mfma_f32_16x16x32_bf16 a[228:231], v[48:51], v[84:87], a[228:231]
    ds_read2_b32 v[68:69], v4 offset0:0 offset1:1
    s_add_u32 s22, s22, 4096
    buffer_load_dwordx4 v[192:195], v3, s[60:63], s22 offen offset:0 sc1
    v_mfma_f32_16x16x32_bf16 a[228:231], v[52:55], v[88:91], a[228:231]
    ds_read2_b32 v[70:71], v4 offset0:2 offset1:3
    s_waitcnt lgkmcnt(7)
    v_mfma_f32_16x16x32_bf16 a[232:235], v[48:51], v[80:83], a[232:235]
    ds_read_b128 v[96:99], v8 offset:1024
    v_mfma_f32_16x16x32_bf16 a[232:235], v[52:55], v[84:87], a[232:235]
    ds_read2_b32 v[72:73], v5 offset0:128 offset1:129
    v_mfma_f32_16x16x32_bf16 a[232:235], v[56:59], v[88:91], a[232:235]
    ds_read2_b32 v[74:75], v5 offset0:130 offset1:131
    s_waitcnt lgkmcnt(9)
    v_mfma_f32_16x16x32_bf16 a[236:239], v[48:51], v[92:95], a[236:239]
    ds_read_b128 v[92:95], v8 offset:1536
    v_mfma_f32_16x16x32_bf16 a[236:239], v[52:55], v[80:83], a[236:239]
    ds_read2_b32 v[76:77], v5 offset0:0 offset1:1
    buffer_load_dwordx4 v[196:199], v3, s[60:63], s22 offen offset:1024 sc1
    v_mfma_f32_16x16x32_bf16 a[236:239], v[56:59], v[84:87], a[236:239]
    ds_read2_b32 v[78:79], v5 offset0:2 offset1:3
    v_mfma_f32_16x16x32_bf16 a[236:239], v[60:63], v[88:91], a[236:239]
    ds_read_b128 v[80:83], v8 offset:1728
    s_waitcnt lgkmcnt(10)
    v_mfma_f32_16x16x32_bf16 a[224:227], v[64:67], v[104:107], a[224:227]
    ds_read2_b32 v[84:85], v6 offset0:176 offset1:177
    s_waitcnt lgkmcnt(10)
    v_mfma_f32_16x16x32_bf16 a[228:231], v[64:67], v[100:103], a[228:231]
    ds_read2_b32 v[86:87], v6 offset0:178 offset1:179
    s_waitcnt lgkmcnt(9)
    v_mfma_f32_16x16x32_bf16 a[228:231], v[68:71], v[104:107], a[228:231]
    ds_read_b128 v[88:91], v8 offset:1216
    buffer_load_dwordx4 v[200:203], v3, s[60:63], s22 offen offset:2048 sc1
    s_waitcnt lgkmcnt(9)
    v_mfma_f32_16x16x32_bf16 a[232:235], v[64:67], v[96:99], a[232:235]
    v_mfma_f32_16x16x32_bf16 a[232:235], v[68:71], v[100:103], a[232:235]
    ds_write_b128 v9, a[224:227] offset:0
    s_waitcnt lgkmcnt(8)
    v_mfma_f32_16x16x32_bf16 a[232:235], v[72:75], v[104:107], a[232:235]
    s_waitcnt lgkmcnt(7)
    v_mfma_f32_16x16x32_bf16 a[236:239], v[64:67], v[92:95], a[236:239]
    ds_write_b128 v9, a[228:231] offset:256
    v_mfma_f32_16x16x32_bf16 a[236:239], v[68:71], v[96:99], a[236:239]
    ds_read2_b32 v[92:93], v6 offset0:48 offset1:49
    v_mfma_f32_16x16x32_bf16 a[236:239], v[72:75], v[100:103], a[236:239]
    ds_read2_b32 v[94:95], v6 offset0:50 offset1:51
    buffer_load_dwordx4 v[204:207], v3, s[60:63], s22 offen offset:3072 sc1
    s_waitcnt lgkmcnt(8)
    v_mfma_f32_16x16x32_bf16 a[236:239], v[76:79], v[104:107], a[236:239]
    ds_write_b128 v9, a[232:235] offset:512
    s_waitcnt lgkmcnt(8)
    v_mfma_f32_16x16x32_bf16 a[240:243], v[20:23], v[80:83], 0
    ds_read_b128 v[96:99], v8 offset:704
    v_mfma_f32_16x16x32_bf16 a[244:247], v[24:27], v[80:83], 0
    ds_read2_b32 v[100:101], v7 offset0:176 offset1:177
    v_mfma_f32_16x16x32_bf16 a[248:251], v[28:31], v[80:83], 0
    ds_read2_b32 v[102:103], v7 offset0:178 offset1:179
    s_waitcnt lgkmcnt(9)
    v_mfma_f32_16x16x32_bf16 a[252:255], v[84:87], v[80:83], 0
    ds_write_b128 v9, a[236:239] offset:768
    s_add_u32 s22, s22, 4096
    buffer_load_dwordx4 v[208:211], v3, s[60:63], s22 offen offset:0 sc1
    s_waitcnt lgkmcnt(9)
    v_mfma_f32_16x16x32_bf16 a[240:243], v[24:27], v[88:91], a[240:243]
    ds_read_b128 v[104:107], v8 offset:192
    v_mfma_f32_16x16x32_bf16 a[244:247], v[28:31], v[88:91], a[244:247]
    ds_read2_b32 v[80:81], v7 offset0:48 offset1:49
    v_mfma_f32_16x16x32_bf16 a[248:251], v[84:87], v[88:91], a[248:251]
    s_waitcnt vmcnt(8)
    v_cmp_ne_u32 vcc, s38, v14
    s_cbranch_vccnz L8
L9:
    s_waitcnt lgkmcnt(2)
    s_barrier
    s_mov_b32 s85, 3145728
    ds_read_b128 v[136:139], v10 offset:0
    v_mfma_f32_16x16x32_bf16 a[252:255], v[92:95], v[88:91], a[252:255]
    ds_read_b128 v[140:143], v10 offset:4352
    v_mfma_f32_16x16x32_bf16 a[240:243], v[28:31], v[96:99], a[240:243]
    ds_read_b128 v[116:119], v10 offset:8704
    v_mfma_f32_16x16x32_bf16 a[244:247], v[84:87], v[96:99], a[244:247]
    ds_read_b128 v[120:123], v10 offset:13056
    buffer_load_dwordx4 v[212:215], v3, s[60:63], s22 offen offset:1024 sc1
    v_mfma_f32_16x16x32_bf16 a[248:251], v[92:95], v[96:99], a[248:251]
    ds_read2_b32 v[82:83], v7 offset0:50 offset1:51
    v_mfma_f32_16x16x32_bf16 a[252:255], v[100:103], v[96:99], a[252:255]
    ds_read_b128 a[224:227], v8 offset:1664
    s_waitcnt lgkmcnt(5)
    v_add_f32 v108, v108, v136
    v_mfma_f32_16x16x32_bf16 a[240:243], v[84:87], v[104:107], a[240:243]
    v_add_f32 v109, v109, v137
    v_add_f32 v110, v110, v138
    v_add_f32 v111, v111, v139
    s_waitcnt lgkmcnt(4)
    v_add_f32 v108, v108, v140
    v_add_f32 v109, v109, v141
    ds_read2_b32 a[228:229], v6 offset0:160 offset1:161
    v_mfma_f32_16x16x32_bf16 a[244:247], v[92:95], v[104:107], a[244:247]
    v_add_f32 v110, v110, v142
    v_add_f32 v111, v111, v143
    v_cvt_pk_bf16_f32 v108, v108, v109
    v_cvt_pk_bf16_f32 v109, v110, v111
    ds_read2_b32 a[230:231], v6 offset0:162 offset1:163
    v_mfma_f32_16x16x32_bf16 a[248:251], v[100:103], v[104:107], a[248:251]
    buffer_store_dwordx2 v[108:109], v11, s[60:63], s85 offen offset:0 sc1
    s_waitcnt lgkmcnt(5)
    v_add_f32 v112, v112, v116
    v_add_f32 v113, v113, v117
    ds_read_b128 a[232:235], v8 offset:1152
    buffer_load_dwordx4 v[216:219], v3, s[60:63], s22 offen offset:2048 sc1
    s_waitcnt lgkmcnt(4)
    v_mfma_f32_16x16x32_bf16 a[252:255], v[80:83], v[104:107], a[252:255]
    v_add_f32 v114, v114, v118
    v_add_f32 v115, v115, v119
    v_add_f32 v112, v112, v120
    v_add_f32 v113, v113, v121
    v_add_f32 v114, v114, v122
    ds_read2_b32 a[236:237], v6 offset0:32 offset1:33
    s_waitcnt lgkmcnt(4)
    v_mfma_f32_16x16x32_bf16 a[240:243], v[36:39], a[224:227], a[240:243]
    v_add_f32 v115, v115, v123
    v_cvt_pk_bf16_f32 v112, v112, v113
    v_cvt_pk_bf16_f32 v113, v114, v115
    ds_read2_b32 a[238:239], v6 offset0:34 offset1:35
    v_mfma_f32_16x16x32_bf16 a[244:247], v[40:43], a[224:227], a[244:247]
    buffer_store_dwordx2 v[112:113], v11, s[60:63], s85 offen offset:64 sc1
    ds_read_b128 v[88:91], v8 offset:640
    v_mfma_f32_16x16x32_bf16 a[248:251], v[44:47], a[224:227], a[248:251]
    ds_read2_b32 v[96:97], v7 offset0:160 offset1:161
    s_waitcnt lgkmcnt(5)
    v_mfma_f32_16x16x32_bf16 a[252:255], a[228:231], a[224:227], a[252:255]
    ds_read2_b32 v[98:99], v7 offset0:162 offset1:163
    s_waitcnt lgkmcnt(5)
    v_mfma_f32_16x16x32_bf16 a[240:243], v[40:43], a[232:235], a[240:243]
    ds_read_b128 v[84:87], v8 offset:128
    buffer_load_dwordx4 v[220:223], v3, s[60:63], s22 offen offset:3072 sc1
    v_mfma_f32_16x16x32_bf16 a[244:247], v[44:47], a[232:235], a[244:247]
    ds_read2_b32 v[92:93], v7 offset0:32 offset1:33
    v_mfma_f32_16x16x32_bf16 a[248:251], a[228:231], a[232:235], a[248:251]
    ds_read2_b32 v[94:95], v7 offset0:34 offset1:35
    s_waitcnt lgkmcnt(6)
    v_mfma_f32_16x16x32_bf16 a[252:255], a[236:239], a[232:235], a[252:255]
    ds_read_b128 v[100:103], v8 offset:1600
    s_waitcnt lgkmcnt(6)
    v_mfma_f32_16x16x32_bf16 a[240:243], v[44:47], v[88:91], a[240:243]
    ds_read2_b32 v[80:81], v6 offset0:144 offset1:145
    v_mfma_f32_16x16x32_bf16 a[244:247], a[228:231], v[88:91], a[244:247]
    ds_read2_b32 v[82:83], v6 offset0:146 offset1:147
    s_add_u32 s22, s22, 4096
    buffer_load_dwordx4 v[224:227], v3, s[60:63], s22 offen offset:0 sc1
    v_lshlrev_b32 v116, 16, v132
    v_mfma_f32_16x16x32_bf16 a[248:251], a[236:239], v[88:91], a[248:251]
    ds_read_b128 v[104:107], v8 offset:1088
    v_and_b32 v117, s69, v132
    s_waitcnt lgkmcnt(7)
    v_mfma_f32_16x16x32_bf16 a[252:255], v[96:99], v[88:91], a[252:255]
    ds_read2_b32 a[224:225], v6 offset0:16 offset1:17
    v_lshlrev_b32 v118, 16, v133
    s_waitcnt lgkmcnt(7)
    v_mfma_f32_16x16x32_bf16 a[240:243], a[228:231], v[84:87], a[240:243]
    ds_read2_b32 a[226:227], v6 offset0:18 offset1:19
    v_and_b32 v119, s69, v133
    v_mfma_f32_16x16x32_bf16 a[244:247], a[236:239], v[84:87], a[244:247]
    ds_read_b128 a[232:235], v8 offset:576
    v_lshlrev_b32 v120, 16, v134
    v_mfma_f32_16x16x32_bf16 a[248:251], v[96:99], v[84:87], a[248:251]
    ds_read2_b32 v[88:89], v7 offset0:144 offset1:145
    v_and_b32 v121, s69, v134
    s_waitcnt lgkmcnt(8)
    v_mfma_f32_16x16x32_bf16 a[252:255], v[92:95], v[84:87], a[252:255]
    ds_read2_b32 v[90:91], v7 offset0:146 offset1:147
    buffer_load_dwordx4 v[228:231], v3, s[60:63], s22 offen offset:1024 sc1
    v_lshlrev_b32 v122, 16, v135
    s_waitcnt lgkmcnt(8)
    v_mfma_f32_16x16x32_bf16 a[240:243], v[52:55], v[100:103], a[240:243]
    ds_read_b128 a[228:231], v8 offset:64
    v_and_b32 v123, s69, v135
    v_mfma_f32_16x16x32_bf16 a[244:247], v[56:59], v[100:103], a[244:247]
    ds_read2_b32 a[236:237], v7 offset0:16 offset1:17
    v_fma_f32 v136, v116, v125, v124
    v_mfma_f32_16x16x32_bf16 a[248:251], v[60:63], v[100:103], a[248:251]
    ds_read2_b32 a[238:239], v7 offset0:18 offset1:19
    v_fma_f32 v137, v117, v127, v126
    s_waitcnt lgkmcnt(9)
    v_mfma_f32_16x16x32_bf16 a[252:255], v[80:83], v[100:103], a[252:255]
    ds_read_b128 v[96:99], v8 offset:1536
    v_fma_f32 v138, v118, v129, v128
    s_waitcnt lgkmcnt(9)
    v_mfma_f32_16x16x32_bf16 a[240:243], v[56:59], v[104:107], a[240:243]
    ds_read2_b32 v[92:93], v6 offset0:128 offset1:129
    buffer_load_dwordx4 v[232:235], v3, s[60:63], s22 offen offset:2048 sc1
    v_fma_f32 v139, v119, v131, v130
    v_mfma_f32_16x16x32_bf16 a[244:247], v[60:63], v[104:107], a[244:247]
    ds_read2_b32 v[94:95], v6 offset0:130 offset1:131
    v_cvt_pk_bf16_f32 v132, v136, v137
    v_mfma_f32_16x16x32_bf16 a[248:251], v[80:83], v[104:107], a[248:251]
    ds_read_b128 v[84:87], v8 offset:1024
    v_cvt_pk_bf16_f32 v133, v138, v139
    s_waitcnt lgkmcnt(10)
    v_mfma_f32_16x16x32_bf16 a[252:255], a[224:227], v[104:107], a[252:255]
    ds_read2_b32 v[100:101], v6 offset0:0 offset1:1
    s_waitcnt lgkmcnt(10)
    v_mfma_f32_16x16x32_bf16 a[240:243], v[60:63], a[232:235], a[240:243]
    ds_read2_b32 v[102:103], v6 offset0:2 offset1:3
    v_mfma_f32_16x16x32_bf16 a[244:247], v[80:83], a[232:235], a[244:247]
    ds_read_b128 v[104:107], v8 offset:512
    v_mfma_f32_16x16x32_bf16 a[248:251], a[224:227], a[232:235], a[248:251]
    buffer_load_dwordx4 v[236:239], v3, s[60:63], s22 offen offset:3072 sc1
    s_waitcnt lgkmcnt(10)
    v_mfma_f32_16x16x32_bf16 a[252:255], v[88:91], a[232:235], a[252:255]
    ds_read2_b32 a[232:233], v7 offset0:128 offset1:129
    s_waitcnt lgkmcnt(10)
    v_mfma_f32_16x16x32_bf16 a[240:243], v[80:83], a[228:231], a[240:243]
    ds_read2_b32 a[234:235], v7 offset0:130 offset1:131
    v_mfma_f32_16x16x32_bf16 a[244:247], a[224:227], a[228:231], a[244:247]
    ds_read_b128 v[80:83], v8 offset:0
    v_mfma_f32_16x16x32_bf16 a[248:251], v[88:91], a[228:231], a[248:251]
    ds_read2_b32 a[224:225], v7 offset0:0 offset1:1
    s_waitcnt lgkmcnt(11)
    v_mfma_f32_16x16x32_bf16 a[252:255], a[236:239], a[228:231], a[252:255]
    ds_read2_b32 a[226:227], v7 offset0:2 offset1:3
    s_add_u32 s22, s22, 4096
    buffer_load_dwordx4 v[240:243], v3, s[60:63], s22 offen offset:0 sc1
    s_waitcnt lgkmcnt(11)
    v_mfma_f32_16x16x32_bf16 a[240:243], v[68:71], v[96:99], a[240:243]
    ds_write_b64 v12, v[132:133] offset:2048
    v_mfma_f32_16x16x32_bf16 a[244:247], v[72:75], v[96:99], a[244:247]
    v_fma_f32 v140, v120, v125, v124
    v_mfma_f32_16x16x32_bf16 a[248:251], v[76:79], v[96:99], a[248:251]
    v_fma_f32 v141, v121, v127, v126
    s_waitcnt lgkmcnt(10)
    v_mfma_f32_16x16x32_bf16 a[252:255], v[92:95], v[96:99], a[252:255]
    v_fma_f32 v142, v122, v129, v128
    s_waitcnt lgkmcnt(9)
    v_mfma_f32_16x16x32_bf16 a[240:243], v[72:75], v[84:87], a[240:243]
    v_fma_f32 v143, v123, v131, v130
    v_mfma_f32_16x16x32_bf16 a[244:247], v[76:79], v[84:87], a[244:247]
    buffer_load_dwordx4 v[244:247], v3, s[60:63], s22 offen offset:1024 sc1
    v_cvt_pk_bf16_f32 v134, v140, v141
    v_mfma_f32_16x16x32_bf16 a[248:251], v[92:95], v[84:87], a[248:251]
    v_cvt_pk_bf16_f32 v135, v142, v143
    s_waitcnt lgkmcnt(7)
    v_mfma_f32_16x16x32_bf16 a[252:255], v[100:103], v[84:87], a[252:255]
    ds_write_b64 v12, v[134:135] offset:6656
    s_waitcnt lgkmcnt(7)
    v_mfma_f32_16x16x32_bf16 a[240:243], v[76:79], v[104:107], a[240:243]
    v_mfma_f32_16x16x32_bf16 a[244:247], v[92:95], v[104:107], a[244:247]
    v_mfma_f32_16x16x32_bf16 a[248:251], v[100:103], v[104:107], a[248:251]
    buffer_load_dwordx4 v[248:251], v3, s[60:63], s22 offen offset:2048 sc1
    s_waitcnt lgkmcnt(0)
    s_barrier
    v_mfma_f32_16x16x32_bf16 a[252:255], a[232:235], v[104:107], a[252:255]
    ds_read_b128 v[88:91], v8 offset:2240
    v_fmac_f32 v116, s44, v136
    v_mfma_f32_16x16x32_bf16 a[240:243], v[92:95], v[80:83], a[240:243]
    ds_read_b128 a[236:239], v8 offset:2752
    v_fmac_f32 v117, s44, v137
    v_mfma_f32_16x16x32_bf16 a[244:247], v[100:103], v[80:83], a[244:247]
    ds_read_b128 a[228:231], v8 offset:3264
    v_fmac_f32 v118, s44, v138
    v_mfma_f32_16x16x32_bf16 a[248:251], a[232:235], v[80:83], a[248:251]
    ds_read_b128 v[96:99], v8 offset:3776
    v_fmac_f32 v119, s44, v139
    v_mfma_f32_16x16x32_bf16 a[252:255], a[224:227], v[80:83], a[252:255]
    ds_read_b128 v[84:87], v8 offset:2176
    v_fmac_f32 v120, s45, v140
    s_waitcnt lgkmcnt(4)
    v_mfma_f32_16x16x32_bf16 a[240:243], v[16:19], v[88:91], a[240:243]
    ds_read_b128 v[104:107], v8 offset:2688
    buffer_load_dwordx4 v[252:255], v3, s[60:63], s22 offen offset:3072 sc1
    s_waitcnt lgkmcnt(4)
    v_mfma_f32_16x16x32_bf16 a[244:247], v[16:19], a[236:239], a[244:247]
    ds_read_b128 v[92:95], v8 offset:3200
    v_fmac_f32 v121, s45, v141
    v_mfma_f32_16x16x32_bf16 a[244:247], v[20:23], v[88:91], a[244:247]
    ds_read_b128 v[100:103], v8 offset:3712
    v_fmac_f32 v122, s45, v142
    s_waitcnt lgkmcnt(5)
    v_mfma_f32_16x16x32_bf16 a[248:251], v[16:19], a[228:231], a[248:251]
    ds_read_b128 a[232:235], v8 offset:2112
    v_fmac_f32 v123, s45, v143
    v_mfma_f32_16x16x32_bf16 a[248:251], v[20:23], a[236:239], a[248:251]
    ds_read_b128 a[224:227], v8 offset:2624
    v_mfma_f32_16x16x32_bf16 a[248:251], v[24:27], v[88:91], a[248:251]
    ds_read_b128 v[80:83], v8 offset:3136
    buffer_load_dwordx4 a[0:3], v3, s[60:63], s23 offen offset:0 sc1
    s_waitcnt lgkmcnt(7)
    v_mfma_f32_16x16x32_bf16 a[252:255], v[16:19], v[96:99], a[252:255]
    ds_read_b128 v[96:99], v8 offset:3648
    v_mfma_f32_16x16x32_bf16 a[252:255], v[20:23], a[228:231], a[252:255]
    ds_read_b128 a[228:231], v8 offset:2048
    v_mfma_f32_16x16x32_bf16 a[252:255], v[24:27], a[236:239], a[252:255]
    ds_read_b128 a[236:239], v8 offset:2560
    v_mfma_f32_16x16x32_bf16 a[252:255], v[28:31], v[88:91], a[252:255]
    ds_read_b128 v[88:91], v8 offset:3072
    s_waitcnt lgkmcnt(10)
    v_mfma_f32_16x16x32_bf16 a[240:243], v[32:35], v[84:87], a[240:243]
    s_waitcnt lgkmcnt(9)
    v_mfma_f32_16x16x32_bf16 a[244:247], v[32:35], v[104:107], a[244:247]
    buffer_load_dwordx4 a[4:7], v3, s[60:63], s23 offen offset:1024 sc1
    v_mfma_f32_16x16x32_bf16 a[244:247], v[36:39], v[84:87], a[244:247]
    s_waitcnt lgkmcnt(8)
    v_mfma_f32_16x16x32_bf16 a[248:251], v[32:35], v[92:95], a[248:251]
    v_mfma_f32_16x16x32_bf16 a[248:251], v[36:39], v[104:107], a[248:251]
    v_mfma_f32_16x16x32_bf16 a[248:251], v[40:43], v[84:87], a[248:251]
    s_waitcnt lgkmcnt(7)
    v_mfma_f32_16x16x32_bf16 a[252:255], v[32:35], v[100:103], a[252:255]
    ds_read_b128 v[100:103], v8 offset:3584
    buffer_load_dwordx4 a[8:11], v3, s[60:63], s23 offen offset:2048 sc1
    v_mfma_f32_16x16x32_bf16 a[252:255], v[36:39], v[92:95], a[252:255]
    v_mfma_f32_16x16x32_bf16 a[252:255], v[40:43], v[104:107], a[252:255]
    v_mfma_f32_16x16x32_bf16 a[252:255], v[44:47], v[84:87], a[252:255]
    s_waitcnt lgkmcnt(7)
    v_mfma_f32_16x16x32_bf16 a[240:243], v[48:51], a[232:235], a[240:243]
    s_waitcnt lgkmcnt(6)
    v_mfma_f32_16x16x32_bf16 a[244:247], v[48:51], a[224:227], a[244:247]
    buffer_load_dwordx4 a[12:15], v3, s[60:63], s23 offen offset:3072 sc1
    v_mfma_f32_16x16x32_bf16 a[244:247], v[52:55], a[232:235], a[244:247]
    s_add_u32 s80, s64, 16777216
    s_waitcnt lgkmcnt(5)
    v_mfma_f32_16x16x32_bf16 a[248:251], v[48:51], v[80:83], a[248:251]
    s_add_u32 s81, s65, 16777216
    v_mfma_f32_16x16x32_bf16 a[248:251], v[52:55], a[224:227], a[248:251]
    s_add_u32 s82, s64, 20709376
    v_mfma_f32_16x16x32_bf16 a[248:251], v[56:59], a[232:235], a[248:251]
    s_add_u32 s83, s65, 20709376
    s_waitcnt lgkmcnt(4)
    v_mfma_f32_16x16x32_bf16 a[252:255], v[48:51], v[96:99], a[252:255]
    s_add_u32 s74, s66, 16777216
    v_mfma_f32_16x16x32_bf16 a[252:255], v[52:55], v[80:83], a[252:255]
    s_add_u32 s75, s67, 16777216
    s_add_u32 s23, s23, 4096
    buffer_load_dwordx4 a[16:19], v3, s[60:63], s23 offen offset:0 sc1
    v_mfma_f32_16x16x32_bf16 a[252:255], v[56:59], a[224:227], a[252:255]
    s_add_u32 s86, s66, 20709376
    v_mfma_f32_16x16x32_bf16 a[252:255], v[60:63], a[232:235], a[252:255]
    s_add_u32 s87, s67, 20709376
    s_waitcnt lgkmcnt(3)
    v_mfma_f32_16x16x32_bf16 a[240:243], v[64:67], a[228:231], a[240:243]
    v_bfe_u32 v128, v1, 1, 3
    s_waitcnt lgkmcnt(2)
    v_mfma_f32_16x16x32_bf16 a[244:247], v[64:67], a[236:239], a[244:247]
    v_lshl_add_u32 v128, v128, 2, s68
    v_mfma_f32_16x16x32_bf16 a[244:247], v[68:71], a[228:231], a[244:247]
    v_lshl_add_u32 v132, v1, 6, v128
    buffer_load_dwordx4 a[20:23], v3, s[60:63], s23 offen offset:1024 sc1
    s_waitcnt lgkmcnt(1)
    v_mfma_f32_16x16x32_bf16 a[248:251], v[64:67], v[88:91], a[248:251]
    v_min_u32 v133, 47, v1
    v_mfma_f32_16x16x32_bf16 a[248:251], v[68:71], a[236:239], a[248:251]
    ds_write_b128 v9, a[240:243] offset:0
    v_lshl_add_u32 v133, v133, 6, v128
    v_mfma_f32_16x16x32_bf16 a[248:251], v[72:75], a[228:231], a[248:251]
    v_add_u32 v133, 4096, v133
    s_waitcnt lgkmcnt(1)
    v_mfma_f32_16x16x32_bf16 a[252:255], v[64:67], v[100:103], a[252:255]
    ds_write_b128 v9, a[244:247] offset:256
    v_mfma_f32_16x16x32_bf16 a[252:255], v[68:71], v[88:91], a[252:255]
    v_mfma_f32_16x16x32_bf16 a[252:255], v[72:75], a[236:239], a[252:255]
    buffer_load_dwordx4 a[24:27], v3, s[60:63], s23 offen offset:2048 sc1
    v_mfma_f32_16x16x32_bf16 a[252:255], v[76:79], a[228:231], a[252:255]
    ds_write_b128 v9, a[248:251] offset:512
    s_nop 6
    ds_write_b128 v9, a[252:255] offset:768
    s_waitcnt lgkmcnt(0)
    s_barrier
    s_mov_b32 s85, 4071424
    ds_read_b128 v[80:83], v10 offset:0
    ds_read_b128 v[84:87], v10 offset:4352
    ds_read_b128 v[88:91], v10 offset:8704
    ds_read_b128 v[92:95], v10 offset:13056
    s_waitcnt lgkmcnt(3)
    v_pk_add_f32 v[116:117], v[116:117], v[80:81]
    v_pk_add_f32 v[118:119], v[118:119], v[82:83]
    s_waitcnt lgkmcnt(2)
    v_pk_add_f32 v[116:117], v[116:117], v[84:85]
    v_pk_add_f32 v[118:119], v[118:119], v[86:87]
    v_cvt_pk_bf16_f32 v116, v116, v117
    v_cvt_pk_bf16_f32 v117, v118, v119
    buffer_store_dwordx2 v[116:117], v11, s[60:63], s85 offen offset:0 sc1
    s_waitcnt lgkmcnt(1)
    v_pk_add_f32 v[120:121], v[120:121], v[88:89]
    v_pk_add_f32 v[122:123], v[122:123], v[90:91]
    s_waitcnt lgkmcnt(0)
    v_pk_add_f32 v[120:121], v[120:121], v[92:93]
    v_pk_add_f32 v[122:123], v[122:123], v[94:95]
    v_cvt_pk_bf16_f32 v120, v120, v121
    v_cvt_pk_bf16_f32 v121, v122, v123
    buffer_store_dwordx2 v[120:121], v11, s[60:63], s85 offen offset:64 sc1
    v_mov_b32 v16, 0
    v_mov_b32 v17, 0
    v_bfe_u32 v28, v1, 2, 1
    v_lshrrev_b32 v29, 5, v1
    v_and_b32 v30, 1, v1
    v_lshlrev_b32 v30, 4, v30
    v_mov_b32 v31, 0x3f80
    v_lshlrev_b32 v31, v30, v31
    v_cmp_eq_u32 vcc, v28, v29
    v_bfe_u32 v28, v1, 3, 2
    v_bfe_u32 v29, v1, 1, 1
    v_cndmask_b32 v31, 0, v31, vcc
    v_lshl_add_u32 v28, v28, 1, v29
    v_cmp_eq_u32 s[94:95], 0, v28
    v_cmp_eq_u32 s[92:93], 1, v28
    s_nop 0
    v_cndmask_b32 v20, 0, v31, s[94:95]
    v_cmp_eq_u32 s[94:95], 2, v28
    v_cndmask_b32 v21, 0, v31, s[92:93]
    v_cmp_eq_u32 s[92:93], 3, v28
    v_cndmask_b32 v22, 0, v31, s[94:95]
    v_cmp_eq_u32 s[94:95], 4, v28
    v_cndmask_b32 v23, 0, v31, s[92:93]
    v_cmp_eq_u32 s[92:93], 5, v28
    v_cndmask_b32 v24, 0, v31, s[94:95]
    v_cmp_eq_u32 s[94:95], 6, v28
    v_cndmask_b32 v25, 0, v31, s[92:93]
    v_cmp_eq_u32 s[92:93], 7, v28
    v_cndmask_b32 v26, 0, v31, s[94:95]
    s_nop 0
    v_cndmask_b32 v27, 0, v31, s[92:93]
    v_dot2c_f32_bf16 v16, s73, v144
    v_dot2c_f32_bf16 v17, s73, v145
    v_dot2c_f32_bf16 v16, s73, v146
    v_dot2c_f32_bf16 v17, s73, v147
    s_add_u32 m0, s68, 0
    s_xor_b32 s76, s78, 0
    s_mul_i32 s76, s76, 28928
    s_add_u32 s76, s76, s68
    s_add_u32 s76, s76, 3145728
    buffer_load_dwordx4 a[28:31], v3, s[60:63], s23 offen offset:3072 sc1
    v_dot2c_f32_bf16 v16, s73, v148
    v_dot2c_f32_bf16 v17, s73, v149
    v_dot2c_f32_bf16 v16, s73, v150
    v_dot2c_f32_bf16 v17, s73, v151
    buffer_load_dwordx4 v3, s[60:63], s76 offen offset:0 sc1 lds
    v_dot2c_f32_bf16 v16, s73, v152
    v_dot2c_f32_bf16 v17, s73, v153
    v_dot2c_f32_bf16 v16, s73, v154
    v_dot2c_f32_bf16 v17, s73, v155
    v_dot2c_f32_bf16 v16, s73, v156
    v_dot2c_f32_bf16 v17, s73, v157
    v_dot2c_f32_bf16 v16, s73, v158
    v_dot2c_f32_bf16 v17, s73, v159
    s_add_u32 s23, s23, 4096
    buffer_load_dwordx4 a[32:35], v3, s[60:63], s23 offen offset:0 sc1
    v_dot2c_f32_bf16 v16, s73, v160
    v_dot2c_f32_bf16 v17, s73, v161
    v_dot2c_f32_bf16 v16, s73, v162
    v_dot2c_f32_bf16 v17, s73, v163
    v_dot2c_f32_bf16 v16, s73, v164
    v_dot2c_f32_bf16 v17, s73, v165
    v_dot2c_f32_bf16 v16, s73, v166
    v_dot2c_f32_bf16 v17, s73, v167
    v_dot2c_f32_bf16 v16, s73, v168
    v_dot2c_f32_bf16 v17, s73, v169
    v_dot2c_f32_bf16 v16, s73, v170
    v_dot2c_f32_bf16 v17, s73, v171
    v_dot2c_f32_bf16 v16, s73, v172
    v_dot2c_f32_bf16 v17, s73, v173
    v_dot2c_f32_bf16 v16, s73, v174
    v_dot2c_f32_bf16 v17, s73, v175
    buffer_load_dwordx4 v3, s[60:63], s76 offen offset:1024 sc1 lds
    s_waitcnt vmcnt(31)
    v_dot2c_f32_bf16 v16, s73, v176
    v_dot2c_f32_bf16 v17, s73, v177
    v_dot2c_f32_bf16 v16, s73, v178
    v_dot2c_f32_bf16 v17, s73, v179
    v_dot2c_f32_bf16 v16, s73, v180
    v_dot2c_f32_bf16 v17, s73, v181
    v_dot2c_f32_bf16 v16, s73, v182
    v_dot2c_f32_bf16 v17, s73, v183
    v_dot2c_f32_bf16 v16, s73, v184
    v_dot2c_f32_bf16 v17, s73, v185
    v_dot2c_f32_bf16 v16, s73, v186
    v_dot2c_f32_bf16 v17, s73, v187
    v_dot2c_f32_bf16 v16, s73, v188
    v_dot2c_f32_bf16 v17, s73, v189
    v_dot2c_f32_bf16 v16, s73, v190
    v_dot2c_f32_bf16 v17, s73, v191
    buffer_load_dwordx4 a[36:39], v3, s[60:63], s23 offen offset:1024 sc1
    s_waitcnt vmcnt(28)
    v_dot2c_f32_bf16 v16, s73, v192
    v_dot2c_f32_bf16 v17, s73, v193
    v_dot2c_f32_bf16 v16, s73, v194
    v_dot2c_f32_bf16 v17, s73, v195
    v_dot2c_f32_bf16 v16, s73, v196
    v_dot2c_f32_bf16 v17, s73, v197
    v_dot2c_f32_bf16 v16, s73, v198
    v_dot2c_f32_bf16 v17, s73, v199
    v_dot2c_f32_bf16 v16, s73, v200
    v_dot2c_f32_bf16 v17, s73, v201
    v_dot2c_f32_bf16 v16, s73, v202
    v_dot2c_f32_bf16 v17, s73, v203
    v_dot2c_f32_bf16 v16, s73, v204
    v_dot2c_f32_bf16 v17, s73, v205
    v_dot2c_f32_bf16 v16, s73, v206
    v_dot2c_f32_bf16 v17, s73, v207
    buffer_load_dwordx4 v3, s[60:63], s76 offen offset:2048 sc1 lds
    s_waitcnt vmcnt(23)
    v_dot2c_f32_bf16 v16, s73, v208
    v_dot2c_f32_bf16 v17, s73, v209
    v_dot2c_f32_bf16 v16, s73, v210
    v_dot2c_f32_bf16 v17, s73, v211
    v_dot2c_f32_bf16 v16, s73, v212
    v_dot2c_f32_bf16 v17, s73, v213
    v_dot2c_f32_bf16 v16, s73, v214
    v_dot2c_f32_bf16 v17, s73, v215
    v_dot2c_f32_bf16 v16, s73, v216
    v_dot2c_f32_bf16 v17, s73, v217
    v_dot2c_f32_bf16 v16, s73, v218
    v_dot2c_f32_bf16 v17, s73, v219
    v_dot2c_f32_bf16 v16, s73, v220
    v_dot2c_f32_bf16 v17, s73, v221
    v_dot2c_f32_bf16 v16, s73, v222
    v_dot2c_f32_bf16 v17, s73, v223
    buffer_load_dwordx4 a[40:43], v3, s[60:63], s23 offen offset:2048 sc1
    s_waitcnt vmcnt(20)
    v_dot2c_f32_bf16 v16, s73, v224
    v_dot2c_f32_bf16 v17, s73, v225
    v_dot2c_f32_bf16 v16, s73, v226
    v_dot2c_f32_bf16 v17, s73, v227
    v_dot2c_f32_bf16 v16, s73, v228
    v_dot2c_f32_bf16 v17, s73, v229
    v_dot2c_f32_bf16 v16, s73, v230
    v_dot2c_f32_bf16 v17, s73, v231
    v_dot2c_f32_bf16 v16, s73, v232
    v_dot2c_f32_bf16 v17, s73, v233
    v_dot2c_f32_bf16 v16, s73, v234
    v_dot2c_f32_bf16 v17, s73, v235
    buffer_load_dwordx4 v3, s[60:63], s76 offen offset:3072 sc1 lds
    v_dot2c_f32_bf16 v16, s73, v236
    v_dot2c_f32_bf16 v17, s73, v237
    v_dot2c_f32_bf16 v16, s73, v238
    v_dot2c_f32_bf16 v17, s73, v239
    s_add_u32 m0, s68, 4096
    s_add_u32 s76, s76, 4096
    s_waitcnt vmcnt(17)
    v_dot2c_f32_bf16 v16, s73, v240
    v_dot2c_f32_bf16 v17, s73, v241
    v_dot2c_f32_bf16 v16, s73, v242
    v_dot2c_f32_bf16 v17, s73, v243
    v_dot2c_f32_bf16 v16, s73, v244
    v_dot2c_f32_bf16 v17, s73, v245
    v_dot2c_f32_bf16 v16, s73, v246
    v_dot2c_f32_bf16 v17, s73, v247
    v_dot2c_f32_bf16 v16, s73, v248
    v_dot2c_f32_bf16 v17, s73, v249
    v_dot2c_f32_bf16 v16, s73, v250
    v_dot2c_f32_bf16 v17, s73, v251
    buffer_load_dwordx4 a[44:47], v3, s[60:63], s23 offen offset:3072 sc1
    v_dot2c_f32_bf16 v16, s73, v252
    v_dot2c_f32_bf16 v17, s73, v253
    v_dot2c_f32_bf16 v16, s73, v254
    v_dot2c_f32_bf16 v17, s73, v255
    s_nop 2
    v_add_f32 v16, v16, v17
    v_mov_b32 v17, v16
    s_nop 1
    v_permlane32_swap_b32 v16, v17
    v_add_f32 v16, v16, v17
    v_mul_f32 v32, 0xbb124925, v16
    v_mov_b32 v33, v32
    v_mov_b64 v[34:35], v[32:33]
    v_mov_b64 v[36:37], v[32:33]
    v_mov_b64 v[38:39], v[32:33]
    v_mov_b64 v[40:41], v[32:33]
    v_mov_b64 v[42:43], v[32:33]
    v_mov_b64 v[44:45], v[32:33]
    v_mov_b64 v[46:47], v[32:33]
    buffer_load_dwordx4 v3, s[60:63], s76 offen offset:0 sc1 lds
    s_nop 0
    v_mfma_f32_32x32x16_bf16 v[48:63], v[20:23], v[144:147], v[32:47]
    s_add_u32 s23, s23, 4096
    buffer_load_dwordx4 a[48:51], v3, s[60:63], s23 offen offset:0 sc1
    v_mfma_f32_32x32x16_bf16 v[48:63], v[24:27], v[148:151], v[48:63]
    s_nop 2
    v_mfma_f32_32x32x16_bf16 v[64:79], v[20:23], v[152:155], v[32:47]
    s_nop 2
    buffer_load_dwordx4 v3, s[60:63], s76 offen offset:1024 sc1 lds
    v_mfma_f32_32x32x16_bf16 v[64:79], v[24:27], v[156:159], v[64:79]
    s_nop 2
    v_mfma_f32_32x32x16_bf16 v[80:95], v[20:23], v[160:163], v[32:47]
    buffer_load_dwordx4 a[52:55], v3, s[60:63], s23 offen offset:1024 sc1
    v_cvt_pk_bf16_f32 v144, v48, v49
    v_cvt_pk_bf16_f32 v145, v50, v51
    v_cvt_pk_bf16_f32 v146, v52, v53
    v_cvt_pk_bf16_f32 v147, v54, v55
    v_mfma_f32_32x32x16_bf16 v[80:95], v[24:27], v[164:167], v[80:95]
    v_cvt_pk_bf16_f32 v148, v56, v57
    v_cvt_pk_bf16_f32 v149, v58, v59
    v_cvt_pk_bf16_f32 v150, v60, v61
    v_cvt_pk_bf16_f32 v151, v62, v63
    v_mfma_f32_32x32x16_bf16 v[48:63], v[20:23], v[168:171], v[32:47]
    buffer_load_dwordx4 v3, s[60:63], s76 offen offset:2048 sc1 lds
    v_cvt_pk_bf16_f32 v152, v64, v65
    v_cvt_pk_bf16_f32 v153, v66, v67
    v_cvt_pk_bf16_f32 v154, v68, v69
    v_cvt_pk_bf16_f32 v155, v70, v71
    v_mfma_f32_32x32x16_bf16 v[48:63], v[24:27], v[172:175], v[48:63]
    s_add_u32 m0, s68, 28672
    s_xor_b32 s76, s78, 1
    s_mul_i32 s76, s76, 28928
    s_add_u32 s76, s76, s68
    s_add_u32 s76, s76, 3145728
    v_cvt_pk_bf16_f32 v156, v72, v73
    v_cvt_pk_bf16_f32 v157, v74, v75
    v_cvt_pk_bf16_f32 v158, v76, v77
    v_cvt_pk_bf16_f32 v159, v78, v79
    v_mfma_f32_32x32x16_bf16 v[64:79], v[20:23], v[176:179], v[32:47]
    buffer_load_dwordx4 a[56:59], v3, s[60:63], s23 offen offset:2048 sc1
    v_cvt_pk_bf16_f32 v160, v80, v81
    v_cvt_pk_bf16_f32 v161, v82, v83
    v_cvt_pk_bf16_f32 v162, v84, v85
    v_cvt_pk_bf16_f32 v163, v86, v87
    v_mfma_f32_32x32x16_bf16 v[64:79], v[24:27], v[180:183], v[64:79]
    v_cvt_pk_bf16_f32 v164, v88, v89
    v_cvt_pk_bf16_f32 v165, v90, v91
    v_cvt_pk_bf16_f32 v166, v92, v93
    v_cvt_pk_bf16_f32 v167, v94, v95
    v_mfma_f32_32x32x16_bf16 v[80:95], v[20:23], v[184:187], v[32:47]
    buffer_load_dwordx4 v3, s[60:63], s76 offen offset:0 sc1 lds
    v_cvt_pk_bf16_f32 v168, v48, v49
    v_cvt_pk_bf16_f32 v169, v50, v51
    v_cvt_pk_bf16_f32 v170, v52, v53
    v_cvt_pk_bf16_f32 v171, v54, v55
    v_mfma_f32_32x32x16_bf16 v[80:95], v[24:27], v[188:191], v[80:95]
    v_cvt_pk_bf16_f32 v172, v56, v57
    v_cvt_pk_bf16_f32 v173, v58, v59
    v_cvt_pk_bf16_f32 v174, v60, v61
    v_cvt_pk_bf16_f32 v175, v62, v63
    v_mfma_f32_32x32x16_bf16 v[48:63], v[20:23], v[192:195], v[32:47]
    buffer_load_dwordx4 a[60:63], v3, s[60:63], s23 offen offset:3072 sc1
    v_cvt_pk_bf16_f32 v176, v64, v65
    v_cvt_pk_bf16_f32 v177, v66, v67
    v_cvt_pk_bf16_f32 v178, v68, v69
    v_cvt_pk_bf16_f32 v179, v70, v71
    v_mfma_f32_32x32x16_bf16 v[48:63], v[24:27], v[196:199], v[48:63]
    v_cvt_pk_bf16_f32 v180, v72, v73
    v_cvt_pk_bf16_f32 v181, v74, v75
    v_cvt_pk_bf16_f32 v182, v76, v77
    v_cvt_pk_bf16_f32 v183, v78, v79
    v_mfma_f32_32x32x16_bf16 v[64:79], v[20:23], v[200:203], v[32:47]
    buffer_load_dwordx4 v3, s[60:63], s76 offen offset:1024 sc1 lds
    v_cvt_pk_bf16_f32 v184, v80, v81
    v_cvt_pk_bf16_f32 v185, v82, v83
    v_cvt_pk_bf16_f32 v186, v84, v85
    v_cvt_pk_bf16_f32 v187, v86, v87
    v_mfma_f32_32x32x16_bf16 v[64:79], v[24:27], v[204:207], v[64:79]
    v_cvt_pk_bf16_f32 v188, v88, v89
    v_cvt_pk_bf16_f32 v189, v90, v91
    v_cvt_pk_bf16_f32 v190, v92, v93
    v_cvt_pk_bf16_f32 v191, v94, v95
    v_mfma_f32_32x32x16_bf16 v[80:95], v[20:23], v[208:211], v[32:47]
    s_add_u32 s23, s23, 4096
    buffer_load_dwordx4 a[64:67], v3, s[60:63], s23 offen offset:0 sc1
    v_cvt_pk_bf16_f32 v192, v48, v49
    v_cvt_pk_bf16_f32 v193, v50, v51
    v_cvt_pk_bf16_f32 v194, v52, v53
    v_cvt_pk_bf16_f32 v195, v54, v55
    v_mfma_f32_32x32x16_bf16 v[80:95], v[24:27], v[212:215], v[80:95]
    v_cvt_pk_bf16_f32 v196, v56, v57
    v_cvt_pk_bf16_f32 v197, v58, v59
    v_cvt_pk_bf16_f32 v198, v60, v61
    v_cvt_pk_bf16_f32 v199, v62, v63
    v_mfma_f32_32x32x16_bf16 v[48:63], v[20:23], v[216:219], v[32:47]
    buffer_load_dwordx4 v3, s[60:63], s76 offen offset:2048 sc1 lds
    v_cvt_pk_bf16_f32 v200, v64, v65
    v_cvt_pk_bf16_f32 v201, v66, v67
    v_cvt_pk_bf16_f32 v202, v68, v69
    v_cvt_pk_bf16_f32 v203, v70, v71
    v_mfma_f32_32x32x16_bf16 v[48:63], v[24:27], v[220:223], v[48:63]
    v_cvt_pk_bf16_f32 v204, v72, v73
    v_cvt_pk_bf16_f32 v205, v74, v75
    v_cvt_pk_bf16_f32 v206, v76, v77
    v_cvt_pk_bf16_f32 v207, v78, v79
    v_mfma_f32_32x32x16_bf16 v[64:79], v[20:23], v[224:227], v[32:47]
    buffer_load_dwordx4 a[68:71], v3, s[60:63], s23 offen offset:1024 sc1
    v_cvt_pk_bf16_f32 v208, v80, v81
    v_cvt_pk_bf16_f32 v209, v82, v83
    v_cvt_pk_bf16_f32 v210, v84, v85
    v_cvt_pk_bf16_f32 v211, v86, v87
    v_mfma_f32_32x32x16_bf16 v[64:79], v[24:27], v[228:231], v[64:79]
    v_cvt_pk_bf16_f32 v212, v88, v89
    v_cvt_pk_bf16_f32 v213, v90, v91
    v_cvt_pk_bf16_f32 v214, v92, v93
    v_cvt_pk_bf16_f32 v215, v94, v95
    v_mfma_f32_32x32x16_bf16 v[80:95], v[20:23], v[232:235], v[32:47]
    buffer_load_dwordx4 v3, s[60:63], s76 offen offset:3072 sc1 lds
    v_cvt_pk_bf16_f32 v216, v48, v49
    v_cvt_pk_bf16_f32 v217, v50, v51
    v_cvt_pk_bf16_f32 v218, v52, v53
    v_cvt_pk_bf16_f32 v219, v54, v55
    v_mfma_f32_32x32x16_bf16 v[80:95], v[24:27], v[236:239], v[80:95]
    s_add_u32 m0, s68, 32768
    s_add_u32 s76, s76, 4096
    v_cvt_pk_bf16_f32 v220, v56, v57
    v_cvt_pk_bf16_f32 v221, v58, v59
    v_cvt_pk_bf16_f32 v222, v60, v61
    v_cvt_pk_bf16_f32 v223, v62, v63
    v_mfma_f32_32x32x16_bf16 v[48:63], v[20:23], v[240:243], v[32:47]
    buffer_load_dwordx4 a[72:75], v3, s[60:63], s23 offen offset:2048 sc1
    v_cvt_pk_bf16_f32 v224, v64, v65
    v_cvt_pk_bf16_f32 v225, v66, v67
    v_cvt_pk_bf16_f32 v226, v68, v69
    v_cvt_pk_bf16_f32 v227, v70, v71
    v_mfma_f32_32x32x16_bf16 v[48:63], v[24:27], v[244:247], v[48:63]
    v_cvt_pk_bf16_f32 v228, v72, v73
    v_cvt_pk_bf16_f32 v229, v74, v75
    v_cvt_pk_bf16_f32 v230, v76, v77
    v_cvt_pk_bf16_f32 v231, v78, v79
    v_mfma_f32_32x32x16_bf16 v[64:79], v[20:23], v[248:251], v[32:47]
    buffer_load_dwordx4 v3, s[60:63], s76 offen offset:0 sc1 lds
    v_cvt_pk_bf16_f32 v232, v80, v81
    v_cvt_pk_bf16_f32 v233, v82, v83
    v_cvt_pk_bf16_f32 v234, v84, v85
    v_cvt_pk_bf16_f32 v235, v86, v87
    v_mfma_f32_32x32x16_bf16 v[64:79], v[24:27], v[252:255], v[64:79]
    v_cvt_pk_bf16_f32 v236, v88, v89
    v_cvt_pk_bf16_f32 v237, v90, v91
    v_cvt_pk_bf16_f32 v238, v92, v93
    v_cvt_pk_bf16_f32 v239, v94, v95
    buffer_load_dwordx4 a[76:79], v3, s[60:63], s23 offen offset:3072 sc1
    v_cvt_pk_bf16_f32 v240, v48, v49
    v_cvt_pk_bf16_f32 v241, v50, v51
    v_cvt_pk_bf16_f32 v242, v52, v53
    v_cvt_pk_bf16_f32 v243, v54, v55
    v_cvt_pk_bf16_f32 v244, v56, v57
    v_cvt_pk_bf16_f32 v245, v58, v59
    v_cvt_pk_bf16_f32 v246, v60, v61
    v_cvt_pk_bf16_f32 v247, v62, v63
    buffer_load_dwordx4 v3, s[60:63], s76 offen offset:1024 sc1 lds
    v_cvt_pk_bf16_f32 v248, v64, v65
    v_cvt_pk_bf16_f32 v249, v66, v67
    v_cvt_pk_bf16_f32 v250, v68, v69
    v_cvt_pk_bf16_f32 v251, v70, v71
    v_cvt_pk_bf16_f32 v252, v72, v73
    v_cvt_pk_bf16_f32 v253, v74, v75
    v_cvt_pk_bf16_f32 v254, v76, v77
    v_cvt_pk_bf16_f32 v255, v78, v79
    buffer_load_dwordx4 v3, s[60:63], s76 offen offset:2048 sc1 lds
    v_add_u32 v44, 57344, v2
    s_waitcnt vmcnt(13)
    ds_read_b32 v128, v132 offset:0
    ds_read_b32 v129, v132 offset:32
    ds_read_b32 v130, v133 offset:0
    ds_read_b32 v131, v133 offset:32
    s_waitcnt lgkmcnt(0)
    v_max3_u32 v128, v128, v129, v130
    v_max_u32 v128, v128, v131
    v_cmp_eq_u32 vcc, -1, v128
    s_cbranch_vccnz L10
L11:
    s_barrier
    ds_read_b64_tr_b16 v[16:17], v2 offset:0
    ds_read_b64_tr_b16 v[18:19], v2 offset:512
    ds_read_b64_tr_b16 v[20:21], v2 offset:1024
    ds_read_b64_tr_b16 v[22:23], v2 offset:1536
    ds_read_b64_tr_b16 v[24:25], v2 offset:2048
    ds_read_b64_tr_b16 v[26:27], v2 offset:2560
    ds_read_b64_tr_b16 v[28:29], v2 offset:3072
    ds_read_b64_tr_b16 v[30:31], v2 offset:3584
    ds_read_b64_tr_b16 v[32:33], v2 offset:4096
    ds_read_b64_tr_b16 v[34:35], v2 offset:4608
    s_waitcnt lgkmcnt(6)
    v_mfma_f32_32x32x16_bf16 v[64:79], v[144:147], v[16:19], 0
    ds_read_b64_tr_b16 v[36:37], v2 offset:5120
    ds_read_b64_tr_b16 v[38:39], v2 offset:5632
    s_add_u32 m0, s68, 57344
    s_xor_b32 s76, s78, 0
    s_mul_i32 s76, s76, 28928
    v_mfma_f32_32x32x16_bf16 v[64:79], v[148:151], v[20:23], v[64:79]
    ds_read_b64_tr_b16 v[40:41], v2 offset:6144
    ds_read_b64_tr_b16 v[42:43], v2 offset:6656
    s_add_u32 s76, s76, s68
    s_add_u32 s76, s76, 4071424
    s_waitcnt lgkmcnt(6)
    v_mfma_f32_32x32x16_bf16 v[64:79], v[152:155], v[24:27], v[64:79]
    ds_read_b64_tr_b16 v[16:17], v2 offset:7168
    ds_read_b64_tr_b16 v[18:19], v2 offset:7680
    s_add_u32 s23, s23, 4096
    buffer_load_dwordx4 a[80:83], v3, s[60:63], s23 offen offset:0 sc1
    v_min_u32 v13, 6, v1
    v_mfma_f32_32x32x16_bf16 v[64:79], v[156:159], v[28:31], v[64:79]
    ds_read_b64_tr_b16 v[20:21], v2 offset:8192
    ds_read_b64_tr_b16 v[22:23], v2 offset:8704
    v_lshlrev_b32 v13, 2, v13
    v_mov_b32 v142, s38
    s_waitcnt lgkmcnt(6)
    v_mfma_f32_32x32x16_bf16 v[64:79], v[160:163], v[32:35], v[64:79]
    ds_read_b64_tr_b16 v[24:25], v2 offset:9216
    ds_read_b64_tr_b16 v[26:27], v2 offset:9728
    buffer_load_dwordx4 v3, s[60:63], s76 offen offset:0 sc1 lds
    v_mfma_f32_32x32x16_bf16 v[64:79], v[164:167], v[36:39], v[64:79]
    ds_read_b64_tr_b16 v[28:29], v2 offset:10240
    ds_read_b64_tr_b16 v[30:31], v2 offset:10752
    s_waitcnt lgkmcnt(6)
    v_mfma_f32_32x32x16_bf16 v[64:79], v[168:171], v[40:43], v[64:79]
    ds_read_b64_tr_b16 v[32:33], v2 offset:11264
    ds_read_b64_tr_b16 v[34:35], v2 offset:11776
    buffer_load_dwordx4 a[84:87], v3, s[60:63], s23 offen offset:1024 sc1
    v_mfma_f32_32x32x16_bf16 v[64:79], v[172:175], v[16:19], v[64:79]
    ds_read_b64_tr_b16 v[36:37], v2 offset:12288
    ds_read_b64_tr_b16 v[38:39], v2 offset:12800
    s_waitcnt lgkmcnt(6)
    v_mfma_f32_32x32x16_bf16 v[64:79], v[176:179], v[20:23], v[64:79]
    ds_read_b64_tr_b16 v[40:41], v2 offset:13312
    ds_read_b64_tr_b16 v[42:43], v2 offset:13824
    buffer_load_dwordx4 v3, s[60:63], s76 offen offset:1024 sc1 lds
    v_mfma_f32_32x32x16_bf16 v[64:79], v[180:183], v[24:27], v[64:79]
    ds_read_b64_tr_b16 v[16:17], v2 offset:14336
    ds_read_b64_tr_b16 v[18:19], v2 offset:14848
    s_waitcnt lgkmcnt(6)
    v_mfma_f32_32x32x16_bf16 v[64:79], v[184:187], v[28:31], v[64:79]
    ds_read_b64_tr_b16 v[20:21], v2 offset:15360
    ds_read_b64_tr_b16 v[22:23], v2 offset:15872
    buffer_load_dwordx4 a[88:91], v3, s[60:63], s23 offen offset:2048 sc1
    v_mfma_f32_32x32x16_bf16 v[64:79], v[188:191], v[32:35], v[64:79]
    ds_read_b64_tr_b16 v[24:25], v2 offset:16384
    ds_read_b64_tr_b16 v[26:27], v2 offset:16896
    s_waitcnt lgkmcnt(6)
    v_mfma_f32_32x32x16_bf16 v[64:79], v[192:195], v[36:39], v[64:79]
    ds_read_b64_tr_b16 v[28:29], v2 offset:17408
    ds_read_b64_tr_b16 v[30:31], v2 offset:17920
    buffer_load_dwordx4 v3, s[60:63], s76 offen offset:2048 sc1 lds
    v_mfma_f32_32x32x16_bf16 v[64:79], v[196:199], v[40:43], v[64:79]
    ds_read_b64_tr_b16 v[32:33], v2 offset:18432
    ds_read_b64_tr_b16 v[34:35], v2 offset:18944
    s_waitcnt lgkmcnt(6)
    v_mfma_f32_32x32x16_bf16 v[64:79], v[200:203], v[16:19], v[64:79]
    ds_read_b64_tr_b16 v[36:37], v2 offset:19456
    ds_read_b64_tr_b16 v[38:39], v2 offset:19968
    buffer_load_dwordx4 a[92:95], v3, s[60:63], s23 offen offset:3072 sc1
    v_mfma_f32_32x32x16_bf16 v[64:79], v[204:207], v[20:23], v[64:79]
    ds_read_b64_tr_b16 v[40:41], v2 offset:20480
    ds_read_b64_tr_b16 v[42:43], v2 offset:20992
    s_waitcnt lgkmcnt(6)
    v_mfma_f32_32x32x16_bf16 v[64:79], v[208:211], v[24:27], v[64:79]
    ds_read_b64_tr_b16 v[16:17], v2 offset:21504
    ds_read_b64_tr_b16 v[18:19], v2 offset:22016
    buffer_load_dwordx4 v3, s[60:63], s76 offen offset:3072 sc1 lds
    s_waitcnt vmcnt(8)
    ds_read_b32 v128, v132 offset:28672
    v_mfma_f32_32x32x16_bf16 v[64:79], v[212:215], v[28:31], v[64:79]
    ds_read_b64_tr_b16 v[20:21], v2 offset:22528
    ds_read_b64_tr_b16 v[22:23], v2 offset:23040
    s_add_u32 m0, s68, 61440
    s_add_u32 s76, s76, 4096
    s_waitcnt lgkmcnt(7)
    v_mfma_f32_32x32x16_bf16 v[64:79], v[216:219], v[32:35], v[64:79]
    ds_read_b64_tr_b16 v[24:25], v2 offset:23552
    ds_read_b64_tr_b16 v[26:27], v2 offset:24064
    s_add_u32 s23, s23, 4096
    buffer_load_dwordx4 a[96:99], v3, s[60:63], s23 offen offset:0 sc1
    ds_read_b32 v129, v132 offset:28704
    v_mfma_f32_32x32x16_bf16 v[64:79], v[220:223], v[36:39], v[64:79]
    ds_read_b64_tr_b16 v[28:29], v2 offset:24576
    ds_read_b64_tr_b16 v[30:31], v2 offset:25088
    ds_read_b32 v130, v133 offset:28672
    ds_read_b32 v131, v133 offset:28704
    s_waitcnt lgkmcnt(10)
    v_mfma_f32_32x32x16_bf16 v[64:79], v[224:227], v[40:43], v[64:79]
    ds_read_b64_tr_b16 v[32:33], v2 offset:25600
    ds_read_b64_tr_b16 v[34:35], v2 offset:26112
    buffer_load_dwordx4 v3, s[60:63], s76 offen offset:0 sc1 lds
    v_mfma_f32_32x32x16_bf16 v[64:79], v[228:231], v[16:19], v[64:79]
    ds_read_b64_tr_b16 v[36:37], v2 offset:26624
    ds_read_b64_tr_b16 v[38:39], v2 offset:27136
    s_waitcnt lgkmcnt(9)
    v_mfma_f32_32x32x16_bf16 v[64:79], v[232:235], v[20:23], v[64:79]
    ds_read_b64_tr_b16 v[40:41], v2 offset:27648
    ds_read_b64_tr_b16 v[42:43], v2 offset:28160
    buffer_load_dwordx4 a[100:103], v3, s[60:63], s23 offen offset:1024 sc1
    s_waitcnt lgkmcnt(6)
    v_max3_u32 v128, v128, v129, v130
    v_mfma_f32_32x32x16_bf16 v[64:79], v[236:239], v[24:27], v[64:79]
    v_max_u32 v128, v128, v131
    v_cmp_eq_u32 vcc, -1, v128
    s_cbranch_vccnz L12
L13:
    s_barrier
    ds_read_b64_tr_b16 v[16:17], v2 offset:28672
    ds_read_b64_tr_b16 v[18:19], v2 offset:29184
    s_waitcnt lgkmcnt(6)
    v_mfma_f32_32x32x16_bf16 v[64:79], v[240:243], v[28:31], v[64:79]
    ds_read_b64_tr_b16 v[20:21], v2 offset:29696
    ds_read_b64_tr_b16 v[22:23], v2 offset:30208
    buffer_load_dwordx4 v3, s[60:63], s76 offen offset:1024 sc1 lds
    v_mfma_f32_32x32x16_bf16 v[64:79], v[244:247], v[32:35], v[64:79]
    ds_read_b64_tr_b16 v[24:25], v2 offset:30720
    ds_read_b64_tr_b16 v[26:27], v2 offset:31232
    s_waitcnt lgkmcnt(6)
    v_mfma_f32_32x32x16_bf16 v[64:79], v[248:251], v[36:39], v[64:79]
    ds_read_b64_tr_b16 v[28:29], v2 offset:31744
    ds_read_b64_tr_b16 v[30:31], v2 offset:32256
    buffer_load_dwordx4 a[104:107], v3, s[60:63], s23 offen offset:2048 sc1
    v_mfma_f32_32x32x16_bf16 v[64:79], v[252:255], v[40:43], v[64:79]
    ds_read_b64_tr_b16 v[32:33], v2 offset:32768
    ds_read_b64_tr_b16 v[34:35], v2 offset:33280
    s_waitcnt lgkmcnt(6)
    v_mfma_f32_32x32x16_bf16 v[48:63], v[144:147], v[16:19], 0
    ds_read_b64_tr_b16 v[36:37], v2 offset:33792
    ds_read_b64_tr_b16 v[38:39], v2 offset:34304
    buffer_load_dwordx4 v3, s[60:63], s76 offen offset:2048 sc1 lds
    v_mfma_f32_32x32x16_bf16 v[48:63], v[148:151], v[20:23], v[48:63]
    ds_read_b64_tr_b16 v[40:41], v2 offset:34816
    ds_read_b64_tr_b16 v[42:43], v2 offset:35328
    s_add_u32 m0, s68, 86016
    s_xor_b32 s76, s78, 1
    s_waitcnt lgkmcnt(6)
    v_mfma_f32_32x32x16_bf16 v[48:63], v[152:155], v[24:27], v[48:63]
    ds_read_b64_tr_b16 v[16:17], v2 offset:35840
    ds_read_b64_tr_b16 v[18:19], v2 offset:36352
    s_mul_i32 s76, s76, 28928
    s_add_u32 s76, s76, s68
    s_add_u32 s76, s76, 4071424
    v_mfma_f32_32x32x16_bf16 v[48:63], v[156:159], v[28:31], v[48:63]
    ds_read_b64_tr_b16 v[20:21], v2 offset:36864
    ds_read_b64_tr_b16 v[22:23], v2 offset:37376
    buffer_load_dwordx4 v3, s[60:63], s76 offen offset:0 sc1 lds
    v_cvt_pk_bf16_f32 v120, v64, v65
    s_waitcnt lgkmcnt(6)
    v_mfma_f32_32x32x16_bf16 v[48:63], v[160:163], v[32:35], v[48:63]
    ds_read_b64_tr_b16 v[24:25], v2 offset:37888
    ds_read_b64_tr_b16 v[26:27], v2 offset:38400
    buffer_load_dwordx4 v3, s[60:63], s76 offen offset:1024 sc1 lds
    v_cvt_pk_bf16_f32 v121, v66, v67
    v_cvt_pk_bf16_f32 v122, v68, v69
    v_mfma_f32_32x32x16_bf16 v[48:63], v[164:167], v[36:39], v[48:63]
    ds_read_b64_tr_b16 v[28:29], v2 offset:38912
    ds_read_b64_tr_b16 v[30:31], v2 offset:39424
    v_cvt_pk_bf16_f32 v123, v70, v71
    v_cvt_pk_bf16_f32 v124, v72, v73
    s_waitcnt lgkmcnt(6)
    v_mfma_f32_32x32x16_bf16 v[48:63], v[168:171], v[40:43], v[48:63]
    ds_read_b64_tr_b16 v[32:33], v2 offset:39936
    ds_read_b64_tr_b16 v[34:35], v2 offset:40448
    buffer_load_dwordx4 v3, s[60:63], s76 offen offset:2048 sc1 lds
    v_cvt_pk_bf16_f32 v125, v74, v75
    v_cvt_pk_bf16_f32 v126, v76, v77
    v_mfma_f32_32x32x16_bf16 v[48:63], v[172:175], v[16:19], v[48:63]
    ds_read_b64_tr_b16 v[36:37], v2 offset:40960
    ds_read_b64_tr_b16 v[38:39], v2 offset:41472
    v_cvt_pk_bf16_f32 v127, v78, v79
    v_pk_max_i16 v120, v120, 0
    s_waitcnt lgkmcnt(6)
    v_mfma_f32_32x32x16_bf16 v[48:63], v[176:179], v[20:23], v[48:63]
    ds_read_b64_tr_b16 v[40:41], v2 offset:41984
    ds_read_b64_tr_b16 v[42:43], v2 offset:42496
    buffer_load_dwordx4 v3, s[60:63], s76 offen offset:3072 sc1 lds
    v_pk_max_i16 v121, v121, 0
    v_pk_max_i16 v122, v122, 0
    v_mfma_f32_32x32x16_bf16 v[48:63], v[180:183], v[24:27], v[48:63]
    ds_read_b64_tr_b16 v[16:17], v2 offset:43008
    ds_read_b64_tr_b16 v[18:19], v2 offset:43520
    s_add_u32 m0, s68, 90112
    s_add_u32 s76, s76, 4096
    s_waitcnt lgkmcnt(6)
    v_mfma_f32_32x32x16_bf16 v[48:63], v[184:187], v[28:31], v[48:63]
    ds_read_b64_tr_b16 v[20:21], v2 offset:44032
    ds_read_b64_tr_b16 v[22:23], v2 offset:44544
    buffer_load_dwordx4 v3, s[60:63], s76 offen offset:0 sc1 lds
    v_pk_max_i16 v123, v123, 0
    v_pk_max_i16 v124, v124, 0
    v_mfma_f32_32x32x16_bf16 v[48:63], v[188:191], v[32:35], v[48:63]
    ds_read_b64_tr_b16 v[24:25], v2 offset:45056
    ds_read_b64_tr_b16 v[26:27], v2 offset:45568
    v_pk_max_i16 v125, v125, 0
    v_pk_max_i16 v126, v126, 0
    s_waitcnt lgkmcnt(6)
    v_mfma_f32_32x32x16_bf16 v[48:63], v[192:195], v[36:39], v[48:63]
    ds_read_b64_tr_b16 v[28:29], v2 offset:46080
    ds_read_b64_tr_b16 v[30:31], v2 offset:46592
    v_pk_max_i16 v127, v127, 0
    buffer_store_dwordx4 v[120:123], v3, s[60:63], s80 offen offset:0 sc1
    v_mfma_f32_32x32x16_bf16 v[48:63], v[196:199], v[40:43], v[48:63]
    ds_read_b64_tr_b16 v[32:33], v2 offset:47104
    ds_read_b64_tr_b16 v[34:35], v2 offset:47616
    buffer_load_dwordx4 v3, s[60:63], s76 offen offset:1024 sc1 lds
    s_waitcnt lgkmcnt(6)
    v_mfma_f32_32x32x16_bf16 v[48:63], v[200:203], v[16:19], v[48:63]
    ds_read_b64_tr_b16 v[36:37], v2 offset:48128
    ds_read_b64_tr_b16 v[38:39], v2 offset:48640
    buffer_store_dwordx4 v[124:127], v3, s[60:63], s80 offen offset:1024 sc1
    v_mfma_f32_32x32x16_bf16 v[48:63], v[204:207], v[20:23], v[48:63]
    ds_read_b64_tr_b16 v[40:41], v2 offset:49152
    ds_read_b64_tr_b16 v[42:43], v2 offset:49664
    buffer_load_dwordx4 v3, s[60:63], s76 offen offset:2048 sc1 lds
    v_add_u32 v132, 57344, v132
    s_waitcnt lgkmcnt(6)
    v_mfma_f32_32x32x16_bf16 v[48:63], v[208:211], v[24:27], v[48:63]
    ds_read_b64_tr_b16 v[16:17], v2 offset:50176
    ds_read_b64_tr_b16 v[18:19], v2 offset:50688
    buffer_load_dwordx4 a[108:111], v3, s[60:63], s23 offen offset:3072 sc1
    v_add_u32 v133, 57344, v133
    s_waitcnt vmcnt(10)
    v_mfma_f32_32x32x16_bf16 v[48:63], v[212:215], v[28:31], v[48:63]
    ds_read_b64_tr_b16 v[20:21], v2 offset:51200
    ds_read_b64_tr_b16 v[22:23], v2 offset:51712
    ds_read_b32 v128, v132 offset:0
    ds_read_b32 v129, v132 offset:32
    s_waitcnt lgkmcnt(8)
    v_mfma_f32_32x32x16_bf16 v[48:63], v[216:219], v[32:35], v[48:63]
    ds_read_b64_tr_b16 v[24:25], v2 offset:52224
    ds_read_b64_tr_b16 v[26:27], v2 offset:52736
    buffer_load_dwordx4 a[112:115], v3, s[60:63], s30 offen offset:0 sc1
    ds_read_b32 v130, v133 offset:0
    ds_read_b32 v131, v133 offset:32
    v_mfma_f32_32x32x16_bf16 v[48:63], v[220:223], v[36:39], v[48:63]
    ds_read_b64_tr_b16 v[28:29], v2 offset:53248
    ds_read_b64_tr_b16 v[30:31], v2 offset:53760
    s_waitcnt lgkmcnt(10)
    v_mfma_f32_32x32x16_bf16 v[48:63], v[224:227], v[40:43], v[48:63]
    ds_read_b64_tr_b16 v[32:33], v2 offset:54272
    ds_read_b64_tr_b16 v[34:35], v2 offset:54784
    buffer_load_dwordx4 a[116:119], v3, s[60:63], s30 offen offset:1024 sc1
    v_mfma_f32_32x32x16_bf16 v[48:63], v[228:231], v[16:19], v[48:63]
    ds_read_b64_tr_b16 v[36:37], v2 offset:55296
    ds_read_b64_tr_b16 v[38:39], v2 offset:55808
    s_waitcnt lgkmcnt(6)
    v_max3_u32 v128, v128, v129, v130
    v_mfma_f32_32x32x16_bf16 v[48:63], v[232:235], v[20:23], v[48:63]
    ds_read_b64_tr_b16 v[40:41], v2 offset:56320
    ds_read_b64_tr_b16 v[42:43], v2 offset:56832
    buffer_load_dwordx4 a[120:123], v3, s[60:63], s30 offen offset:2048 sc1
    v_max_u32 v128, v128, v131
    v_cmp_eq_u32 vcc, -1, v128
    v_mfma_f32_32x32x16_bf16 v[48:63], v[236:239], v[24:27], v[48:63]
    s_cbranch_vccnz L14
L15:
    s_barrier
    ds_read_b64_tr_b16 v[16:17], v44 offset:0
    ds_read_b64_tr_b16 v[18:19], v44 offset:512
    s_waitcnt lgkmcnt(6)
    v_mfma_f32_32x32x16_bf16 v[48:63], v[240:243], v[28:31], v[48:63]
    ds_read_b64_tr_b16 v[20:21], v44 offset:1024
    ds_read_b64_tr_b16 v[22:23], v44 offset:1536
    v_mfma_f32_32x32x16_bf16 v[48:63], v[244:247], v[32:35], v[48:63]
    ds_read_b64_tr_b16 v[24:25], v44 offset:2048
    ds_read_b64_tr_b16 v[26:27], v44 offset:2560
    buffer_load_dwordx4 a[124:127], v3, s[60:63], s30 offen offset:3072 sc1
    s_waitcnt lgkmcnt(6)
    v_mfma_f32_32x32x16_bf16 v[48:63], v[248:251], v[36:39], v[48:63]
    ds_read_b64_tr_b16 v[28:29], v44 offset:3072
    ds_read_b64_tr_b16 v[30:31], v44 offset:3584
    v_mfma_f32_32x32x16_bf16 v[48:63], v[252:255], v[40:43], v[48:63]
    ds_read_b64_tr_b16 v[32:33], v44 offset:4096
    ds_read_b64_tr_b16 v[34:35], v44 offset:4608
    s_add_u32 s30, s30, 4096
    buffer_load_dwordx4 a[128:131], v3, s[60:63], s30 offen offset:0 sc1
    s_waitcnt lgkmcnt(6)
    v_mfma_f32_32x32x16_bf16 v[64:79], v[144:147], v[16:19], 0
    ds_read_b64_tr_b16 v[36:37], v44 offset:5120
    ds_read_b64_tr_b16 v[38:39], v44 offset:5632
    v_mfma_f32_32x32x16_bf16 v[64:79], v[148:151], v[20:23], v[64:79]
    ds_read_b64_tr_b16 v[40:41], v44 offset:6144
    ds_read_b64_tr_b16 v[42:43], v44 offset:6656
    buffer_load_dwordx4 a[132:135], v3, s[60:63], s30 offen offset:1024 sc1
    s_waitcnt lgkmcnt(6)
    v_mfma_f32_32x32x16_bf16 v[64:79], v[152:155], v[24:27], v[64:79]
    ds_read_b64_tr_b16 v[16:17], v44 offset:7168
    ds_read_b64_tr_b16 v[18:19], v44 offset:7680
    v_mfma_f32_32x32x16_bf16 v[64:79], v[156:159], v[28:31], v[64:79]
    ds_read_b64_tr_b16 v[20:21], v44 offset:8192
    ds_read_b64_tr_b16 v[22:23], v44 offset:8704
    buffer_load_dwordx4 a[136:139], v3, s[60:63], s30 offen offset:2048 sc1
    v_cvt_pk_bf16_f32 v120, v48, v49
    s_waitcnt lgkmcnt(6)
    v_mfma_f32_32x32x16_bf16 v[64:79], v[160:163], v[32:35], v[64:79]
    ds_read_b64_tr_b16 v[24:25], v44 offset:9216
    ds_read_b64_tr_b16 v[26:27], v44 offset:9728
    v_cvt_pk_bf16_f32 v121, v50, v51
    v_cvt_pk_bf16_f32 v122, v52, v53
    v_cvt_pk_bf16_f32 v123, v54, v55
    v_mfma_f32_32x32x16_bf16 v[64:79], v[164:167], v[36:39], v[64:79]
    ds_read_b64_tr_b16 v[28:29], v44 offset:10240
    ds_read_b64_tr_b16 v[30:31], v44 offset:10752
    buffer_load_dwordx4 a[140:143], v3, s[60:63], s30 offen offset:3072 sc1
    v_cvt_pk_bf16_f32 v124, v56, v57
    s_waitcnt lgkmcnt(6)
    v_mfma_f32_32x32x16_bf16 v[64:79], v[168:171], v[40:43], v[64:79]
    ds_read_b64_tr_b16 v[32:33], v44 offset:11264
    ds_read_b64_tr_b16 v[34:35], v44 offset:11776
    s_waitcnt vmcnt(10)
    s_mov_b64 exec, 1
    s_cmp_eq_u32 s46, 1
    s_cbranch_scc0 L16
    buffer_store_dword v142, off, s[60:63], s4 offset:0
L17:
    s_mov_b64 exec, -1
    v_mfma_f32_32x32x16_bf16 v[64:79], v[172:175], v[16:19], v[64:79]
    ds_read_b64_tr_b16 v[36:37], v44 offset:12288
    ds_read_b64_tr_b16 v[38:39], v44 offset:12800
    s_add_u32 s30, s30, 4096
    buffer_load_dwordx4 a[144:147], v3, s[60:63], s30 offen offset:0 sc1
    s_waitcnt lgkmcnt(6)
    v_mfma_f32_32x32x16_bf16 v[64:79], v[176:179], v[20:23], v[64:79]
    ds_read_b64_tr_b16 v[40:41], v44 offset:13312
    ds_read_b64_tr_b16 v[42:43], v44 offset:13824
    v_cvt_pk_bf16_f32 v125, v58, v59
    v_cvt_pk_bf16_f32 v126, v60, v61
    v_cvt_pk_bf16_f32 v127, v62, v63
    v_mfma_f32_32x32x16_bf16 v[64:79], v[180:183], v[24:27], v[64:79]
    ds_read_b64_tr_b16 v[16:17], v44 offset:14336
    ds_read_b64_tr_b16 v[18:19], v44 offset:14848
    v_pk_max_i16 v120, v120, 0
    v_pk_max_i16 v121, v121, 0
    s_waitcnt lgkmcnt(6)
    v_mfma_f32_32x32x16_bf16 v[64:79], v[184:187], v[28:31], v[64:79]
    ds_read_b64_tr_b16 v[20:21], v44 offset:15360
    ds_read_b64_tr_b16 v[22:23], v44 offset:15872
    s_lshl_b32 s96, s35, 10
    s_add_u32 s96, s96, 172032
    v_and_b32 v45, 0x1f0, v3
    buffer_load_dword v46, v45, s[60:63], s96 offen sc1
    v_mfma_f32_32x32x16_bf16 v[64:79], v[188:191], v[32:35], v[64:79]
    ds_read_b64_tr_b16 v[24:25], v44 offset:16384
    ds_read_b64_tr_b16 v[26:27], v44 offset:16896
    buffer_load_dwordx4 a[148:151], v3, s[60:63], s30 offen offset:1024 sc1
    v_pk_max_i16 v122, v122, 0
    s_waitcnt lgkmcnt(6)
    v_mfma_f32_32x32x16_bf16 v[64:79], v[192:195], v[36:39], v[64:79]
    ds_read_b64_tr_b16 v[28:29], v44 offset:17408
    ds_read_b64_tr_b16 v[30:31], v44 offset:17920
    v_pk_max_i16 v123, v123, 0
    v_pk_max_i16 v124, v124, 0
    v_pk_max_i16 v125, v125, 0
    v_pk_max_i16 v126, v126, 0
    v_pk_max_i16 v127, v127, 0
    buffer_store_dwordx4 v[120:123], v3, s[60:63], s81 offen offset:0 sc1
    v_mfma_f32_32x32x16_bf16 v[64:79], v[196:199], v[40:43], v[64:79]
    ds_read_b64_tr_b16 v[32:33], v44 offset:18432
    ds_read_b64_tr_b16 v[34:35], v44 offset:18944
    buffer_load_dwordx4 a[152:155], v3, s[60:63], s30 offen offset:2048 sc1
    s_waitcnt lgkmcnt(6)
    v_mfma_f32_32x32x16_bf16 v[64:79], v[200:203], v[16:19], v[64:79]
    ds_read_b64_tr_b16 v[36:37], v44 offset:19456
    ds_read_b64_tr_b16 v[38:39], v44 offset:19968
    buffer_store_dwordx4 v[124:127], v3, s[60:63], s81 offen offset:1024 sc1
    v_mfma_f32_32x32x16_bf16 v[64:79], v[204:207], v[20:23], v[64:79]
    ds_read_b64_tr_b16 v[40:41], v44 offset:20480
    ds_read_b64_tr_b16 v[42:43], v44 offset:20992
    buffer_load_dwordx4 a[156:159], v3, s[60:63], s30 offen offset:3072 sc1
    s_waitcnt vmcnt(17)
    s_waitcnt lgkmcnt(6)
    v_mfma_f32_32x32x16_bf16 v[64:79], v[208:211], v[24:27], v[64:79]
    ds_read_b64_tr_b16 v[16:17], v44 offset:21504
    ds_read_b64_tr_b16 v[18:19], v44 offset:22016
    s_add_u32 s30, s30, 4096
    buffer_load_dwordx4 a[160:163], v3, s[60:63], s30 offen offset:0 sc1
    ds_read_b32 v128, v132 offset:28672
    v_mfma_f32_32x32x16_bf16 v[64:79], v[212:215], v[28:31], v[64:79]
    ds_read_b64_tr_b16 v[20:21], v44 offset:22528
    ds_read_b64_tr_b16 v[22:23], v44 offset:23040
    ds_read_b32 v129, v132 offset:28704
    ds_read_b32 v130, v133 offset:28672
    s_waitcnt lgkmcnt(9)
    v_mfma_f32_32x32x16_bf16 v[64:79], v[216:219], v[32:35], v[64:79]
    ds_read_b64_tr_b16 v[24:25], v44 offset:23552
    ds_read_b64_tr_b16 v[26:27], v44 offset:24064
    buffer_load_dwordx4 a[164:167], v3, s[60:63], s30 offen offset:1024 sc1
    ds_read_b32 v131, v133 offset:28704
    v_mfma_f32_32x32x16_bf16 v[64:79], v[220:223], v[36:39], v[64:79]
    ds_read_b64_tr_b16 v[28:29], v44 offset:24576
    ds_read_b64_tr_b16 v[30:31], v44 offset:25088
    s_waitcnt lgkmcnt(10)
    v_mfma_f32_32x32x16_bf16 v[64:79], v[224:227], v[40:43], v[64:79]
    ds_read_b64_tr_b16 v[32:33], v44 offset:25600
    ds_read_b64_tr_b16 v[34:35], v44 offset:26112
    v_mfma_f32_32x32x16_bf16 v[64:79], v[228:231], v[16:19], v[64:79]
    ds_read_b64_tr_b16 v[36:37], v44 offset:26624
    ds_read_b64_tr_b16 v[38:39], v44 offset:27136
    buffer_load_dwordx4 a[168:171], v3, s[60:63], s30 offen offset:2048 sc1
    s_waitcnt lgkmcnt(6)
    v_mfma_f32_32x32x16_bf16 v[64:79], v[232:235], v[20:23], v[64:79]
    ds_read_b64_tr_b16 v[40:41], v44 offset:27648
    ds_read_b64_tr_b16 v[42:43], v44 offset:28160
    v_max3_u32 v128, v128, v129, v130
    v_max_u32 v128, v128, v131
    v_cmp_eq_u32 vcc, -1, v128
    v_mfma_f32_32x32x16_bf16 v[64:79], v[236:239], v[24:27], v[64:79]
    s_cbranch_vccnz L18
L19:
    s_barrier
    ds_read_b64_tr_b16 v[16:17], v44 offset:28672
    ds_read_b64_tr_b16 v[18:19], v44 offset:29184
    s_waitcnt lgkmcnt(6)
    v_mfma_f32_32x32x16_bf16 v[64:79], v[240:243], v[28:31], v[64:79]
    ds_read_b64_tr_b16 v[20:21], v44 offset:29696
    ds_read_b64_tr_b16 v[22:23], v44 offset:30208
    buffer_load_dword v14, v13, s[60:63], s5 offen offset:0 sc1
    buffer_load_dwordx4 a[172:175], v3, s[60:63], s30 offen offset:3072 sc1
    v_mfma_f32_32x32x16_bf16 v[64:79], v[244:247], v[32:35], v[64:79]
    ds_read_b64_tr_b16 v[24:25], v44 offset:30720
    ds_read_b64_tr_b16 v[26:27], v44 offset:31232
    s_add_u32 s30, s30, 4096
    buffer_load_dwordx4 a[176:179], v3, s[60:63], s30 offen offset:0 sc1
    s_waitcnt lgkmcnt(6)
    v_mfma_f32_32x32x16_bf16 v[64:79], v[248:251], v[36:39], v[64:79]
    ds_read_b64_tr_b16 v[28:29], v44 offset:31744
    ds_read_b64_tr_b16 v[30:31], v44 offset:32256
    v_mfma_f32_32x32x16_bf16 v[64:79], v[252:255], v[40:43], v[64:79]
    ds_read_b64_tr_b16 v[32:33], v44 offset:32768
    ds_read_b64_tr_b16 v[34:35], v44 offset:33280
    buffer_load_dwordx4 a[180:183], v3, s[60:63], s30 offen offset:1024 sc1
    s_waitcnt lgkmcnt(6)
    v_mfma_f32_32x32x16_bf16 v[48:63], v[144:147], v[16:19], 0
    ds_read_b64_tr_b16 v[36:37], v44 offset:33792
    ds_read_b64_tr_b16 v[38:39], v44 offset:34304
    v_mfma_f32_32x32x16_bf16 v[48:63], v[148:151], v[20:23], v[48:63]
    ds_read_b64_tr_b16 v[40:41], v44 offset:34816
    ds_read_b64_tr_b16 v[42:43], v44 offset:35328
    buffer_load_dwordx4 a[184:187], v3, s[60:63], s30 offen offset:2048 sc1
    s_waitcnt lgkmcnt(6)
    v_mfma_f32_32x32x16_bf16 v[48:63], v[152:155], v[24:27], v[48:63]
    ds_read_b64_tr_b16 v[16:17], v44 offset:35840
    ds_read_b64_tr_b16 v[18:19], v44 offset:36352
    s_waitcnt vmcnt(9)
    s_mov_b64 exec, 1
    s_cmp_eq_u32 s46, 1
    s_cbranch_scc0 L20
    buffer_store_dword v142, off, s[60:63], s4 offset:256
L21:
    s_mov_b64 exec, -1
    v_mfma_f32_32x32x16_bf16 v[48:63], v[156:159], v[28:31], v[48:63]
    ds_read_b64_tr_b16 v[20:21], v44 offset:36864
    ds_read_b64_tr_b16 v[22:23], v44 offset:37376
    buffer_load_dwordx4 a[188:191], v3, s[60:63], s30 offen offset:3072 sc1
    v_cvt_pk_bf16_f32 v120, v64, v65
    s_waitcnt lgkmcnt(6)
    v_mfma_f32_32x32x16_bf16 v[48:63], v[160:163], v[32:35], v[48:63]
    ds_read_b64_tr_b16 v[24:25], v44 offset:37888
    ds_read_b64_tr_b16 v[26:27], v44 offset:38400
    v_cvt_pk_bf16_f32 v121, v66, v67
    v_cvt_pk_bf16_f32 v122, v68, v69
    v_cvt_pk_bf16_f32 v123, v70, v71
    v_mfma_f32_32x32x16_bf16 v[48:63], v[164:167], v[36:39], v[48:63]
    ds_read_b64_tr_b16 v[28:29], v44 offset:38912
    ds_read_b64_tr_b16 v[30:31], v44 offset:39424
    v_cvt_pk_bf16_f32 v124, v72, v73
    v_cvt_pk_bf16_f32 v125, v74, v75
    s_waitcnt lgkmcnt(6)
    v_mfma_f32_32x32x16_bf16 v[48:63], v[168:171], v[40:43], v[48:63]
    ds_read_b64_tr_b16 v[32:33], v44 offset:39936
    ds_read_b64_tr_b16 v[34:35], v44 offset:40448
    s_add_u32 s30, s30, 4096
    buffer_load_dwordx4 a[192:195], v3, s[60:63], s30 offen offset:0 sc1
    v_cvt_pk_bf16_f32 v126, v76, v77
    v_mfma_f32_32x32x16_bf16 v[48:63], v[172:175], v[16:19], v[48:63]
    ds_read_b64_tr_b16 v[36:37], v44 offset:40960
    ds_read_b64_tr_b16 v[38:39], v44 offset:41472
    v_cvt_pk_bf16_f32 v127, v78, v79
    v_pk_max_i16 v120, v120, 0
    s_waitcnt lgkmcnt(6)
    v_mfma_f32_32x32x16_bf16 v[48:63], v[176:179], v[20:23], v[48:63]
    ds_read_b64_tr_b16 v[40:41], v44 offset:41984
    ds_read_b64_tr_b16 v[42:43], v44 offset:42496
    buffer_load_dwordx4 a[196:199], v3, s[60:63], s30 offen offset:1024 sc1
    v_pk_max_i16 v121, v121, 0
    v_pk_max_i16 v122, v122, 0
    v_mfma_f32_32x32x16_bf16 v[48:63], v[180:183], v[24:27], v[48:63]
    ds_read_b64_tr_b16 v[16:17], v44 offset:43008
    ds_read_b64_tr_b16 v[18:19], v44 offset:43520
    s_waitcnt vmcnt(8)
    v_cmp_ne_u32 vcc, s38, v14
    s_waitcnt lgkmcnt(6)
    v_mfma_f32_32x32x16_bf16 v[48:63], v[184:187], v[28:31], v[48:63]
    ds_read_b64_tr_b16 v[20:21], v44 offset:44032
    ds_read_b64_tr_b16 v[22:23], v44 offset:44544
    s_cbranch_vccnz L22
L23:
    v_mfma_f32_32x32x16_bf16 v[48:63], v[188:191], v[32:35], v[48:63]
    ds_read_b64_tr_b16 v[24:25], v44 offset:45056
    ds_read_b64_tr_b16 v[26:27], v44 offset:45568
    buffer_load_dwordx4 a[200:203], v3, s[60:63], s30 offen offset:2048 sc1
    v_pk_max_i16 v123, v123, 0
    s_waitcnt lgkmcnt(6)
    v_mfma_f32_32x32x16_bf16 v[48:63], v[192:195], v[36:39], v[48:63]
    ds_read_b64_tr_b16 v[28:29], v44 offset:46080
    ds_read_b64_tr_b16 v[30:31], v44 offset:46592
    v_pk_max_i16 v124, v124, 0
    v_pk_max_i16 v125, v125, 0
    v_pk_max_i16 v126, v126, 0
    v_pk_max_i16 v127, v127, 0
    buffer_store_dwordx4 v[120:123], v3, s[60:63], s82 offen offset:0 sc1
    v_mfma_f32_32x32x16_bf16 v[48:63], v[196:199], v[40:43], v[48:63]
    ds_read_b64_tr_b16 v[32:33], v44 offset:47104
    ds_read_b64_tr_b16 v[34:35], v44 offset:47616
    buffer_load_dwordx4 v[80:83], v3, s[60:63], s74 offen offset:0 sc1
    s_waitcnt lgkmcnt(6)
    v_mfma_f32_32x32x16_bf16 v[48:63], v[200:203], v[16:19], v[48:63]
    ds_read_b64_tr_b16 v[36:37], v44 offset:48128
    ds_read_b64_tr_b16 v[38:39], v44 offset:48640
    buffer_store_dwordx4 v[124:127], v3, s[60:63], s82 offen offset:1024 sc1
    v_mfma_f32_32x32x16_bf16 v[48:63], v[204:207], v[20:23], v[48:63]
    ds_read_b64_tr_b16 v[40:41], v44 offset:49152
    ds_read_b64_tr_b16 v[42:43], v44 offset:49664
    buffer_load_dwordx4 a[204:207], v3, s[60:63], s30 offen offset:3072 sc1
    s_waitcnt lgkmcnt(6)
    v_mfma_f32_32x32x16_bf16 v[48:63], v[208:211], v[24:27], v[48:63]
    ds_read_b64_tr_b16 v[16:17], v44 offset:50176
    ds_read_b64_tr_b16 v[18:19], v44 offset:50688
    v_mfma_f32_32x32x16_bf16 v[48:63], v[212:215], v[28:31], v[48:63]
    ds_read_b64_tr_b16 v[20:21], v44 offset:51200
    ds_read_b64_tr_b16 v[22:23], v44 offset:51712
    buffer_load_dwordx4 v[84:87], v3, s[60:63], s74 offen offset:1024 sc1
    s_waitcnt lgkmcnt(6)
    v_mfma_f32_32x32x16_bf16 v[48:63], v[216:219], v[32:35], v[48:63]
    ds_read_b64_tr_b16 v[24:25], v44 offset:52224
    ds_read_b64_tr_b16 v[26:27], v44 offset:52736
    v_cmp_ne_u32 vcc, s38, v46
    v_mfma_f32_32x32x16_bf16 v[48:63], v[220:223], v[36:39], v[48:63]
    ds_read_b64_tr_b16 v[28:29], v44 offset:53248
    ds_read_b64_tr_b16 v[30:31], v44 offset:53760
    s_cbranch_vccnz L24
L25:
    s_waitcnt lgkmcnt(6)
    v_mfma_f32_32x32x16_bf16 v[48:63], v[224:227], v[40:43], v[48:63]
    ds_read_b64_tr_b16 v[32:33], v44 offset:54272
    ds_read_b64_tr_b16 v[34:35], v44 offset:54784
    s_add_u32 s30, s30, 4096
    buffer_load_dwordx4 a[208:211], v3, s[60:63], s30 offen offset:0 sc1
    v_mfma_f32_32x32x16_bf16 v[48:63], v[228:231], v[16:19], v[48:63]
    ds_read_b64_tr_b16 v[36:37], v44 offset:55296
    ds_read_b64_tr_b16 v[38:39], v44 offset:55808
    buffer_load_dwordx4 v[88:91], v3, s[60:63], s74 offen offset:2048 sc1
    s_waitcnt lgkmcnt(6)
    v_mfma_f32_32x32x16_bf16 v[48:63], v[232:235], v[20:23], v[48:63]
    ds_read_b64_tr_b16 v[40:41], v44 offset:56320
    ds_read_b64_tr_b16 v[42:43], v44 offset:56832
    v_mfma_f32_32x32x16_bf16 v[48:63], v[236:239], v[24:27], v[48:63]
    buffer_load_dwordx4 a[212:215], v3, s[60:63], s30 offen offset:1024 sc1
    s_waitcnt lgkmcnt(4)
    v_mfma_f32_32x32x16_bf16 v[48:63], v[240:243], v[28:31], v[48:63]
    buffer_load_dword v14, v13, s[60:63], s6 offen offset:256 sc1
    v_mfma_f32_32x32x16_bf16 v[48:63], v[244:247], v[32:35], v[48:63]
    buffer_load_dwordx4 v[92:95], v3, s[60:63], s74 offen offset:3072 sc1
    s_add_u32 s74, s74, 4096
    s_waitcnt lgkmcnt(0)
    v_mfma_f32_32x32x16_bf16 v[48:63], v[248:251], v[36:39], v[48:63]
    v_mfma_f32_32x32x16_bf16 v[48:63], v[252:255], v[40:43], v[48:63]
    buffer_load_dwordx4 a[216:219], v3, s[60:63], s30 offen offset:2048 sc1
    s_waitcnt vmcnt(9)
    v_mfma_f32_32x32x16_bf16 v[16:31], a[0:3], v[80:83], 0
    buffer_load_dwordx4 v[96:99], v3, s[60:63], s74 offen offset:0 sc1
    s_nop 2
    v_mfma_f32_32x32x16_bf16 v[32:47], a[4:7], v[80:83], 0
    buffer_load_dwordx4 v[100:103], v3, s[60:63], s74 offen offset:1024 sc1
    s_nop 2
    s_waitcnt vmcnt(8)
    v_mfma_f32_32x32x16_bf16 v[16:31], a[8:11], v[84:87], v[16:31]
    buffer_load_dwordx4 v[104:107], v3, s[60:63], s74 offen offset:2048 sc1
    s_nop 2
    v_mfma_f32_32x32x16_bf16 v[32:47], a[12:15], v[84:87], v[32:47]
    buffer_load_dwordx4 v[108:111], v3, s[60:63], s74 offen offset:3072 sc1
    s_add_u32 s74, s74, 4096
    v_cvt_pk_bf16_f32 v120, v48, v49
    v_cvt_pk_bf16_f32 v121, v50, v51
    s_waitcnt vmcnt(8)
    v_mfma_f32_32x32x16_bf16 v[16:31], a[16:19], v[88:91], v[16:31]
    buffer_load_dwordx4 v[112:115], v3, s[60:63], s74 offen offset:0 sc1
    v_cvt_pk_bf16_f32 v122, v52, v53
    v_cvt_pk_bf16_f32 v123, v54, v55
    v_cvt_pk_bf16_f32 v124, v56, v57
    v_mfma_f32_32x32x16_bf16 v[32:47], a[20:23], v[88:91], v[32:47]
    buffer_load_dwordx4 v[116:119], v3, s[60:63], s74 offen offset:1024 sc1
    v_cvt_pk_bf16_f32 v125, v58, v59
    v_cvt_pk_bf16_f32 v126, v60, v61
    v_cvt_pk_bf16_f32 v127, v62, v63
    s_waitcnt vmcnt(7)
    v_mfma_f32_32x32x16_bf16 v[16:31], a[24:27], v[92:95], v[16:31]
    s_mov_b64 exec, 1
    s_cmp_eq_u32 s46, 1
    s_cbranch_scc0 L26
    buffer_store_dword v142, off, s[60:63], s4 offset:512
L27:
    s_mov_b64 exec, -1
    buffer_load_dwordx4 a[224:227], v3, s[60:63], s74 offen offset:2048 sc1
    v_mfma_f32_32x32x16_bf16 v[32:47], a[28:31], v[92:95], v[32:47]
    v_pk_max_i16 v120, v120, 0
    v_pk_max_i16 v121, v121, 0
    v_pk_max_i16 v122, v122, 0
    v_pk_max_i16 v123, v123, 0
    v_pk_max_i16 v124, v124, 0
    v_pk_max_i16 v125, v125, 0
    v_pk_max_i16 v126, v126, 0
    v_pk_max_i16 v127, v127, 0
    buffer_store_dwordx4 v[120:123], v3, s[60:63], s83 offen offset:0 sc1
    buffer_load_dwordx4 a[228:231], v3, s[60:63], s74 offen offset:3072 sc1
    s_add_u32 s74, s74, 4096
    s_waitcnt vmcnt(9)
    v_mfma_f32_32x32x16_bf16 v[16:31], a[32:35], v[96:99], v[16:31]
    buffer_load_dwordx4 a[232:235], v3, s[60:63], s74 offen offset:0 sc1
    v_mfma_f32_32x32x16_bf16 v[32:47], a[36:39], v[96:99], v[32:47]
    buffer_store_dwordx4 v[124:127], v3, s[60:63], s83 offen offset:1024 sc1
    v_cmp_ne_u32 vcc, s38, v14
    buffer_load_dwordx4 a[236:239], v3, s[60:63], s74 offen offset:1024 sc1
    s_waitcnt vmcnt(11)
    v_mfma_f32_32x32x16_bf16 v[16:31], a[40:43], v[100:103], v[16:31]
    s_cbranch_vccnz L28
L29:
    buffer_load_dwordx4 a[240:243], v3, s[60:63], s75 offen offset:0 sc1
    v_mfma_f32_32x32x16_bf16 v[32:47], a[44:47], v[100:103], v[32:47]
    buffer_load_dwordx4 a[244:247], v3, s[60:63], s75 offen offset:1024 sc1
    s_barrier
    s_lshl_b32 s48, s43, 2
    s_waitcnt vmcnt(12)
    v_mfma_f32_32x32x16_bf16 v[16:31], a[48:51], v[104:107], v[16:31]
    buffer_load_dwordx4 a[248:251], v3, s[60:63], s75 offen offset:2048 sc1
    s_add_u32 s48, s48, s34
    s_lshl_b32 s49, s48, 10
    v_add_u32 v124, s49, v2
    ds_read_b64_tr_b16 v[128:129], v124 offset:0
    v_mfma_f32_32x32x16_bf16 v[32:47], a[52:55], v[104:107], v[32:47]
    buffer_load_dwordx4 a[252:255], v3, s[60:63], s75 offen offset:3072 sc1
    s_add_u32 s75, s75, 4096
    ds_read_b64_tr_b16 v[130:131], v124 offset:512
    ds_read_b64_tr_b16 v[132:133], v124 offset:57344
    s_waitcnt vmcnt(13)
    v_mfma_f32_32x32x16_bf16 v[16:31], a[56:59], v[108:111], v[16:31]
    ds_read_b64_tr_b16 v[134:135], v124 offset:57856
    v_and_b32 v138, 31, v1
    v_lshrrev_b32 v127, 2, v138
    v_lshlrev_b32 v127, 4, v127
    v_and_b32 v139, 1, v138
    v_mfma_f32_32x32x16_bf16 v[32:47], a[60:63], v[108:111], v[32:47]
    buffer_load_dwordx4 v[80:83], v3, s[60:63], s75 offen offset:0 sc1
    v_lshl_add_u32 v127, v139, 3, v127
    v_bfe_u32 v139, v138, 1, 1
    v_lshl_add_u32 v127, v139, 12, v127
    s_waitcnt vmcnt(13)
    v_mfma_f32_32x32x16_bf16 v[16:31], a[64:67], v[112:115], v[16:31]
    s_lshl_b32 s82, s78, 7
    s_add_u32 s82, s82, 9191424
    s_add_u32 s83, s82, 8192
    buffer_load_dword v136, v127, s[60:63], s82 offen offset:4 sc1
    s_xor_b32 s49, s34, 1
    v_mfma_f32_32x32x16_bf16 v[32:47], a[68:71], v[112:115], v[32:47]
    buffer_load_dwordx4 v[84:87], v3, s[60:63], s75 offen offset:1024 sc1
    s_mul_i32 s49, s49, 6144
    s_add_u32 s49, s49, 28672
    v_add_u32 v121, s49, v3
    s_waitcnt vmcnt(14)
    v_mfma_f32_32x32x16_bf16 v[16:31], a[72:75], v[116:119], v[16:31]
    s_xor_b32 s49, s34, 2
    s_mul_i32 s49, s49, 6144
    s_add_u32 s49, s49, 30720
    v_add_u32 v122, s49, v3
    s_xor_b32 s49, s34, 3
    v_mfma_f32_32x32x16_bf16 v[32:47], a[76:79], v[116:119], v[32:47]
    buffer_load_dwordx4 v[88:91], v3, s[60:63], s75 offen offset:2048 sc1
    s_mul_i32 s49, s49, 6144
    s_add_u32 s49, s49, 32768
    v_add_u32 v123, s49, v3
    s_waitcnt vmcnt(13)
    v_mfma_f32_32x32x16_bf16 v[16:31], a[80:83], a[224:227], v[16:31]
    buffer_load_dword v14, v13, s[60:63], s5 offen offset:512 sc1
    s_mul_i32 s49, s34, 6144
    s_add_u32 s49, s49, 28672
    v_add_u32 v120, s49, v3
    s_mul_i32 s49, s34, 1280
    v_mfma_f32_32x32x16_bf16 v[32:47], a[84:87], a[224:227], v[32:47]
    buffer_load_dwordx4 v[92:95], v3, s[60:63], s75 offen offset:3072 sc1
    s_add_u32 s75, s75, 4096
    s_add_u32 s49, s49, 114688
    v_lshrrev_b32 v139, 5, v1
    s_waitcnt vmcnt(13)
    v_mfma_f32_32x32x16_bf16 v[16:31], a[88:91], a[228:231], v[16:31]
    v_mul_u32_u24 v124, 40, v138
    v_lshl_add_u32 v124, v139, 3, v124
    v_add_u32 v124, s49, v124
    v_lshrrev_b32 v138, 4, v1
    v_bfe_u32 v125, v1, 2, 2
    v_mfma_f32_32x32x16_bf16 v[32:47], a[92:95], a[228:231], v[32:47]
    buffer_load_dwordx4 v[96:99], v3, s[60:63], s75 offen offset:0 sc1
    v_lshl_add_u32 v125, v138, 3, v125
    v_mul_u32_u24 v125, 40, v125
    v_and_b32 v139, 3, v1
    s_waitcnt vmcnt(13)
    v_mfma_f32_32x32x16_bf16 v[16:31], a[96:99], a[232:235], v[16:31]
    v_lshl_add_u32 v125, v139, 3, v125
    v_add_u32 v125, s49, v125
    v_and_b32 v126, 15, v1
    v_lshlrev_b32 v126, 6, v126
    v_lshl_add_u32 v126, v138, 4, v126
    v_mfma_f32_32x32x16_bf16 v[32:47], a[100:103], a[232:235], v[32:47]
    buffer_load_dwordx4 v[100:103], v3, s[60:63], s75 offen offset:1024 sc1
    s_lshl_b32 s48, s48, 10
    s_mul_i32 s80, s78, 28928
    s_add_u32 s80, s80, s48
    s_waitcnt vmcnt(12)
    v_mfma_f32_32x32x16_bf16 v[16:31], a[104:107], a[236:239], v[16:31]
    s_add_u32 s80, s80, 7340032
    s_add_u32 s81, s80, 925696
    s_lshr_b32 s48, s48, 3
    s_mul_i32 s84, s78, 7168
    s_add_u32 s84, s84, s48
    v_mfma_f32_32x32x16_bf16 v[32:47], a[108:111], a[236:239], v[32:47]
    buffer_load_dwordx4 v[104:107], v3, s[60:63], s75 offen offset:2048 sc1
    s_add_u32 s84, s84, 9240576
    s_add_u32 s85, s84, 229376
    v_and_b32 v143, 15, v1
    s_waitcnt vmcnt(12)
    v_mfma_f32_32x32x16_bf16 v[16:31], a[112:115], a[240:243], v[16:31]
    v_lshrrev_b32 v139, 1, v138
    v_lshl_add_u32 v143, v139, 4, v143
    v_and_b32 v138, 1, v138
    v_mul_u32_u24 v138, 3584, v138
    v_lshl_add_u32 v143, v143, 2, v138
    v_mfma_f32_32x32x16_bf16 v[32:47], a[116:119], a[240:243], v[32:47]
    buffer_load_dwordx4 v[108:111], v3, s[60:63], s75 offen offset:3072 sc1
    s_add_u32 s75, s75, 4096
    buffer_load_dword v137, v127, s[60:63], s83 offen offset:4 sc1
    s_waitcnt vmcnt(13)
    v_mfma_f32_32x32x16_bf16 v[16:31], a[120:123], a[244:247], v[16:31]
    s_mov_b64 exec, 1
    s_cmp_eq_u32 s46, 1
    s_cbranch_scc0 L30
    buffer_store_dword v142, off, s[60:63], s4 offset:768
L31:
    s_mov_b64 exec, -1
    v_mfma_f32_32x32x16_bf16 v[32:47], a[124:127], a[244:247], v[32:47]
    buffer_load_dwordx4 v[112:115], v3, s[60:63], s75 offen offset:0 sc1
    s_waitcnt vmcnt(14)
    v_mfma_f32_32x32x16_bf16 v[16:31], a[128:131], a[248:251], v[16:31]
    s_waitcnt vmcnt(8)
    v_cmp_ne_u32 vcc, s38, v14
    v_mfma_f32_32x32x16_bf16 v[32:47], a[132:135], a[248:251], v[32:47]
    s_cbranch_vccnz L32
L33:
    buffer_load_dwordx4 v[116:119], v3, s[60:63], s75 offen offset:1024 sc1
    v_mfma_f32_32x32x16_bf16 v[16:31], a[136:139], a[252:255], v[16:31]
    v_mfma_f32_32x32x16_bf16 v[32:47], a[140:143], a[252:255], v[32:47]
    buffer_load_dwordx4 a[224:227], v3, s[60:63], s86 offen offset:0 sc1
    v_mfma_f32_32x32x16_bf16 v[16:31], a[144:147], v[80:83], v[16:31]
    v_mfma_f32_32x32x16_bf16 v[32:47], a[148:151], v[80:83], v[32:47]
    buffer_load_dwordx4 a[228:231], v3, s[60:63], s86 offen offset:1024 sc1
    v_mfma_f32_32x32x16_bf16 v[16:31], a[152:155], v[84:87], v[16:31]
    v_mfma_f32_32x32x16_bf16 v[32:47], a[156:159], v[84:87], v[32:47]
    buffer_load_dwordx4 a[220:223], v3, s[60:63], s30 offen offset:3072 sc1
    v_mfma_f32_32x32x16_bf16 v[16:31], a[160:163], v[88:91], v[16:31]
    buffer_load_dwordx4 a[232:235], v3, s[60:63], s86 offen offset:2048 sc1
    v_mfma_f32_32x32x16_bf16 v[32:47], a[164:167], v[88:91], v[32:47]
    buffer_load_dwordx4 a[236:239], v3, s[60:63], s86 offen offset:3072 sc1
    s_add_u32 s86, s86, 4096
    s_waitcnt vmcnt(13)
    v_mfma_f32_32x32x16_bf16 v[16:31], a[168:171], v[92:95], v[16:31]
    v_mfma_f32_32x32x16_bf16 v[32:47], a[172:175], v[92:95], v[32:47]
    buffer_load_dwordx4 a[240:243], v3, s[60:63], s86 offen offset:0 sc1
    s_waitcnt vmcnt(13)
    v_mfma_f32_32x32x16_bf16 v[16:31], a[176:179], v[96:99], v[16:31]
    buffer_load_dword v14, v13, s[60:63], s6 offen offset:768 sc1
    v_mfma_f32_32x32x16_bf16 v[32:47], a[180:183], v[96:99], v[32:47]
    buffer_load_dwordx4 a[244:247], v3, s[60:63], s86 offen offset:1024 sc1
    s_waitcnt vmcnt(14)
    v_mfma_f32_32x32x16_bf16 v[16:31], a[184:187], v[100:103], v[16:31]
    v_mfma_f32_32x32x16_bf16 v[32:47], a[188:191], v[100:103], v[32:47]
    buffer_load_dwordx4 a[248:251], v3, s[60:63], s86 offen offset:2048 sc1
    s_waitcnt vmcnt(14)
    v_mfma_f32_32x32x16_bf16 v[16:31], a[192:195], v[104:107], v[16:31]
    v_mfma_f32_32x32x16_bf16 v[32:47], a[196:199], v[104:107], v[32:47]
    buffer_load_dwordx4 a[252:255], v3, s[60:63], s86 offen offset:3072 sc1
    s_add_u32 s86, s86, 4096
    s_waitcnt vmcnt(14)
    v_mfma_f32_32x32x16_bf16 v[16:31], a[200:203], v[108:111], v[16:31]
    v_mfma_f32_32x32x16_bf16 v[32:47], a[204:207], v[108:111], v[32:47]
    buffer_load_dwordx4 v[80:83], v3, s[60:63], s86 offen offset:0 sc1
    s_waitcnt vmcnt(12)
    v_mfma_f32_32x32x16_bf16 v[16:31], a[208:211], v[112:115], v[16:31]
    v_mfma_f32_32x32x16_bf16 v[32:47], a[212:215], v[112:115], v[32:47]
    buffer_load_dwordx4 v[84:87], v3, s[60:63], s86 offen offset:1024 sc1
    s_waitcnt vmcnt(12)
    v_mfma_f32_32x32x16_bf16 v[16:31], a[216:219], v[116:119], v[16:31]
    s_waitcnt vmcnt(9)
    v_mfma_f32_32x32x16_bf16 v[32:47], a[220:223], v[116:119], v[32:47]
    s_waitcnt vmcnt(5)
    v_cmp_ne_u32 vcc, s38, v14
    buffer_load_dwordx4 v[88:91], v3, s[60:63], s86 offen offset:2048 sc1
    v_mfma_f32_32x32x16_bf16 v[48:63], a[0:3], a[224:227], 0
    s_cbranch_vccnz L34
L35:
    v_cmp_eq_u32 vcc, -1, v136
    v_mfma_f32_32x32x16_bf16 v[64:79], a[4:7], a[224:227], 0
    buffer_load_dwordx4 v[92:95], v3, s[60:63], s86 offen offset:3072 sc1
    s_add_u32 s86, s86, 4096
    s_cbranch_vccnz L36
L37:
    v_mfma_f32_32x32x16_bf16 v[48:63], a[8:11], a[228:231], v[48:63]
    v_cmp_eq_u32 vcc, -1, v137
    v_mfma_f32_32x32x16_bf16 v[64:79], a[12:15], a[228:231], v[64:79]
    buffer_load_dwordx4 v[96:99], v3, s[60:63], s86 offen offset:0 sc1
    s_cbranch_vccnz L38
L39:
    v_mfma_f32_32x32x16_bf16 v[48:63], a[16:19], a[232:235], v[48:63]
    ds_write_b128 v121, v[24:27] offset:0
    v_mfma_f32_32x32x16_bf16 v[64:79], a[20:23], a[232:235], v[64:79]
    buffer_load_dwordx4 v[100:103], v3, s[60:63], s86 offen offset:1024 sc1
    v_mfma_f32_32x32x16_bf16 v[48:63], a[24:27], a[236:239], v[48:63]
    ds_write_b128 v121, v[28:31] offset:1024
    v_mfma_f32_32x32x16_bf16 v[64:79], a[28:31], a[236:239], v[64:79]
    buffer_load_dwordx4 v[104:107], v3, s[60:63], s87 offen offset:0 sc1
    v_mfma_f32_32x32x16_bf16 v[48:63], a[32:35], a[240:243], v[48:63]
    ds_write_b128 v122, v[32:35] offset:0
    v_mfma_f32_32x32x16_bf16 v[64:79], a[36:39], a[240:243], v[64:79]
    buffer_load_dwordx4 v[108:111], v3, s[60:63], s87 offen offset:1024 sc1
    s_waitcnt vmcnt(10)
    v_mfma_f32_32x32x16_bf16 v[48:63], a[40:43], a[244:247], v[48:63]
    ds_write_b128 v122, v[36:39] offset:1024
    v_mfma_f32_32x32x16_bf16 v[64:79], a[44:47], a[244:247], v[64:79]
    buffer_load_dwordx4 v[112:115], v3, s[60:63], s87 offen offset:2048 sc1
    s_waitcnt vmcnt(10)
    v_mfma_f32_32x32x16_bf16 v[48:63], a[48:51], a[248:251], v[48:63]
    ds_write_b128 v123, v[40:43] offset:0
    v_mfma_f32_32x32x16_bf16 v[64:79], a[52:55], a[248:251], v[64:79]
    buffer_load_dwordx4 v[116:119], v3, s[60:63], s87 offen offset:3072 sc1
    s_add_u32 s87, s87, 4096
    s_waitcnt vmcnt(10)
    v_mfma_f32_32x32x16_bf16 v[48:63], a[56:59], a[252:255], v[48:63]
    ds_write_b128 v123, v[44:47] offset:1024
    v_mfma_f32_32x32x16_bf16 v[64:79], a[60:63], a[252:255], v[64:79]
    buffer_load_dwordx4 a[224:227], v3, s[60:63], s87 offen offset:0 sc1
    s_waitcnt vmcnt(10)
    v_mfma_f32_32x32x16_bf16 v[48:63], a[64:67], v[80:83], v[48:63]
    s_waitcnt lgkmcnt(0)
    s_barrier
    ds_read_b128 v[32:35], v120 offset:0
    ds_read_b128 v[36:39], v120 offset:1024
    v_mfma_f32_32x32x16_bf16 v[64:79], a[68:71], v[80:83], v[64:79]
    buffer_load_dwordx4 a[228:231], v3, s[60:63], s87 offen offset:1024 sc1
    ds_read_b128 v[40:43], v120 offset:2048
    ds_read_b128 v[44:47], v120 offset:3072
    v_lshlrev_b32 v24, 16, v128
    s_waitcnt vmcnt(10)
    v_mfma_f32_32x32x16_bf16 v[48:63], a[72:75], v[84:87], v[48:63]
    v_and_b32 v25, s69, v128
    v_lshlrev_b32 v26, 16, v129
    v_and_b32 v27, s69, v129
    v_lshlrev_b32 v28, 16, v130
    v_and_b32 v29, s69, v130
    v_lshlrev_b32 v30, 16, v131
    v_mfma_f32_32x32x16_bf16 v[64:79], a[76:79], v[84:87], v[64:79]
    buffer_load_dwordx4 a[232:235], v3, s[60:63], s87 offen offset:2048 sc1
    v_and_b32 v31, s69, v131
    s_waitcnt lgkmcnt(2)
    v_add_f32 v16, v16, v32
    s_waitcnt vmcnt(10)
    v_mfma_f32_32x32x16_bf16 v[48:63], a[80:83], v[88:91], v[48:63]
    v_add_f32 v17, v17, v33
    v_add_f32 v18, v18, v34
    v_add_f32 v19, v19, v35
    ds_read_b128 v[32:35], v120 offset:4096
    v_add_f32 v20, v20, v36
    v_mfma_f32_32x32x16_bf16 v[64:79], a[84:87], v[88:91], v[64:79]
    buffer_load_dwordx4 a[236:239], v3, s[60:63], s87 offen offset:3072 sc1
    s_add_u32 s87, s87, 4096
    v_add_f32 v21, v21, v37
    v_add_f32 v22, v22, v38
    s_waitcnt vmcnt(10)
    v_mfma_f32_32x32x16_bf16 v[48:63], a[88:91], v[92:95], v[48:63]
    v_add_f32 v23, v23, v39
    ds_read_b128 v[36:39], v120 offset:5120
    s_waitcnt lgkmcnt(2)
    v_add_f32 v16, v16, v40
    v_add_f32 v17, v17, v41
    v_mfma_f32_32x32x16_bf16 v[64:79], a[92:95], v[92:95], v[64:79]
    buffer_load_dwordx4 a[240:243], v3, s[60:63], s87 offen offset:0 sc1
    v_add_f32 v18, v18, v42
    v_add_f32 v19, v19, v43
    v_add_f32 v20, v20, v44
    s_waitcnt vmcnt(10)
    v_mfma_f32_32x32x16_bf16 v[48:63], a[96:99], v[96:99], v[48:63]
    buffer_load_dwordx4 a[244:247], v3, s[60:63], s87 offen offset:1024 sc1
    v_add_f32 v21, v21, v45
    v_add_f32 v22, v22, v46
    v_add_f32 v23, v23, v47
    s_waitcnt lgkmcnt(0)
    v_mfma_f32_32x32x16_bf16 v[64:79], a[100:103], v[96:99], v[64:79]
    buffer_load_dwordx4 a[248:251], v3, s[60:63], s87 offen offset:2048 sc1
    v_add_f32 v16, v16, v32
    v_add_f32 v17, v17, v33
    v_add_f32 v18, v18, v34
    s_waitcnt vmcnt(11)
    v_mfma_f32_32x32x16_bf16 v[48:63], a[104:107], v[100:103], v[48:63]
    buffer_load_dwordx4 a[252:255], v3, s[60:63], s87 offen offset:3072 sc1
    s_add_u32 s87, s87, 4096
    v_add_f32 v19, v19, v35
    v_add_f32 v20, v20, v36
    v_add_f32 v21, v21, v37
    v_mfma_f32_32x32x16_bf16 v[64:79], a[108:111], v[100:103], v[64:79]
    buffer_load_dwordx4 v[80:83], v3, s[60:63], s87 offen offset:0 sc1
    v_add_f32 v22, v22, v38
    v_add_f32 v23, v23, v39
    v_fmac_f32 v24, v16, v136
    s_waitcnt vmcnt(12)
    v_mfma_f32_32x32x16_bf16 v[48:63], a[112:115], v[104:107], v[48:63]
    buffer_load_dwordx4 v[84:87], v3, s[60:63], s87 offen offset:1024 sc1
    v_fmac_f32 v25, v17, v136
    v_fmac_f32 v26, v18, v136
    v_fmac_f32 v27, v19, v136
    v_fmac_f32 v28, v20, v136
    v_mfma_f32_32x32x16_bf16 v[64:79], a[116:119], v[104:107], v[64:79]
    v_fmac_f32 v29, v21, v136
    v_fmac_f32 v30, v22, v136
    v_fmac_f32 v31, v23, v136
    v_add_f32 v138, v24, v25
    v_mul_f32 v139, v24, v24
    s_waitcnt vmcnt(12)
    v_mfma_f32_32x32x16_bf16 v[48:63], a[120:123], v[108:111], v[48:63]
    v_fmac_f32 v139, v25, v25
    v_add_f32 v138, v138, v26
    v_fmac_f32 v139, v26, v26
    v_add_f32 v138, v138, v27
    v_fmac_f32 v139, v27, v27
    v_add_f32 v138, v138, v28
    v_mfma_f32_32x32x16_bf16 v[64:79], a[124:127], v[108:111], v[64:79]
    v_fmac_f32 v139, v28, v28
    v_add_f32 v138, v138, v29
    v_fmac_f32 v139, v29, v29
    v_add_f32 v138, v138, v30
    v_fmac_f32 v139, v30, v30
    s_waitcnt vmcnt(11)
    v_mfma_f32_32x32x16_bf16 v[48:63], a[128:131], v[112:115], v[48:63]
    v_add_f32 v138, v138, v31
    v_fmac_f32 v139, v31, v31
    v_cvt_pk_bf16_f32 v32, v24, v25
    v_cvt_pk_bf16_f32 v33, v26, v27
    v_permlane32_swap_b32 v138, v139
    v_mfma_f32_32x32x16_bf16 v[64:79], a[132:135], v[112:115], v[64:79]
    v_add_f32 v138, v138, v139
    s_cmp_eq_u32 s46, 1
    s_cbranch_scc0 L40
    buffer_store_dword v138, v143, s[60:63], s84 offen
L40x:
    s_waitcnt vmcnt(11)
    v_mfma_f32_32x32x16_bf16 v[48:63], a[136:139], v[116:119], v[48:63]
    v_cvt_pk_bf16_f32 v34, v28, v29
    v_cvt_pk_bf16_f32 v35, v30, v31
    v_mfma_f32_32x32x16_bf16 v[64:79], a[140:143], v[116:119], v[64:79]
    ds_write_b64 v124, v[32:33] offset:0
    s_waitcnt vmcnt(10)
    v_mfma_f32_32x32x16_bf16 v[64:79], a[148:151], a[224:227], v[64:79]
    ds_write_b64 v124, v[34:35] offset:16
    s_waitcnt vmcnt(9)
    v_mfma_f32_32x32x16_bf16 v[64:79], a[156:159], a[228:231], v[64:79]
    ds_read_b64_tr_b16 v[36:37], v125 offset:0
    ds_read_b64_tr_b16 v[38:39], v125 offset:160
    s_waitcnt vmcnt(8)
    v_mfma_f32_32x32x16_bf16 v[64:79], a[164:167], a[232:235], v[64:79]
    s_waitcnt vmcnt(7)
    v_mfma_f32_32x32x16_bf16 v[64:79], a[172:175], a[236:239], v[64:79]
    s_waitcnt vmcnt(6)
    v_mfma_f32_32x32x16_bf16 v[64:79], a[180:183], a[240:243], v[64:79]
    s_waitcnt lgkmcnt(0)
    buffer_store_dwordx4 v[36:39], v126, s[60:63], s80 offen sc1
    s_waitcnt vmcnt(6)
    v_mfma_f32_32x32x16_bf16 v[64:79], a[188:191], a[244:247], v[64:79]
    ds_read2_b32 v[16:17], v4 offset0:176 offset1:177
    ds_read2_b32 v[18:19], v4 offset0:178 offset1:179
    s_waitcnt vmcnt(5)
    v_mfma_f32_32x32x16_bf16 v[64:79], a[196:199], a[248:251], v[64:79]
    ds_read2_b32 v[20:21], v4 offset0:48 offset1:49
    ds_read2_b32 v[22:23], v4 offset0:50 offset1:51
    s_waitcnt vmcnt(4)
    v_mfma_f32_32x32x16_bf16 v[64:79], a[204:207], a[252:255], v[64:79]
    ds_read2_b32 v[24:25], v5 offset0:176 offset1:177
    ds_read2_b32 v[26:27], v5 offset0:178 offset1:179
    s_waitcnt vmcnt(3)
    v_mfma_f32_32x32x16_bf16 v[64:79], a[212:215], v[80:83], v[64:79]
    ds_read2_b32 v[28:29], v5 offset0:48 offset1:49
    ds_read2_b32 v[30:31], v5 offset0:50 offset1:51
    s_waitcnt vmcnt(2)
    v_mfma_f32_32x32x16_bf16 v[64:79], a[220:223], v[84:87], v[64:79]
    ds_read2_b32 v[32:33], v4 offset0:160 offset1:161
    ds_read2_b32 v[34:35], v4 offset0:162 offset1:163
    v_mfma_f32_32x32x16_bf16 v[48:63], a[144:147], a[224:227], v[48:63]
    ds_read2_b32 v[36:37], v4 offset0:32 offset1:33
    ds_read2_b32 v[38:39], v4 offset0:34 offset1:35
    ds_read2_b32 v[40:41], v5 offset0:160 offset1:161
    ds_read2_b32 v[42:43], v5 offset0:162 offset1:163
    ds_read2_b32 v[44:45], v5 offset0:32 offset1:33
    s_waitcnt lgkmcnt(13)
    ds_read2_b32 v[46:47], v5 offset0:34 offset1:35
    s_waitcnt lgkmcnt(2)
    v_mfma_f32_32x32x16_bf16 v[48:63], a[152:155], a[228:231], v[48:63]
    v_lshlrev_b32 v108, 16, v132
    v_and_b32 v109, s69, v132
    v_lshlrev_b32 v110, 16, v133
    v_and_b32 v111, s69, v133
    v_lshlrev_b32 v112, 16, v134
    v_and_b32 v113, s69, v134
    v_mfma_f32_32x32x16_bf16 v[48:63], a[160:163], a[232:235], v[48:63]
    v_lshlrev_b32 v114, 16, v135
    v_and_b32 v115, s69, v135
    v_mfma_f32_32x32x16_bf16 v[48:63], a[168:171], a[236:239], v[48:63]
    ds_write_b128 v122, v[64:67] offset:57344
    v_mfma_f32_32x32x16_bf16 v[48:63], a[176:179], a[240:243], v[48:63]
    v_mfma_f32_32x32x16_bf16 v[48:63], a[184:187], a[244:247], v[48:63]
    ds_write_b128 v122, v[68:71] offset:58368
    v_mfma_f32_32x32x16_bf16 v[48:63], a[192:195], a[248:251], v[48:63]
    v_mfma_f32_32x32x16_bf16 v[48:63], a[200:203], a[252:255], v[48:63]
    ds_write_b128 v123, v[72:75] offset:57344
    v_mfma_f32_32x32x16_bf16 v[48:63], a[208:211], v[80:83], v[48:63]
    v_mfma_f32_32x32x16_bf16 v[48:63], a[216:219], v[84:87], v[48:63]
    ds_write_b128 v123, v[76:79] offset:58368
    s_nop 10
    ds_write_b128 v121, v[56:59] offset:57344
    ds_write_b128 v121, v[60:63] offset:58368
    v_pk_fma_f32 v[108:109], v[48:49], v[136:137], v[108:109] op_sel:[0,1,0]
    v_pk_fma_f32 v[110:111], v[50:51], v[136:137], v[110:111] op_sel:[0,1,0]
    v_pk_fma_f32 v[112:113], v[52:53], v[136:137], v[112:113] op_sel:[0,1,0]
    v_pk_fma_f32 v[114:115], v[54:55], v[136:137], v[114:115] op_sel:[0,1,0]
    s_waitcnt lgkmcnt(0)
    s_barrier
    ds_read_b128 v[56:59], v120 offset:57344
    ds_read_b128 v[60:63], v120 offset:58368
    ds_read_b128 v[64:67], v120 offset:59392
    ds_read_b128 v[68:71], v120 offset:60416
    ds_read_b128 v[72:75], v120 offset:61440
    ds_read_b128 v[76:79], v120 offset:62464
    s_mov_b32 s86, 9207808
    s_mov_b32 s87, 9211904
    s_mov_b32 s96, 7340032
    s_waitcnt lgkmcnt(5)
    v_pk_fma_f32 v[108:109], v[56:57], v[136:137], v[108:109] op_sel:[0,1,0]
    v_pk_fma_f32 v[110:111], v[58:59], v[136:137], v[110:111] op_sel:[0,1,0]
    s_waitcnt lgkmcnt(4)
    v_pk_fma_f32 v[112:113], v[60:61], v[136:137], v[112:113] op_sel:[0,1,0]
    v_pk_fma_f32 v[114:115], v[62:63], v[136:137], v[114:115] op_sel:[0,1,0]
    s_waitcnt lgkmcnt(3)
    v_pk_fma_f32 v[108:109], v[64:65], v[136:137], v[108:109] op_sel:[0,1,0]
    v_pk_fma_f32 v[110:111], v[66:67], v[136:137], v[110:111] op_sel:[0,1,0]
    s_waitcnt lgkmcnt(2)
    v_pk_fma_f32 v[112:113], v[68:69], v[136:137], v[112:113] op_sel:[0,1,0]
    v_pk_fma_f32 v[114:115], v[70:71], v[136:137], v[114:115] op_sel:[0,1,0]
    s_waitcnt lgkmcnt(1)
    v_pk_fma_f32 v[108:109], v[72:73], v[136:137], v[108:109] op_sel:[0,1,0]
    v_pk_fma_f32 v[110:111], v[74:75], v[136:137], v[110:111] op_sel:[0,1,0]
    s_waitcnt lgkmcnt(0)
    v_pk_fma_f32 v[112:113], v[76:77], v[136:137], v[112:113] op_sel:[0,1,0]
    v_pk_fma_f32 v[114:115], v[78:79], v[136:137], v[114:115] op_sel:[0,1,0]
    v_cvt_pk_bf16_f32 v116, v108, v109
    v_cvt_pk_bf16_f32 v117, v110, v111
    v_cvt_pk_bf16_f32 v118, v112, v113
    v_cvt_pk_bf16_f32 v119, v114, v115
    ds_write_b64 v124, v[116:117] offset:0
    ds_write_b64 v124, v[118:119] offset:16
    ds_read_b64_tr_b16 v[116:117], v125 offset:0
    ds_read_b64_tr_b16 v[118:119], v125 offset:160
    v_pk_add_f32 v[48:49], v[108:109], v[110:111]
    v_pk_mul_f32 v[50:51], v[108:109], v[108:109]
    v_pk_add_f32 v[52:53], v[112:113], v[114:115]
    v_pk_fma_f32 v[50:51], v[110:111], v[110:111], v[50:51]
    v_pk_add_f32 v[48:49], v[48:49], v[52:53]
    v_pk_fma_f32 v[50:51], v[112:113], v[112:113], v[50:51]
    v_add_f32 v138, v48, v49
    v_pk_fma_f32 v[50:51], v[114:115], v[114:115], v[50:51]
    v_add_f32 v139, v50, v51
    s_cmp_eq_u32 s46, 1
    s_nop 0
    v_permlane32_swap_b32 v138, v139
    v_add_f32 v138, v138, v139
    s_cbranch_scc0 L41
    buffer_store_dword v138, v143, s[60:63], s85 offen
L41x:
    s_waitcnt lgkmcnt(0)
    buffer_store_dwordx4 v[116:119], v126, s[60:63], s81 offen sc1
    ds_read2_b32 v[48:49], v4 offset0:144 offset1:145
    ds_read2_b32 v[50:51], v4 offset0:146 offset1:147
    ds_read2_b32 v[52:53], v4 offset0:16 offset1:17
    ds_read2_b32 v[54:55], v4 offset0:18 offset1:19
    ds_read2_b32 v[56:57], v5 offset0:144 offset1:145
    ds_read2_b32 v[58:59], v5 offset0:146 offset1:147
    ds_read2_b32 v[60:61], v5 offset0:16 offset1:17
    ds_read2_b32 v[62:63], v5 offset0:18 offset1:19
    ds_read2_b32 v[64:65], v4 offset0:128 offset1:129
    ds_read2_b32 v[66:67], v4 offset0:130 offset1:131
    ds_read2_b32 v[68:69], v4 offset0:0 offset1:1
    ds_read2_b32 v[70:71], v4 offset0:2 offset1:3
    ds_read2_b32 v[72:73], v5 offset0:128 offset1:129
    ds_read2_b32 v[74:75], v5 offset0:130 offset1:131
    ds_read2_b32 v[76:77], v5 offset0:0 offset1:1
    s_waitcnt lgkmcnt(13)
    ds_read2_b32 v[78:79], v5 offset0:2 offset1:3
    buffer_load_dwordx4 v[96:99], v0, s[60:63], s86 offen sc1
    buffer_load_dwordx4 v[100:103], v0, s[60:63], s87 offen sc1
    buffer_load_dwordx2 v[104:105], v11, s[60:63], s96 offen sc1
    buffer_load_dwordx2 v[106:107], v11, s[60:63], s96 offen offset:64 sc1
    s_waitcnt vmcnt(0)
    v_max3_u32 v136, v96, v97, v98
    v_max3_u32 v136, v136, v99, v100
    v_max3_u32 v136, v136, v101, v102
    v_max3_u32 v136, v136, v103, v104
    v_max3_u32 v136, v136, v105, v106
    v_max_u32 v136, v136, v107
    v_cmp_eq_u32 vcc, -1, v136
    s_cbranch_vccnz L42
L43:
    v_lshlrev_b32 v108, 16, v104
    v_and_b32 v109, s69, v104
    v_lshlrev_b32 v110, 16, v105
    v_and_b32 v111, s69, v105
    v_lshlrev_b32 v112, 16, v106
    v_and_b32 v113, s69, v106
    v_lshlrev_b32 v114, 16, v107
    v_and_b32 v115, s69, v107
    v_fma_f32 v136, v108, v97, v96
    v_fma_f32 v137, v109, v99, v98
    v_fma_f32 v138, v110, v101, v100
    v_fma_f32 v139, v111, v103, v102
    v_cvt_pk_bf16_f32 v104, v136, v137
    v_cvt_pk_bf16_f32 v105, v138, v139
    ds_write_b64 v12, v[104:105] offset:0
    v_fma_f32 v140, v112, v97, v96
    v_fma_f32 v141, v113, v99, v98
    v_fma_f32 v142, v114, v101, v100
    v_fma_f32 v143, v115, v103, v102
    v_cvt_pk_bf16_f32 v106, v140, v141
    v_cvt_pk_bf16_f32 v107, v142, v143
    s_waitcnt lgkmcnt(13)
    ds_write_b64 v12, v[106:107] offset:4608
    s_waitcnt lgkmcnt(0)
    s_barrier
    ds_read_b128 v[80:83], v8 offset:192
    ds_read_b128 v[84:87], v8 offset:704
    ds_read_b128 v[88:91], v8 offset:1216
    ds_read_b128 v[92:95], v8 offset:1728
    ds_read_b128 v[96:99], v8 offset:128
    ds_read_b128 v[100:103], v8 offset:640
    ds_read_b128 v[104:107], v8 offset:1152
    s_waitcnt lgkmcnt(6)
    v_mfma_f32_16x16x32_bf16 a[224:227], v[16:19], v[80:83], 0
    v_fmac_f32 v108, s44, v136
    v_fmac_f32 v109, s44, v137
    s_waitcnt lgkmcnt(5)
    v_mfma_f32_16x16x32_bf16 a[228:231], v[16:19], v[84:87], 0
    v_fmac_f32 v110, s44, v138
    v_fmac_f32 v111, s44, v139
    v_mfma_f32_16x16x32_bf16 a[228:231], v[20:23], v[80:83], a[228:231]
    v_fmac_f32 v112, s45, v140
    v_fmac_f32 v113, s45, v141
    s_waitcnt lgkmcnt(4)
    v_mfma_f32_16x16x32_bf16 a[232:235], v[16:19], v[88:91], 0
    v_fmac_f32 v114, s45, v142
    v_fmac_f32 v115, s45, v143
    v_mfma_f32_16x16x32_bf16 a[232:235], v[20:23], v[84:87], a[232:235]
    v_mfma_f32_16x16x32_bf16 a[232:235], v[24:27], v[80:83], a[232:235]
    s_waitcnt lgkmcnt(3)
    v_mfma_f32_16x16x32_bf16 a[236:239], v[16:19], v[92:95], 0
    ds_read_b128 v[92:95], v8 offset:1664
    v_mfma_f32_16x16x32_bf16 a[236:239], v[20:23], v[88:91], a[236:239]
    ds_read_b128 v[88:91], v8 offset:64
    v_mfma_f32_16x16x32_bf16 a[236:239], v[24:27], v[84:87], a[236:239]
    ds_read_b128 v[84:87], v8 offset:576
    v_mfma_f32_16x16x32_bf16 a[236:239], v[28:31], v[80:83], a[236:239]
    ds_read_b128 v[80:83], v8 offset:1088
    s_waitcnt lgkmcnt(6)
    v_mfma_f32_16x16x32_bf16 a[224:227], v[32:35], v[96:99], a[224:227]
    s_waitcnt lgkmcnt(5)
    v_mfma_f32_16x16x32_bf16 a[228:231], v[32:35], v[100:103], a[228:231]
    v_mfma_f32_16x16x32_bf16 a[228:231], v[36:39], v[96:99], a[228:231]
    s_waitcnt lgkmcnt(4)
    v_mfma_f32_16x16x32_bf16 a[232:235], v[32:35], v[104:107], a[232:235]
    v_mfma_f32_16x16x32_bf16 a[232:235], v[36:39], v[100:103], a[232:235]
    v_mfma_f32_16x16x32_bf16 a[232:235], v[40:43], v[96:99], a[232:235]
    s_waitcnt lgkmcnt(3)
    v_mfma_f32_16x16x32_bf16 a[236:239], v[32:35], v[92:95], a[236:239]
    ds_read_b128 v[92:95], v8 offset:1600
    v_mfma_f32_16x16x32_bf16 a[236:239], v[36:39], v[104:107], a[236:239]
    ds_read_b128 v[104:107], v8 offset:0
    v_mfma_f32_16x16x32_bf16 a[236:239], v[40:43], v[100:103], a[236:239]
    ds_read_b128 v[100:103], v8 offset:512
    v_mfma_f32_16x16x32_bf16 a[236:239], v[44:47], v[96:99], a[236:239]
    ds_read_b128 v[96:99], v8 offset:1024
    s_waitcnt lgkmcnt(6)
    v_mfma_f32_16x16x32_bf16 a[224:227], v[48:51], v[88:91], a[224:227]
    s_waitcnt lgkmcnt(5)
    v_mfma_f32_16x16x32_bf16 a[228:231], v[48:51], v[84:87], a[228:231]
    v_mfma_f32_16x16x32_bf16 a[228:231], v[52:55], v[88:91], a[228:231]
    s_waitcnt lgkmcnt(4)
    v_mfma_f32_16x16x32_bf16 a[232:235], v[48:51], v[80:83], a[232:235]
    v_mfma_f32_16x16x32_bf16 a[232:235], v[52:55], v[84:87], a[232:235]
    v_mfma_f32_16x16x32_bf16 a[232:235], v[56:59], v[88:91], a[232:235]
    s_waitcnt lgkmcnt(3)
    v_mfma_f32_16x16x32_bf16 a[236:239], v[48:51], v[92:95], a[236:239]
    ds_read_b128 v[92:95], v8 offset:1536
    v_mfma_f32_16x16x32_bf16 a[236:239], v[52:55], v[80:83], a[236:239]
    ds_read_b128 v[80:83], v8 offset:1728
    v_mfma_f32_16x16x32_bf16 a[236:239], v[56:59], v[84:87], a[236:239]
    s_mov_b32 s86, 9216000
    s_mov_b32 s87, 9220096
    s_mov_b32 s96, 8265728
    buffer_load_dwordx4 v[124:127], v0, s[60:63], s86 offen sc1
    buffer_load_dwordx4 v[128:131], v0, s[60:63], s87 offen sc1
    buffer_load_dwordx2 v[132:133], v11, s[60:63], s96 offen sc1
    buffer_load_dwordx2 v[134:135], v11, s[60:63], s96 offen offset:64 sc1
    ds_read2_b32 v[84:85], v6 offset0:176 offset1:177
    v_mfma_f32_16x16x32_bf16 a[236:239], v[60:63], v[88:91], a[236:239]
    ds_read2_b32 v[86:87], v6 offset0:178 offset1:179
    s_waitcnt lgkmcnt(6)
    v_mfma_f32_16x16x32_bf16 a[224:227], v[64:67], v[104:107], a[224:227]
    ds_read_b128 v[88:91], v8 offset:1216
    s_waitcnt lgkmcnt(6)
    v_mfma_f32_16x16x32_bf16 a[228:231], v[64:67], v[100:103], a[228:231]
    v_mfma_f32_16x16x32_bf16 a[228:231], v[68:71], v[104:107], a[228:231]
    s_waitcnt lgkmcnt(5)
    v_mfma_f32_16x16x32_bf16 a[232:235], v[64:67], v[96:99], a[232:235]
    v_mfma_f32_16x16x32_bf16 a[232:235], v[68:71], v[100:103], a[232:235]
    s_nop 0
    ds_write_b128 v9, a[224:227] offset:0
    v_mfma_f32_16x16x32_bf16 a[232:235], v[72:75], v[104:107], a[232:235]
    s_waitcnt lgkmcnt(5)
    v_mfma_f32_16x16x32_bf16 a[236:239], v[64:67], v[92:95], a[236:239]
    ds_write_b128 v9, a[228:231] offset:256
    v_mfma_f32_16x16x32_bf16 a[236:239], v[68:71], v[96:99], a[236:239]
    ds_read2_b32 v[92:93], v6 offset0:48 offset1:49
    v_mfma_f32_16x16x32_bf16 a[236:239], v[72:75], v[100:103], a[236:239]
    ds_read2_b32 v[94:95], v6 offset0:50 offset1:51
    v_mfma_f32_16x16x32_bf16 a[236:239], v[76:79], v[104:107], a[236:239]
    ds_write_b128 v9, a[232:235] offset:512
    s_waitcnt lgkmcnt(8)
    v_mfma_f32_16x16x32_bf16 a[240:243], v[20:23], v[80:83], 0
    ds_read_b128 v[96:99], v8 offset:704
    v_mfma_f32_16x16x32_bf16 a[244:247], v[24:27], v[80:83], 0
    ds_read2_b32 v[100:101], v7 offset0:176 offset1:177
    v_mfma_f32_16x16x32_bf16 a[248:251], v[28:31], v[80:83], 0
    ds_read2_b32 v[102:103], v7 offset0:178 offset1:179
    s_waitcnt lgkmcnt(9)
    v_mfma_f32_16x16x32_bf16 a[252:255], v[84:87], v[80:83], 0
    ds_write_b128 v9, a[236:239] offset:768
    s_waitcnt lgkmcnt(9)
    v_mfma_f32_16x16x32_bf16 a[240:243], v[24:27], v[88:91], a[240:243]
    ds_read_b128 v[104:107], v8 offset:192
    v_mfma_f32_16x16x32_bf16 a[244:247], v[28:31], v[88:91], a[244:247]
    ds_read2_b32 v[80:81], v7 offset0:48 offset1:49
    v_mfma_f32_16x16x32_bf16 a[248:251], v[84:87], v[88:91], a[248:251]
    s_waitcnt lgkmcnt(2)
    s_barrier
    s_mov_b32 s85, 5242880
    ds_read_b128 v[136:139], v10 offset:0
    v_mfma_f32_16x16x32_bf16 a[252:255], v[92:95], v[88:91], a[252:255]
    ds_read_b128 v[140:143], v10 offset:4352
    v_mfma_f32_16x16x32_bf16 a[240:243], v[28:31], v[96:99], a[240:243]
    ds_read_b128 v[116:119], v10 offset:8704
    v_mfma_f32_16x16x32_bf16 a[244:247], v[84:87], v[96:99], a[244:247]
    ds_read_b128 v[120:123], v10 offset:13056
    v_mfma_f32_16x16x32_bf16 a[248:251], v[92:95], v[96:99], a[248:251]
    ds_read2_b32 v[82:83], v7 offset0:50 offset1:51
    v_mfma_f32_16x16x32_bf16 a[252:255], v[100:103], v[96:99], a[252:255]
    ds_read_b128 a[224:227], v8 offset:1664
    s_waitcnt lgkmcnt(5)
    v_add_f32 v108, v108, v136
    v_mfma_f32_16x16x32_bf16 a[240:243], v[84:87], v[104:107], a[240:243]
    v_add_f32 v109, v109, v137
    v_add_f32 v110, v110, v138
    v_add_f32 v111, v111, v139
    s_waitcnt lgkmcnt(4)
    v_add_f32 v108, v108, v140
    v_add_f32 v109, v109, v141
    ds_read2_b32 a[228:229], v6 offset0:160 offset1:161
    v_mfma_f32_16x16x32_bf16 a[244:247], v[92:95], v[104:107], a[244:247]
    v_add_f32 v110, v110, v142
    v_add_f32 v111, v111, v143
    v_cvt_pk_bf16_f32 v108, v108, v109
    v_cvt_pk_bf16_f32 v109, v110, v111
    ds_read2_b32 a[230:231], v6 offset0:162 offset1:163
    v_mfma_f32_16x16x32_bf16 a[248:251], v[100:103], v[104:107], a[248:251]
    buffer_store_dwordx2 v[108:109], v11, s[60:63], s85 offen offset:0 sc1
    s_waitcnt lgkmcnt(5)
    v_add_f32 v112, v112, v116
    v_add_f32 v113, v113, v117
    ds_read_b128 a[232:235], v8 offset:1152
    s_waitcnt lgkmcnt(4)
    v_mfma_f32_16x16x32_bf16 a[252:255], v[80:83], v[104:107], a[252:255]
    v_add_f32 v114, v114, v118
    v_add_f32 v115, v115, v119
    v_add_f32 v112, v112, v120
    v_add_f32 v113, v113, v121
    v_add_f32 v114, v114, v122
    ds_read2_b32 a[236:237], v6 offset0:32 offset1:33
    s_waitcnt lgkmcnt(4)
    v_mfma_f32_16x16x32_bf16 a[240:243], v[36:39], a[224:227], a[240:243]
    v_add_f32 v115, v115, v123
    v_cvt_pk_bf16_f32 v112, v112, v113
    v_cvt_pk_bf16_f32 v113, v114, v115
    ds_read2_b32 a[238:239], v6 offset0:34 offset1:35
    v_mfma_f32_16x16x32_bf16 a[244:247], v[40:43], a[224:227], a[244:247]
    buffer_store_dwordx2 v[112:113], v11, s[60:63], s85 offen offset:64 sc1
    ds_read_b128 v[88:91], v8 offset:640
    v_mfma_f32_16x16x32_bf16 a[248:251], v[44:47], a[224:227], a[248:251]
    ds_read2_b32 v[96:97], v7 offset0:160 offset1:161
    s_waitcnt lgkmcnt(5)
    v_mfma_f32_16x16x32_bf16 a[252:255], a[228:231], a[224:227], a[252:255]
    ds_read2_b32 v[98:99], v7 offset0:162 offset1:163
    s_waitcnt lgkmcnt(5)
    v_mfma_f32_16x16x32_bf16 a[240:243], v[40:43], a[232:235], a[240:243]
    ds_read_b128 v[84:87], v8 offset:128
    v_mfma_f32_16x16x32_bf16 a[244:247], v[44:47], a[232:235], a[244:247]
    ds_read2_b32 v[92:93], v7 offset0:32 offset1:33
    v_mfma_f32_16x16x32_bf16 a[248:251], a[228:231], a[232:235], a[248:251]
    ds_read2_b32 v[94:95], v7 offset0:34 offset1:35
    s_waitcnt lgkmcnt(6)
    v_mfma_f32_16x16x32_bf16 a[252:255], a[236:239], a[232:235], a[252:255]
    ds_read_b128 v[100:103], v8 offset:1600
    s_waitcnt lgkmcnt(6)
    v_mfma_f32_16x16x32_bf16 a[240:243], v[44:47], v[88:91], a[240:243]
    ds_read2_b32 v[80:81], v6 offset0:144 offset1:145
    v_mfma_f32_16x16x32_bf16 a[244:247], a[228:231], v[88:91], a[244:247]
    ds_read2_b32 v[82:83], v6 offset0:146 offset1:147
    v_mfma_f32_16x16x32_bf16 a[248:251], a[236:239], v[88:91], a[248:251]
    ds_read_b128 v[104:107], v8 offset:1088
    s_waitcnt lgkmcnt(7)
    v_mfma_f32_16x16x32_bf16 a[252:255], v[96:99], v[88:91], a[252:255]
    ds_read2_b32 a[224:225], v6 offset0:16 offset1:17
    s_waitcnt lgkmcnt(7)
    v_mfma_f32_16x16x32_bf16 a[240:243], a[228:231], v[84:87], a[240:243]
    ds_read2_b32 a[226:227], v6 offset0:18 offset1:19
    v_mfma_f32_16x16x32_bf16 a[244:247], a[236:239], v[84:87], a[244:247]
    ds_read_b128 a[232:235], v8 offset:576
    v_mfma_f32_16x16x32_bf16 a[248:251], v[96:99], v[84:87], a[248:251]
    ds_read2_b32 v[88:89], v7 offset0:144 offset1:145
    s_waitcnt lgkmcnt(8)
    v_mfma_f32_16x16x32_bf16 a[252:255], v[92:95], v[84:87], a[252:255]
    ds_read2_b32 v[90:91], v7 offset0:146 offset1:147
    s_waitcnt lgkmcnt(8)
    v_mfma_f32_16x16x32_bf16 a[240:243], v[52:55], v[100:103], a[240:243]
    ds_read_b128 a[228:231], v8 offset:64
    v_mfma_f32_16x16x32_bf16 a[244:247], v[56:59], v[100:103], a[244:247]
    ds_read2_b32 a[236:237], v7 offset0:16 offset1:17
    v_mfma_f32_16x16x32_bf16 a[248:251], v[60:63], v[100:103], a[248:251]
    ds_read2_b32 a[238:239], v7 offset0:18 offset1:19
    s_waitcnt lgkmcnt(9)
    v_mfma_f32_16x16x32_bf16 a[252:255], v[80:83], v[100:103], a[252:255]
    ds_read_b128 v[96:99], v8 offset:1536
    s_waitcnt lgkmcnt(9)
    v_mfma_f32_16x16x32_bf16 a[240:243], v[56:59], v[104:107], a[240:243]
    ds_read2_b32 v[92:93], v6 offset0:128 offset1:129
    s_waitcnt vmcnt(2)
    v_max3_u32 v136, v124, v125, v126
    v_mfma_f32_16x16x32_bf16 a[244:247], v[60:63], v[104:107], a[244:247]
    ds_read2_b32 v[94:95], v6 offset0:130 offset1:131
    v_max3_u32 v136, v136, v127, v128
    v_mfma_f32_16x16x32_bf16 a[248:251], v[80:83], v[104:107], a[248:251]
    ds_read_b128 v[84:87], v8 offset:1024
    v_max3_u32 v136, v136, v129, v130
    v_max3_u32 v136, v136, v131, v132
    s_waitcnt lgkmcnt(10)
    v_mfma_f32_16x16x32_bf16 a[252:255], a[224:227], v[104:107], a[252:255]
    ds_read2_b32 v[100:101], v6 offset0:0 offset1:1
    v_max3_u32 v136, v136, v133, v134
    v_max_u32 v136, v136, v135
    s_waitcnt lgkmcnt(10)
    v_mfma_f32_16x16x32_bf16 a[240:243], v[60:63], a[232:235], a[240:243]
    ds_read2_b32 v[102:103], v6 offset0:2 offset1:3
    v_cmp_eq_u32 vcc, -1, v136
    v_mfma_f32_16x16x32_bf16 a[244:247], v[80:83], a[232:235], a[244:247]
    ds_read_b128 v[104:107], v8 offset:512
    v_mfma_f32_16x16x32_bf16 a[248:251], a[224:227], a[232:235], a[248:251]
    s_cbranch_vccnz L44
L45:
    s_waitcnt lgkmcnt(10)
    v_mfma_f32_16x16x32_bf16 a[252:255], v[88:91], a[232:235], a[252:255]
    ds_read2_b32 a[232:233], v7 offset0:128 offset1:129
    v_lshlrev_b32 v116, 16, v132
    v_and_b32 v117, s69, v132
    s_waitcnt lgkmcnt(10)
    v_mfma_f32_16x16x32_bf16 a[240:243], v[80:83], a[228:231], a[240:243]
    ds_read2_b32 a[234:235], v7 offset0:130 offset1:131
    v_lshlrev_b32 v118, 16, v133
    v_and_b32 v119, s69, v133
    v_mfma_f32_16x16x32_bf16 a[244:247], a[224:227], a[228:231], a[244:247]
    ds_read_b128 v[80:83], v8 offset:0
    v_lshlrev_b32 v120, 16, v134
    v_and_b32 v121, s69, v134
    v_mfma_f32_16x16x32_bf16 a[248:251], v[88:91], a[228:231], a[248:251]
    ds_read2_b32 a[224:225], v7 offset0:0 offset1:1
    v_lshlrev_b32 v122, 16, v135
    v_and_b32 v123, s69, v135
    s_waitcnt lgkmcnt(11)
    v_mfma_f32_16x16x32_bf16 a[252:255], a[236:239], a[228:231], a[252:255]
    ds_read2_b32 a[226:227], v7 offset0:2 offset1:3
    v_fma_f32 v136, v116, v125, v124
    v_fma_f32 v137, v117, v127, v126
    s_waitcnt lgkmcnt(11)
    v_mfma_f32_16x16x32_bf16 a[240:243], v[68:71], v[96:99], a[240:243]
    v_fma_f32 v138, v118, v129, v128
    v_fma_f32 v139, v119, v131, v130
    v_mfma_f32_16x16x32_bf16 a[244:247], v[72:75], v[96:99], a[244:247]
    v_cvt_pk_bf16_f32 v132, v136, v137
    v_cvt_pk_bf16_f32 v133, v138, v139
    v_mfma_f32_16x16x32_bf16 a[248:251], v[76:79], v[96:99], a[248:251]
    ds_write_b64 v12, v[132:133] offset:2048
    s_waitcnt lgkmcnt(10)
    v_mfma_f32_16x16x32_bf16 a[252:255], v[92:95], v[96:99], a[252:255]
    v_fma_f32 v140, v120, v125, v124
    s_waitcnt lgkmcnt(9)
    v_mfma_f32_16x16x32_bf16 a[240:243], v[72:75], v[84:87], a[240:243]
    v_fma_f32 v141, v121, v127, v126
    v_mfma_f32_16x16x32_bf16 a[244:247], v[76:79], v[84:87], a[244:247]
    v_fma_f32 v142, v122, v129, v128
    v_mfma_f32_16x16x32_bf16 a[248:251], v[92:95], v[84:87], a[248:251]
    v_fma_f32 v143, v123, v131, v130
    v_cvt_pk_bf16_f32 v134, v140, v141
    s_waitcnt lgkmcnt(7)
    v_mfma_f32_16x16x32_bf16 a[252:255], v[100:103], v[84:87], a[252:255]
    s_add_u32 m0, s68, 0
    v_cvt_pk_bf16_f32 v135, v142, v143
    s_waitcnt lgkmcnt(6)
    v_mfma_f32_16x16x32_bf16 a[240:243], v[76:79], v[104:107], a[240:243]
    s_xor_b32 s76, s78, 0
    ds_write_b64 v12, v[134:135] offset:6656
    v_mfma_f32_16x16x32_bf16 a[244:247], v[92:95], v[104:107], a[244:247]
    s_mul_i32 s76, s76, 28928
    v_mfma_f32_16x16x32_bf16 a[248:251], v[100:103], v[104:107], a[248:251]
    s_add_u32 s76, s76, s68
    s_waitcnt lgkmcnt(0)
    s_barrier
    v_mfma_f32_16x16x32_bf16 a[252:255], a[232:235], v[104:107], a[252:255]
    ds_read_b128 v[88:91], v8 offset:2240
    s_add_u32 s76, s76, 5242880
    v_mfma_f32_16x16x32_bf16 a[240:243], v[92:95], v[80:83], a[240:243]
    ds_read_b128 a[236:239], v8 offset:2752
    buffer_load_dwordx4 v3, s[60:63], s76 offen offset:0 sc1 lds
    v_mfma_f32_16x16x32_bf16 a[244:247], v[100:103], v[80:83], a[244:247]
    ds_read_b128 a[228:231], v8 offset:3264
    v_fmac_f32 v116, s44, v136
    v_mfma_f32_16x16x32_bf16 a[248:251], a[232:235], v[80:83], a[248:251]
    ds_read_b128 v[96:99], v8 offset:3776
    v_fmac_f32 v117, s44, v137
    v_mfma_f32_16x16x32_bf16 a[252:255], a[224:227], v[80:83], a[252:255]
    ds_read_b128 v[84:87], v8 offset:2176
    v_fmac_f32 v118, s44, v138
    s_waitcnt lgkmcnt(4)
    v_mfma_f32_16x16x32_bf16 a[240:243], v[16:19], v[88:91], a[240:243]
    ds_read_b128 v[104:107], v8 offset:2688
    buffer_load_dwordx4 v3, s[60:63], s76 offen offset:1024 sc1 lds
    s_waitcnt lgkmcnt(4)
    v_mfma_f32_16x16x32_bf16 a[244:247], v[16:19], a[236:239], a[244:247]
    ds_read_b128 v[92:95], v8 offset:3200
    v_fmac_f32 v119, s44, v139
    v_mfma_f32_16x16x32_bf16 a[244:247], v[20:23], v[88:91], a[244:247]
    ds_read_b128 v[100:103], v8 offset:3712
    v_fmac_f32 v120, s45, v140
    s_waitcnt lgkmcnt(5)
    v_mfma_f32_16x16x32_bf16 a[248:251], v[16:19], a[228:231], a[248:251]
    ds_read_b128 a[232:235], v8 offset:2112
    v_fmac_f32 v121, s45, v141
    v_mfma_f32_16x16x32_bf16 a[248:251], v[20:23], a[236:239], a[248:251]
    ds_read_b128 a[224:227], v8 offset:2624
    buffer_load_dwordx4 v3, s[60:63], s76 offen offset:2048 sc1 lds
    v_mfma_f32_16x16x32_bf16 a[248:251], v[24:27], v[88:91], a[248:251]
    ds_read_b128 v[80:83], v8 offset:3136
    v_fmac_f32 v122, s45, v142
    s_waitcnt lgkmcnt(7)
    v_mfma_f32_16x16x32_bf16 a[252:255], v[16:19], v[96:99], a[252:255]
    ds_read_b128 v[96:99], v8 offset:3648
    v_fmac_f32 v123, s45, v143
    v_mfma_f32_16x16x32_bf16 a[252:255], v[20:23], a[228:231], a[252:255]
    ds_read_b128 a[228:231], v8 offset:2048
    v_mfma_f32_16x16x32_bf16 a[252:255], v[24:27], a[236:239], a[252:255]
    ds_read_b128 a[236:239], v8 offset:2560
    buffer_load_dwordx4 v3, s[60:63], s76 offen offset:3072 sc1 lds
    v_mfma_f32_16x16x32_bf16 a[252:255], v[28:31], v[88:91], a[252:255]
    ds_read_b128 v[88:91], v8 offset:3072
    s_add_u32 m0, s68, 4096
    s_waitcnt lgkmcnt(10)
    v_mfma_f32_16x16x32_bf16 a[240:243], v[32:35], v[84:87], a[240:243]
    s_add_u32 s76, s76, 4096
    s_waitcnt lgkmcnt(9)
    v_mfma_f32_16x16x32_bf16 a[244:247], v[32:35], v[104:107], a[244:247]
    v_mfma_f32_16x16x32_bf16 a[244:247], v[36:39], v[84:87], a[244:247]
    buffer_load_dwordx4 v3, s[60:63], s76 offen offset:0 sc1 lds
    s_waitcnt lgkmcnt(8)
    v_mfma_f32_16x16x32_bf16 a[248:251], v[32:35], v[92:95], a[248:251]
    v_mfma_f32_16x16x32_bf16 a[248:251], v[36:39], v[104:107], a[248:251]
    v_mfma_f32_16x16x32_bf16 a[248:251], v[40:43], v[84:87], a[248:251]
    s_waitcnt lgkmcnt(7)
    v_mfma_f32_16x16x32_bf16 a[252:255], v[32:35], v[100:103], a[252:255]
    ds_read_b128 v[100:103], v8 offset:3584
    buffer_load_dwordx4 v3, s[60:63], s76 offen offset:1024 sc1 lds
    v_mfma_f32_16x16x32_bf16 a[252:255], v[36:39], v[92:95], a[252:255]
    v_mfma_f32_16x16x32_bf16 a[252:255], v[40:43], v[104:107], a[252:255]
    v_mfma_f32_16x16x32_bf16 a[252:255], v[44:47], v[84:87], a[252:255]
    s_waitcnt lgkmcnt(7)
    v_mfma_f32_16x16x32_bf16 a[240:243], v[48:51], a[232:235], a[240:243]
    buffer_load_dwordx4 v3, s[60:63], s76 offen offset:2048 sc1 lds
    s_waitcnt lgkmcnt(6)
    v_mfma_f32_16x16x32_bf16 a[244:247], v[48:51], a[224:227], a[244:247]
    v_mfma_f32_16x16x32_bf16 a[244:247], v[52:55], a[232:235], a[244:247]
    s_add_u32 s80, s64, 16777216
    s_waitcnt lgkmcnt(5)
    v_mfma_f32_16x16x32_bf16 a[248:251], v[48:51], v[80:83], a[248:251]
    s_add_u32 s81, s65, 16777216
    v_mfma_f32_16x16x32_bf16 a[248:251], v[52:55], a[224:227], a[248:251]
    s_add_u32 s82, s64, 20709376
    v_mfma_f32_16x16x32_bf16 a[248:251], v[56:59], a[232:235], a[248:251]
    s_add_u32 s83, s65, 20709376
    s_waitcnt lgkmcnt(4)
    v_mfma_f32_16x16x32_bf16 a[252:255], v[48:51], v[96:99], a[252:255]
    s_add_u32 s74, s66, 16777216
    v_mfma_f32_16x16x32_bf16 a[252:255], v[52:55], v[80:83], a[252:255]
    s_add_u32 s75, s67, 16777216
    v_mfma_f32_16x16x32_bf16 a[252:255], v[56:59], a[224:227], a[252:255]
    s_add_u32 s86, s66, 20709376
    v_mfma_f32_16x16x32_bf16 a[252:255], v[60:63], a[232:235], a[252:255]
    s_add_u32 s87, s67, 20709376
    s_waitcnt lgkmcnt(3)
    v_mfma_f32_16x16x32_bf16 a[240:243], v[64:67], a[228:231], a[240:243]
    v_bfe_u32 v128, v1, 1, 3
    s_waitcnt lgkmcnt(2)
    v_mfma_f32_16x16x32_bf16 a[244:247], v[64:67], a[236:239], a[244:247]
    v_lshl_add_u32 v128, v128, 2, s68
    v_mfma_f32_16x16x32_bf16 a[244:247], v[68:71], a[228:231], a[244:247]
    v_lshl_add_u32 v132, v1, 6, v128
    s_waitcnt lgkmcnt(1)
    v_mfma_f32_16x16x32_bf16 a[248:251], v[64:67], v[88:91], a[248:251]
    v_min_u32 v133, 47, v1
    v_mfma_f32_16x16x32_bf16 a[248:251], v[68:71], a[236:239], a[248:251]
    ds_write_b128 v9, a[240:243] offset:0
    v_lshl_add_u32 v133, v133, 6, v128
    v_mfma_f32_16x16x32_bf16 a[248:251], v[72:75], a[228:231], a[248:251]
    v_add_u32 v133, 4096, v133
    s_waitcnt lgkmcnt(1)
    v_mfma_f32_16x16x32_bf16 a[252:255], v[64:67], v[100:103], a[252:255]
    ds_write_b128 v9, a[244:247] offset:256
    v_mfma_f32_16x16x32_bf16 a[252:255], v[68:71], v[88:91], a[252:255]
    v_mfma_f32_16x16x32_bf16 a[252:255], v[72:75], a[236:239], a[252:255]
    v_mfma_f32_16x16x32_bf16 a[252:255], v[76:79], a[228:231], a[252:255]
    s_nop 0
    ds_write_b128 v9, a[248:251] offset:512
    s_nop 5
    ds_write_b128 v9, a[252:255] offset:768
    s_waitcnt lgkmcnt(0)
    s_barrier
    s_mov_b32 s85, 6168576
    ds_read_b128 v[80:83], v10 offset:0
    ds_read_b128 v[84:87], v10 offset:4352
    ds_read_b128 v[88:91], v10 offset:8704
    ds_read_b128 v[92:95], v10 offset:13056
    s_waitcnt lgkmcnt(3)
    v_pk_add_f32 v[116:117], v[116:117], v[80:81]
    v_pk_add_f32 v[118:119], v[118:119], v[82:83]
    s_waitcnt lgkmcnt(2)
    v_pk_add_f32 v[116:117], v[116:117], v[84:85]
    v_pk_add_f32 v[118:119], v[118:119], v[86:87]
    v_cvt_pk_bf16_f32 v116, v116, v117
    v_cvt_pk_bf16_f32 v117, v118, v119
    buffer_store_dwordx2 v[116:117], v11, s[60:63], s85 offen offset:0 sc1
    s_waitcnt lgkmcnt(1)
    v_pk_add_f32 v[120:121], v[120:121], v[88:89]
    v_pk_add_f32 v[122:123], v[122:123], v[90:91]
    s_waitcnt lgkmcnt(0)
    v_pk_add_f32 v[120:121], v[120:121], v[92:93]
    v_pk_add_f32 v[122:123], v[122:123], v[94:95]
    v_cvt_pk_bf16_f32 v120, v120, v121
    v_cvt_pk_bf16_f32 v121, v122, v123
    buffer_store_dwordx2 v[120:121], v11, s[60:63], s85 offen offset:64 sc1
    s_add_u32 m0, s68, 28672
    s_xor_b32 s76, s78, 1
    s_mul_i32 s76, s76, 28928
    s_add_u32 s76, s76, s68
    s_add_u32 s76, s76, 5242880
    buffer_load_dwordx4 v3, s[60:63], s76 offen offset:0 sc1 lds
    v_add_u32 v44, 57344, v2
    s_waitcnt vmcnt(3)
    ds_read_b32 v128, v132 offset:0
    ds_read_b32 v129, v132 offset:32
    ds_read_b32 v130, v133 offset:0
    ds_read_b32 v131, v133 offset:32
    s_waitcnt lgkmcnt(0)
    v_max3_u32 v128, v128, v129, v130
    v_max_u32 v128, v128, v131
    v_cmp_eq_u32 vcc, -1, v128
    s_cbranch_vccnz L46
L47:
    s_barrier
    ds_read_b64_tr_b16 v[16:17], v2 offset:0
    ds_read_b64_tr_b16 v[18:19], v2 offset:512
    ds_read_b64_tr_b16 v[20:21], v2 offset:1024
    ds_read_b64_tr_b16 v[22:23], v2 offset:1536
    ds_read_b64_tr_b16 v[24:25], v2 offset:2048
    ds_read_b64_tr_b16 v[26:27], v2 offset:2560
    ds_read_b64_tr_b16 v[28:29], v2 offset:3072
    ds_read_b64_tr_b16 v[30:31], v2 offset:3584
    ds_read_b64_tr_b16 v[32:33], v2 offset:4096
    ds_read_b64_tr_b16 v[34:35], v2 offset:4608
    s_waitcnt lgkmcnt(6)
    v_mfma_f32_32x32x16_bf16 v[64:79], v[144:147], v[16:19], 0
    ds_read_b64_tr_b16 v[36:37], v2 offset:5120
    ds_read_b64_tr_b16 v[38:39], v2 offset:5632
    s_mov_b32 s3, 0x80008000
    v_mfma_f32_32x32x16_bf16 v[64:79], v[148:151], v[20:23], v[64:79]
    ds_read_b64_tr_b16 v[40:41], v2 offset:6144
    ds_read_b64_tr_b16 v[42:43], v2 offset:6656
    buffer_load_dwordx4 v3, s[60:63], s76 offen offset:1024 sc1 lds
    s_waitcnt lgkmcnt(6)
    v_mfma_f32_32x32x16_bf16 v[64:79], v[152:155], v[24:27], v[64:79]
    ds_read_b64_tr_b16 v[16:17], v2 offset:7168
    ds_read_b64_tr_b16 v[18:19], v2 offset:7680
    v_mfma_f32_32x32x16_bf16 v[64:79], v[156:159], v[28:31], v[64:79]
    ds_read_b64_tr_b16 v[20:21], v2 offset:8192
    ds_read_b64_tr_b16 v[22:23], v2 offset:8704
    buffer_load_dwordx4 v3, s[60:63], s76 offen offset:2048 sc1 lds
    s_waitcnt lgkmcnt(6)
    v_mfma_f32_32x32x16_bf16 v[64:79], v[160:163], v[32:35], v[64:79]
    ds_read_b64_tr_b16 v[24:25], v2 offset:9216
    ds_read_b64_tr_b16 v[26:27], v2 offset:9728
    v_mfma_f32_32x32x16_bf16 v[64:79], v[164:167], v[36:39], v[64:79]
    ds_read_b64_tr_b16 v[28:29], v2 offset:10240
    ds_read_b64_tr_b16 v[30:31], v2 offset:10752
    buffer_load_dwordx4 v3, s[60:63], s76 offen offset:3072 sc1 lds
    s_waitcnt lgkmcnt(6)
    v_mfma_f32_32x32x16_bf16 v[64:79], v[168:171], v[40:43], v[64:79]
    ds_read_b64_tr_b16 v[32:33], v2 offset:11264
    ds_read_b64_tr_b16 v[34:35], v2 offset:11776
    s_add_u32 m0, s68, 32768
    s_add_u32 s76, s76, 4096
    v_mfma_f32_32x32x16_bf16 v[64:79], v[172:175], v[16:19], v[64:79]
    ds_read_b64_tr_b16 v[36:37], v2 offset:12288
    ds_read_b64_tr_b16 v[38:39], v2 offset:12800
    buffer_load_dwordx4 v3, s[60:63], s76 offen offset:0 sc1 lds
    s_waitcnt lgkmcnt(6)
    v_mfma_f32_32x32x16_bf16 v[64:79], v[176:179], v[20:23], v[64:79]
    ds_read_b64_tr_b16 v[40:41], v2 offset:13312
    ds_read_b64_tr_b16 v[42:43], v2 offset:13824
    v_mfma_f32_32x32x16_bf16 v[64:79], v[180:183], v[24:27], v[64:79]
    ds_read_b64_tr_b16 v[16:17], v2 offset:14336
    ds_read_b64_tr_b16 v[18:19], v2 offset:14848
    buffer_load_dwordx4 v3, s[60:63], s76 offen offset:1024 sc1 lds
    s_waitcnt lgkmcnt(6)
    v_mfma_f32_32x32x16_bf16 v[64:79], v[184:187], v[28:31], v[64:79]
    ds_read_b64_tr_b16 v[20:21], v2 offset:15360
    ds_read_b64_tr_b16 v[22:23], v2 offset:15872
    v_mfma_f32_32x32x16_bf16 v[64:79], v[188:191], v[32:35], v[64:79]
    ds_read_b64_tr_b16 v[24:25], v2 offset:16384
    ds_read_b64_tr_b16 v[26:27], v2 offset:16896
    buffer_load_dwordx4 v3, s[60:63], s76 offen offset:2048 sc1 lds
    s_waitcnt lgkmcnt(6)
    v_mfma_f32_32x32x16_bf16 v[64:79], v[192:195], v[36:39], v[64:79]
    ds_read_b64_tr_b16 v[28:29], v2 offset:17408
    ds_read_b64_tr_b16 v[30:31], v2 offset:17920
    v_mfma_f32_32x32x16_bf16 v[64:79], v[196:199], v[40:43], v[64:79]
    ds_read_b64_tr_b16 v[32:33], v2 offset:18432
    ds_read_b64_tr_b16 v[34:35], v2 offset:18944
    s_waitcnt lgkmcnt(6)
    v_mfma_f32_32x32x16_bf16 v[64:79], v[200:203], v[16:19], v[64:79]
    ds_read_b64_tr_b16 v[36:37], v2 offset:19456
    ds_read_b64_tr_b16 v[38:39], v2 offset:19968
    v_mfma_f32_32x32x16_bf16 v[64:79], v[204:207], v[20:23], v[64:79]
    ds_read_b64_tr_b16 v[40:41], v2 offset:20480
    ds_read_b64_tr_b16 v[42:43], v2 offset:20992
    s_waitcnt lgkmcnt(6)
    v_mfma_f32_32x32x16_bf16 v[64:79], v[208:211], v[24:27], v[64:79]
    ds_read_b64_tr_b16 v[16:17], v2 offset:21504
    ds_read_b64_tr_b16 v[18:19], v2 offset:22016
    s_add_u32 m0, s68, 57344
    s_xor_b32 s76, s78, 0
    s_mul_i32 s76, s76, 28928
    v_mfma_f32_32x32x16_bf16 v[64:79], v[212:215], v[28:31], v[64:79]
    ds_read_b64_tr_b16 v[20:21], v2 offset:22528
    ds_read_b64_tr_b16 v[22:23], v2 offset:23040
    s_add_u32 s76, s76, s68
    s_add_u32 s76, s76, 6168576
    s_waitcnt lgkmcnt(6)
    v_mfma_f32_32x32x16_bf16 v[64:79], v[216:219], v[32:35], v[64:79]
    ds_read_b64_tr_b16 v[24:25], v2 offset:23552
    ds_read_b64_tr_b16 v[26:27], v2 offset:24064
    buffer_load_dwordx4 v3, s[60:63], s76 offen offset:0 sc1 lds
    s_waitcnt vmcnt(1)
    ds_read_b32 v128, v132 offset:28672
    v_mfma_f32_32x32x16_bf16 v[64:79], v[220:223], v[36:39], v[64:79]
    ds_read_b64_tr_b16 v[28:29], v2 offset:24576
    ds_read_b64_tr_b16 v[30:31], v2 offset:25088
    buffer_load_dwordx4 v3, s[60:63], s76 offen offset:1024 sc1 lds
    ds_read_b32 v129, v132 offset:28704
    s_waitcnt lgkmcnt(8)
    v_mfma_f32_32x32x16_bf16 v[64:79], v[224:227], v[40:43], v[64:79]
    ds_read_b64_tr_b16 v[32:33], v2 offset:25600
    ds_read_b64_tr_b16 v[34:35], v2 offset:26112
    buffer_load_dwordx4 v3, s[60:63], s76 offen offset:2048 sc1 lds
    ds_read_b32 v130, v133 offset:28672
    ds_read_b32 v131, v133 offset:28704
    v_mfma_f32_32x32x16_bf16 v[64:79], v[228:231], v[16:19], v[64:79]
    ds_read_b64_tr_b16 v[36:37], v2 offset:26624
    ds_read_b64_tr_b16 v[38:39], v2 offset:27136
    s_waitcnt lgkmcnt(10)
    v_mfma_f32_32x32x16_bf16 v[64:79], v[232:235], v[20:23], v[64:79]
    ds_read_b64_tr_b16 v[40:41], v2 offset:27648
    ds_read_b64_tr_b16 v[42:43], v2 offset:28160
    buffer_load_dwordx4 v3, s[60:63], s76 offen offset:3072 sc1 lds
    v_mfma_f32_32x32x16_bf16 v[64:79], v[236:239], v[24:27], v[64:79]
    s_waitcnt lgkmcnt(4)
    v_max3_u32 v128, v128, v129, v130
    v_max_u32 v128, v128, v131
    v_cmp_eq_u32 vcc, -1, v128
    s_cbranch_vccnz L48
L49:
    s_barrier
    ds_read_b64_tr_b16 v[16:17], v2 offset:28672
    ds_read_b64_tr_b16 v[18:19], v2 offset:29184
    v_mfma_f32_32x32x16_bf16 v[64:79], v[240:243], v[28:31], v[64:79]
    ds_read_b64_tr_b16 v[20:21], v2 offset:29696
    ds_read_b64_tr_b16 v[22:23], v2 offset:30208
    s_add_u32 m0, s68, 61440
    s_add_u32 s76, s76, 4096
    buffer_load_dwordx4 v3, s[60:63], s76 offen offset:0 sc1 lds
    v_mfma_f32_32x32x16_bf16 v[64:79], v[244:247], v[32:35], v[64:79]
    ds_read_b64_tr_b16 v[24:25], v2 offset:30720
    ds_read_b64_tr_b16 v[26:27], v2 offset:31232
    s_waitcnt lgkmcnt(6)
    v_mfma_f32_32x32x16_bf16 v[64:79], v[248:251], v[36:39], v[64:79]
    ds_read_b64_tr_b16 v[28:29], v2 offset:31744
    ds_read_b64_tr_b16 v[30:31], v2 offset:32256
    buffer_load_dwordx4 v3, s[60:63], s76 offen offset:1024 sc1 lds
    v_mfma_f32_32x32x16_bf16 v[64:79], v[252:255], v[40:43], v[64:79]
    ds_read_b64_tr_b16 v[32:33], v2 offset:32768
    ds_read_b64_tr_b16 v[34:35], v2 offset:33280
    s_waitcnt lgkmcnt(6)
    v_mfma_f32_32x32x16_bf16 v[48:63], v[144:147], v[16:19], 0
    ds_read_b64_tr_b16 v[36:37], v2 offset:33792
    ds_read_b64_tr_b16 v[38:39], v2 offset:34304
    buffer_load_dwordx4 v3, s[60:63], s76 offen offset:2048 sc1 lds
    v_mfma_f32_32x32x16_bf16 v[48:63], v[148:151], v[20:23], v[48:63]
    ds_read_b64_tr_b16 v[40:41], v2 offset:34816
    ds_read_b64_tr_b16 v[42:43], v2 offset:35328
    s_add_u32 m0, s68, 86016
    s_xor_b32 s76, s78, 1
    s_waitcnt lgkmcnt(6)
    v_mfma_f32_32x32x16_bf16 v[48:63], v[152:155], v[24:27], v[48:63]
    ds_read_b64_tr_b16 v[16:17], v2 offset:35840
    ds_read_b64_tr_b16 v[18:19], v2 offset:36352
    s_mul_i32 s76, s76, 28928
    s_add_u32 s76, s76, s68
    s_add_u32 s76, s76, 6168576
    v_mfma_f32_32x32x16_bf16 v[48:63], v[156:159], v[28:31], v[48:63]
    ds_read_b64_tr_b16 v[20:21], v2 offset:36864
    ds_read_b64_tr_b16 v[22:23], v2 offset:37376
    buffer_load_dwordx4 v3, s[60:63], s76 offen offset:0 sc1 lds
    v_cvt_pk_bf16_f32 v120, -v64, -v65
    s_waitcnt lgkmcnt(6)
    v_mfma_f32_32x32x16_bf16 v[48:63], v[160:163], v[32:35], v[48:63]
    ds_read_b64_tr_b16 v[24:25], v2 offset:37888
    ds_read_b64_tr_b16 v[26:27], v2 offset:38400
    buffer_load_dwordx4 v3, s[60:63], s76 offen offset:1024 sc1 lds
    v_cvt_pk_bf16_f32 v121, -v66, -v67
    v_cvt_pk_bf16_f32 v122, -v68, -v69
    v_mfma_f32_32x32x16_bf16 v[48:63], v[164:167], v[36:39], v[48:63]
    ds_read_b64_tr_b16 v[28:29], v2 offset:38912
    ds_read_b64_tr_b16 v[30:31], v2 offset:39424
    v_cvt_pk_bf16_f32 v123, -v70, -v71
    v_cvt_pk_bf16_f32 v124, -v72, -v73
    s_waitcnt lgkmcnt(6)
    v_mfma_f32_32x32x16_bf16 v[48:63], v[168:171], v[40:43], v[48:63]
    ds_read_b64_tr_b16 v[32:33], v2 offset:39936
    ds_read_b64_tr_b16 v[34:35], v2 offset:40448
    buffer_load_dwordx4 v3, s[60:63], s76 offen offset:2048 sc1 lds
    v_cvt_pk_bf16_f32 v125, -v74, -v75
    v_cvt_pk_bf16_f32 v126, -v76, -v77
    v_mfma_f32_32x32x16_bf16 v[48:63], v[172:175], v[16:19], v[48:63]
    ds_read_b64_tr_b16 v[36:37], v2 offset:40960
    ds_read_b64_tr_b16 v[38:39], v2 offset:41472
    v_cvt_pk_bf16_f32 v127, -v78, -v79
    v_pk_max_u16 v120, v120, s3
    s_waitcnt lgkmcnt(6)
    v_mfma_f32_32x32x16_bf16 v[48:63], v[176:179], v[20:23], v[48:63]
    ds_read_b64_tr_b16 v[40:41], v2 offset:41984
    ds_read_b64_tr_b16 v[42:43], v2 offset:42496
    buffer_load_dwordx4 v3, s[60:63], s76 offen offset:3072 sc1 lds
    v_pk_max_u16 v121, v121, s3
    v_pk_max_u16 v122, v122, s3
    v_mfma_f32_32x32x16_bf16 v[48:63], v[180:183], v[24:27], v[48:63]
    ds_read_b64_tr_b16 v[16:17], v2 offset:43008
    ds_read_b64_tr_b16 v[18:19], v2 offset:43520
    s_add_u32 m0, s68, 90112
    s_add_u32 s76, s76, 4096
    s_waitcnt lgkmcnt(6)
    v_mfma_f32_32x32x16_bf16 v[48:63], v[184:187], v[28:31], v[48:63]
    ds_read_b64_tr_b16 v[20:21], v2 offset:44032
    ds_read_b64_tr_b16 v[22:23], v2 offset:44544
    buffer_load_dwordx4 v3, s[60:63], s76 offen offset:0 sc1 lds
    v_pk_max_u16 v123, v123, s3
    v_pk_max_u16 v124, v124, s3
    v_mfma_f32_32x32x16_bf16 v[48:63], v[188:191], v[32:35], v[48:63]
    ds_read_b64_tr_b16 v[24:25], v2 offset:45056
    ds_read_b64_tr_b16 v[26:27], v2 offset:45568
    v_pk_max_u16 v125, v125, s3
    v_pk_max_u16 v126, v126, s3
    s_waitcnt lgkmcnt(6)
    v_mfma_f32_32x32x16_bf16 v[48:63], v[192:195], v[36:39], v[48:63]
    ds_read_b64_tr_b16 v[28:29], v2 offset:46080
    ds_read_b64_tr_b16 v[30:31], v2 offset:46592
    v_pk_max_u16 v127, v127, s3
    buffer_store_dwordx4 v[120:123], v3, s[60:63], s80 offen offset:0 sc1
    v_mfma_f32_32x32x16_bf16 v[48:63], v[196:199], v[40:43], v[48:63]
    ds_read_b64_tr_b16 v[32:33], v2 offset:47104
    ds_read_b64_tr_b16 v[34:35], v2 offset:47616
    buffer_load_dwordx4 v3, s[60:63], s76 offen offset:1024 sc1 lds
    s_waitcnt lgkmcnt(6)
    v_mfma_f32_32x32x16_bf16 v[48:63], v[200:203], v[16:19], v[48:63]
    ds_read_b64_tr_b16 v[36:37], v2 offset:48128
    ds_read_b64_tr_b16 v[38:39], v2 offset:48640
    buffer_store_dwordx4 v[124:127], v3, s[60:63], s80 offen offset:1024 sc1
    v_mfma_f32_32x32x16_bf16 v[48:63], v[204:207], v[20:23], v[48:63]
    ds_read_b64_tr_b16 v[40:41], v2 offset:49152
    ds_read_b64_tr_b16 v[42:43], v2 offset:49664
    buffer_load_dwordx4 v3, s[60:63], s76 offen offset:2048 sc1 lds
    v_add_u32 v132, 57344, v132
    s_waitcnt lgkmcnt(6)
    v_mfma_f32_32x32x16_bf16 v[48:63], v[208:211], v[24:27], v[48:63]
    ds_read_b64_tr_b16 v[16:17], v2 offset:50176
    ds_read_b64_tr_b16 v[18:19], v2 offset:50688
    v_add_u32 v133, 57344, v133
    s_waitcnt vmcnt(9)
    ds_read_b32 v128, v132 offset:0
    v_mfma_f32_32x32x16_bf16 v[48:63], v[212:215], v[28:31], v[48:63]
    ds_read_b64_tr_b16 v[20:21], v2 offset:51200
    ds_read_b64_tr_b16 v[22:23], v2 offset:51712
    ds_read_b32 v129, v132 offset:32
    ds_read_b32 v130, v133 offset:0
    s_waitcnt lgkmcnt(9)
    v_mfma_f32_32x32x16_bf16 v[48:63], v[216:219], v[32:35], v[48:63]
    ds_read_b64_tr_b16 v[24:25], v2 offset:52224
    ds_read_b64_tr_b16 v[26:27], v2 offset:52736
    ds_read_b32 v131, v133 offset:32
    v_mfma_f32_32x32x16_bf16 v[48:63], v[220:223], v[36:39], v[48:63]
    ds_read_b64_tr_b16 v[28:29], v2 offset:53248
    ds_read_b64_tr_b16 v[30:31], v2 offset:53760
    s_waitcnt lgkmcnt(10)
    v_mfma_f32_32x32x16_bf16 v[48:63], v[224:227], v[40:43], v[48:63]
    ds_read_b64_tr_b16 v[32:33], v2 offset:54272
    ds_read_b64_tr_b16 v[34:35], v2 offset:54784
    v_mfma_f32_32x32x16_bf16 v[48:63], v[228:231], v[16:19], v[48:63]
    ds_read_b64_tr_b16 v[36:37], v2 offset:55296
    ds_read_b64_tr_b16 v[38:39], v2 offset:55808
    s_waitcnt lgkmcnt(6)
    v_max3_u32 v128, v128, v129, v130
    v_mfma_f32_32x32x16_bf16 v[48:63], v[232:235], v[20:23], v[48:63]
    ds_read_b64_tr_b16 v[40:41], v2 offset:56320
    ds_read_b64_tr_b16 v[42:43], v2 offset:56832
    v_max_u32 v128, v128, v131
    v_cmp_eq_u32 vcc, -1, v128
    v_mfma_f32_32x32x16_bf16 v[48:63], v[236:239], v[24:27], v[48:63]
    s_cbranch_vccnz L50
L51:
    s_barrier
    ds_read_b64_tr_b16 v[16:17], v44 offset:0
    ds_read_b64_tr_b16 v[18:19], v44 offset:512
    s_waitcnt lgkmcnt(6)
    v_mfma_f32_32x32x16_bf16 v[48:63], v[240:243], v[28:31], v[48:63]
    ds_read_b64_tr_b16 v[20:21], v44 offset:1024
    ds_read_b64_tr_b16 v[22:23], v44 offset:1536
    v_mfma_f32_32x32x16_bf16 v[48:63], v[244:247], v[32:35], v[48:63]
    ds_read_b64_tr_b16 v[24:25], v44 offset:2048
    ds_read_b64_tr_b16 v[26:27], v44 offset:2560
    s_waitcnt lgkmcnt(6)
    v_mfma_f32_32x32x16_bf16 v[48:63], v[248:251], v[36:39], v[48:63]
    ds_read_b64_tr_b16 v[28:29], v44 offset:3072
    ds_read_b64_tr_b16 v[30:31], v44 offset:3584
    v_mfma_f32_32x32x16_bf16 v[48:63], v[252:255], v[40:43], v[48:63]
    ds_read_b64_tr_b16 v[32:33], v44 offset:4096
    ds_read_b64_tr_b16 v[34:35], v44 offset:4608
    s_waitcnt lgkmcnt(6)
    v_mfma_f32_32x32x16_bf16 v[64:79], v[144:147], v[16:19], 0
    ds_read_b64_tr_b16 v[36:37], v44 offset:5120
    ds_read_b64_tr_b16 v[38:39], v44 offset:5632
    v_mfma_f32_32x32x16_bf16 v[64:79], v[148:151], v[20:23], v[64:79]
    ds_read_b64_tr_b16 v[40:41], v44 offset:6144
    ds_read_b64_tr_b16 v[42:43], v44 offset:6656
    s_waitcnt lgkmcnt(6)
    v_mfma_f32_32x32x16_bf16 v[64:79], v[152:155], v[24:27], v[64:79]
    ds_read_b64_tr_b16 v[16:17], v44 offset:7168
    ds_read_b64_tr_b16 v[18:19], v44 offset:7680
    v_mfma_f32_32x32x16_bf16 v[64:79], v[156:159], v[28:31], v[64:79]
    ds_read_b64_tr_b16 v[20:21], v44 offset:8192
    ds_read_b64_tr_b16 v[22:23], v44 offset:8704
    v_cvt_pk_bf16_f32 v120, -v48, -v49
    v_cvt_pk_bf16_f32 v121, -v50, -v51
    s_waitcnt lgkmcnt(6)
    v_mfma_f32_32x32x16_bf16 v[64:79], v[160:163], v[32:35], v[64:79]
    ds_read_b64_tr_b16 v[24:25], v44 offset:9216
    ds_read_b64_tr_b16 v[26:27], v44 offset:9728
    v_cvt_pk_bf16_f32 v122, -v52, -v53
    v_cvt_pk_bf16_f32 v123, -v54, -v55
    v_cvt_pk_bf16_f32 v124, -v56, -v57
    v_mfma_f32_32x32x16_bf16 v[64:79], v[164:167], v[36:39], v[64:79]
    ds_read_b64_tr_b16 v[28:29], v44 offset:10240
    ds_read_b64_tr_b16 v[30:31], v44 offset:10752
    v_cvt_pk_bf16_f32 v125, -v58, -v59
    v_cvt_pk_bf16_f32 v126, -v60, -v61
    s_waitcnt lgkmcnt(6)
    v_mfma_f32_32x32x16_bf16 v[64:79], v[168:171], v[40:43], v[64:79]
    ds_read_b64_tr_b16 v[32:33], v44 offset:11264
    ds_read_b64_tr_b16 v[34:35], v44 offset:11776
    v_cvt_pk_bf16_f32 v127, -v62, -v63
    v_pk_max_u16 v120, v120, s3
    v_pk_max_u16 v121, v121, s3
    v_mfma_f32_32x32x16_bf16 v[64:79], v[172:175], v[16:19], v[64:79]
    ds_read_b64_tr_b16 v[36:37], v44 offset:12288
    ds_read_b64_tr_b16 v[38:39], v44 offset:12800
    v_pk_max_u16 v122, v122, s3
    v_pk_max_u16 v123, v123, s3
    s_waitcnt lgkmcnt(6)
    v_mfma_f32_32x32x16_bf16 v[64:79], v[176:179], v[20:23], v[64:79]
    ds_read_b64_tr_b16 v[40:41], v44 offset:13312
    ds_read_b64_tr_b16 v[42:43], v44 offset:13824
    buffer_load_dwordx4 v[80:83], v3, s[60:63], s74 offen offset:0 sc1
    v_pk_max_u16 v124, v124, s3
    v_pk_max_u16 v125, v125, s3
    v_mfma_f32_32x32x16_bf16 v[64:79], v[180:183], v[24:27], v[64:79]
    ds_read_b64_tr_b16 v[16:17], v44 offset:14336
    ds_read_b64_tr_b16 v[18:19], v44 offset:14848
    buffer_load_dwordx4 v[84:87], v3, s[60:63], s74 offen offset:1024 sc1
    v_pk_max_u16 v126, v126, s3
    s_waitcnt lgkmcnt(6)
    v_mfma_f32_32x32x16_bf16 v[64:79], v[184:187], v[28:31], v[64:79]
    ds_read_b64_tr_b16 v[20:21], v44 offset:15360
    ds_read_b64_tr_b16 v[22:23], v44 offset:15872
    v_pk_max_u16 v127, v127, s3
    v_mfma_f32_32x32x16_bf16 v[64:79], v[188:191], v[32:35], v[64:79]
    ds_read_b64_tr_b16 v[24:25], v44 offset:16384
    ds_read_b64_tr_b16 v[26:27], v44 offset:16896
    buffer_load_dwordx4 v[88:91], v3, s[60:63], s74 offen offset:2048 sc1
    s_waitcnt lgkmcnt(6)
    v_mfma_f32_32x32x16_bf16 v[64:79], v[192:195], v[36:39], v[64:79]
    ds_read_b64_tr_b16 v[28:29], v44 offset:17408
    ds_read_b64_tr_b16 v[30:31], v44 offset:17920
    buffer_store_dwordx4 v[120:123], v3, s[60:63], s81 offen offset:0 sc1
    v_mfma_f32_32x32x16_bf16 v[64:79], v[196:199], v[40:43], v[64:79]
    ds_read_b64_tr_b16 v[32:33], v44 offset:18432
    ds_read_b64_tr_b16 v[34:35], v44 offset:18944
    buffer_load_dwordx4 v[92:95], v3, s[60:63], s74 offen offset:3072 sc1
    s_add_u32 s74, s74, 4096
    s_waitcnt lgkmcnt(6)
    v_mfma_f32_32x32x16_bf16 v[64:79], v[200:203], v[16:19], v[64:79]
    ds_read_b64_tr_b16 v[36:37], v44 offset:19456
    ds_read_b64_tr_b16 v[38:39], v44 offset:19968
    buffer_store_dwordx4 v[124:127], v3, s[60:63], s81 offen offset:1024 sc1
    v_mfma_f32_32x32x16_bf16 v[64:79], v[204:207], v[20:23], v[64:79]
    ds_read_b64_tr_b16 v[40:41], v44 offset:20480
    ds_read_b64_tr_b16 v[42:43], v44 offset:20992
    buffer_load_dwordx4 v[96:99], v3, s[60:63], s74 offen offset:0 sc1
    s_waitcnt vmcnt(7)
    s_waitcnt lgkmcnt(6)
    v_mfma_f32_32x32x16_bf16 v[64:79], v[208:211], v[24:27], v[64:79]
    ds_read_b64_tr_b16 v[16:17], v44 offset:21504
    ds_read_b64_tr_b16 v[18:19], v44 offset:22016
    ds_read_b32 v128, v132 offset:28672
    ds_read_b32 v129, v132 offset:28704
    ds_read_b32 v130, v133 offset:28672
    v_mfma_f32_32x32x16_bf16 v[64:79], v[212:215], v[28:31], v[64:79]
    ds_read_b64_tr_b16 v[20:21], v44 offset:22528
    ds_read_b64_tr_b16 v[22:23], v44 offset:23040
    buffer_load_dwordx4 v[100:103], v3, s[60:63], s74 offen offset:1024 sc1
    ds_read_b32 v131, v133 offset:28704
    s_waitcnt lgkmcnt(10)
    v_mfma_f32_32x32x16_bf16 v[64:79], v[216:219], v[32:35], v[64:79]
    ds_read_b64_tr_b16 v[24:25], v44 offset:23552
    ds_read_b64_tr_b16 v[26:27], v44 offset:24064
    v_mfma_f32_32x32x16_bf16 v[64:79], v[220:223], v[36:39], v[64:79]
    ds_read_b64_tr_b16 v[28:29], v44 offset:24576
    ds_read_b64_tr_b16 v[30:31], v44 offset:25088
    s_waitcnt lgkmcnt(10)
    v_mfma_f32_32x32x16_bf16 v[64:79], v[224:227], v[40:43], v[64:79]
    ds_read_b64_tr_b16 v[32:33], v44 offset:25600
    ds_read_b64_tr_b16 v[34:35], v44 offset:26112
    buffer_load_dwordx4 v[104:107], v3, s[60:63], s74 offen offset:2048 sc1
    s_waitcnt lgkmcnt(6)
    v_max3_u32 v128, v128, v129, v130
    v_mfma_f32_32x32x16_bf16 v[64:79], v[228:231], v[16:19], v[64:79]
    ds_read_b64_tr_b16 v[36:37], v44 offset:26624
    ds_read_b64_tr_b16 v[38:39], v44 offset:27136
    v_max_u32 v128, v128, v131
    v_cmp_eq_u32 vcc, -1, v128
    s_waitcnt lgkmcnt(6)
    v_mfma_f32_32x32x16_bf16 v[64:79], v[232:235], v[20:23], v[64:79]
    ds_read_b64_tr_b16 v[40:41], v44 offset:27648
    ds_read_b64_tr_b16 v[42:43], v44 offset:28160
    buffer_load_dwordx4 v[108:111], v3, s[60:63], s74 offen offset:3072 sc1
    s_add_u32 s74, s74, 4096
    v_mfma_f32_32x32x16_bf16 v[64:79], v[236:239], v[24:27], v[64:79]
    s_cbranch_vccnz L52
L53:
    s_barrier
    ds_read_b64_tr_b16 v[16:17], v44 offset:28672
    ds_read_b64_tr_b16 v[18:19], v44 offset:29184
    s_waitcnt lgkmcnt(6)
    v_mfma_f32_32x32x16_bf16 v[64:79], v[240:243], v[28:31], v[64:79]
    ds_read_b64_tr_b16 v[20:21], v44 offset:29696
    ds_read_b64_tr_b16 v[22:23], v44 offset:30208
    buffer_load_dwordx4 v[112:115], v3, s[60:63], s74 offen offset:0 sc1
    v_mfma_f32_32x32x16_bf16 v[64:79], v[244:247], v[32:35], v[64:79]
    ds_read_b64_tr_b16 v[24:25], v44 offset:30720
    ds_read_b64_tr_b16 v[26:27], v44 offset:31232
    s_waitcnt lgkmcnt(6)
    v_mfma_f32_32x32x16_bf16 v[64:79], v[248:251], v[36:39], v[64:79]
    ds_read_b64_tr_b16 v[28:29], v44 offset:31744
    ds_read_b64_tr_b16 v[30:31], v44 offset:32256
    buffer_load_dwordx4 v[116:119], v3, s[60:63], s74 offen offset:1024 sc1
    v_mfma_f32_32x32x16_bf16 v[64:79], v[252:255], v[40:43], v[64:79]
    ds_read_b64_tr_b16 v[32:33], v44 offset:32768
    ds_read_b64_tr_b16 v[34:35], v44 offset:33280
    s_waitcnt lgkmcnt(6)
    v_mfma_f32_32x32x16_bf16 v[48:63], v[144:147], v[16:19], 0
    ds_read_b64_tr_b16 v[36:37], v44 offset:33792
    ds_read_b64_tr_b16 v[38:39], v44 offset:34304
    buffer_load_dwordx4 a[224:227], v3, s[60:63], s74 offen offset:2048 sc1
    v_mfma_f32_32x32x16_bf16 v[48:63], v[148:151], v[20:23], v[48:63]
    ds_read_b64_tr_b16 v[40:41], v44 offset:34816
    ds_read_b64_tr_b16 v[42:43], v44 offset:35328
    s_waitcnt lgkmcnt(6)
    v_mfma_f32_32x32x16_bf16 v[48:63], v[152:155], v[24:27], v[48:63]
    ds_read_b64_tr_b16 v[16:17], v44 offset:35840
    ds_read_b64_tr_b16 v[18:19], v44 offset:36352
    v_mfma_f32_32x32x16_bf16 v[48:63], v[156:159], v[28:31], v[48:63]
    ds_read_b64_tr_b16 v[20:21], v44 offset:36864
    ds_read_b64_tr_b16 v[22:23], v44 offset:37376
    buffer_load_dwordx4 a[228:231], v3, s[60:63], s74 offen offset:3072 sc1
    s_add_u32 s74, s74, 4096
    s_waitcnt lgkmcnt(6)
    v_mfma_f32_32x32x16_bf16 v[48:63], v[160:163], v[32:35], v[48:63]
    ds_read_b64_tr_b16 v[24:25], v44 offset:37888
    ds_read_b64_tr_b16 v[26:27], v44 offset:38400
    v_cvt_pk_bf16_f32 v120, -v64, -v65
    v_cvt_pk_bf16_f32 v121, -v66, -v67
    v_cvt_pk_bf16_f32 v122, -v68, -v69
    v_mfma_f32_32x32x16_bf16 v[48:63], v[164:167], v[36:39], v[48:63]
    ds_read_b64_tr_b16 v[28:29], v44 offset:38912
    ds_read_b64_tr_b16 v[30:31], v44 offset:39424
    buffer_load_dwordx4 a[232:235], v3, s[60:63], s74 offen offset:0 sc1
    v_cvt_pk_bf16_f32 v123, -v70, -v71
    s_waitcnt lgkmcnt(6)
    v_mfma_f32_32x32x16_bf16 v[48:63], v[168:171], v[40:43], v[48:63]
    ds_read_b64_tr_b16 v[32:33], v44 offset:39936
    ds_read_b64_tr_b16 v[34:35], v44 offset:40448
    v_cvt_pk_bf16_f32 v124, -v72, -v73
    v_cvt_pk_bf16_f32 v125, -v74, -v75
    v_cvt_pk_bf16_f32 v126, -v76, -v77
    v_mfma_f32_32x32x16_bf16 v[48:63], v[172:175], v[16:19], v[48:63]
    ds_read_b64_tr_b16 v[36:37], v44 offset:40960
    ds_read_b64_tr_b16 v[38:39], v44 offset:41472
    buffer_load_dwordx4 a[236:239], v3, s[60:63], s74 offen offset:1024 sc1
    v_cvt_pk_bf16_f32 v127, -v78, -v79
    s_waitcnt lgkmcnt(6)
    v_mfma_f32_32x32x16_bf16 v[48:63], v[176:179], v[20:23], v[48:63]
    ds_read_b64_tr_b16 v[40:41], v44 offset:41984
    ds_read_b64_tr_b16 v[42:43], v44 offset:42496
    v_pk_max_u16 v120, v120, s3
    v_pk_max_u16 v121, v121, s3
    v_pk_max_u16 v122, v122, s3
    v_mfma_f32_32x32x16_bf16 v[48:63], v[180:183], v[24:27], v[48:63]
    ds_read_b64_tr_b16 v[16:17], v44 offset:43008
    ds_read_b64_tr_b16 v[18:19], v44 offset:43520
    buffer_load_dwordx4 a[240:243], v3, s[60:63], s75 offen offset:0 sc1
    v_pk_max_u16 v123, v123, s3
    s_waitcnt lgkmcnt(6)
    v_mfma_f32_32x32x16_bf16 v[48:63], v[184:187], v[28:31], v[48:63]
    ds_read_b64_tr_b16 v[20:21], v44 offset:44032
    ds_read_b64_tr_b16 v[22:23], v44 offset:44544
    v_pk_max_u16 v124, v124, s3
    v_pk_max_u16 v125, v125, s3
    v_pk_max_u16 v126, v126, s3
    v_mfma_f32_32x32x16_bf16 v[48:63], v[188:191], v[32:35], v[48:63]
    ds_read_b64_tr_b16 v[24:25], v44 offset:45056
    ds_read_b64_tr_b16 v[26:27], v44 offset:45568
    buffer_load_dwordx4 a[244:247], v3, s[60:63], s75 offen offset:1024 sc1
    v_pk_max_u16 v127, v127, s3
    s_waitcnt lgkmcnt(6)
    v_mfma_f32_32x32x16_bf16 v[48:63], v[192:195], v[36:39], v[48:63]
    ds_read_b64_tr_b16 v[28:29], v44 offset:46080
    ds_read_b64_tr_b16 v[30:31], v44 offset:46592
    buffer_store_dwordx4 v[120:123], v3, s[60:63], s82 offen offset:0 sc1
    v_mfma_f32_32x32x16_bf16 v[48:63], v[196:199], v[40:43], v[48:63]
    ds_read_b64_tr_b16 v[32:33], v44 offset:47104
    ds_read_b64_tr_b16 v[34:35], v44 offset:47616
    buffer_load_dwordx4 a[248:251], v3, s[60:63], s75 offen offset:2048 sc1
    s_waitcnt lgkmcnt(6)
    v_mfma_f32_32x32x16_bf16 v[48:63], v[200:203], v[16:19], v[48:63]
    ds_read_b64_tr_b16 v[36:37], v44 offset:48128
    ds_read_b64_tr_b16 v[38:39], v44 offset:48640
    buffer_store_dwordx4 v[124:127], v3, s[60:63], s82 offen offset:1024 sc1
    v_mfma_f32_32x32x16_bf16 v[48:63], v[204:207], v[20:23], v[48:63]
    ds_read_b64_tr_b16 v[40:41], v44 offset:49152
    ds_read_b64_tr_b16 v[42:43], v44 offset:49664
    s_waitcnt lgkmcnt(6)
    v_mfma_f32_32x32x16_bf16 v[48:63], v[208:211], v[24:27], v[48:63]
    ds_read_b64_tr_b16 v[16:17], v44 offset:50176
    ds_read_b64_tr_b16 v[18:19], v44 offset:50688
    buffer_load_dwordx4 a[252:255], v3, s[60:63], s75 offen offset:3072 sc1
    s_add_u32 s75, s75, 4096
    v_mfma_f32_32x32x16_bf16 v[48:63], v[212:215], v[28:31], v[48:63]
    ds_read_b64_tr_b16 v[20:21], v44 offset:51200
    ds_read_b64_tr_b16 v[22:23], v44 offset:51712
    s_waitcnt lgkmcnt(6)
    v_mfma_f32_32x32x16_bf16 v[48:63], v[216:219], v[32:35], v[48:63]
    ds_read_b64_tr_b16 v[24:25], v44 offset:52224
    ds_read_b64_tr_b16 v[26:27], v44 offset:52736
    v_mfma_f32_32x32x16_bf16 v[48:63], v[220:223], v[36:39], v[48:63]
    ds_read_b64_tr_b16 v[28:29], v44 offset:53248
    ds_read_b64_tr_b16 v[30:31], v44 offset:53760
    s_waitcnt lgkmcnt(6)
    v_mfma_f32_32x32x16_bf16 v[48:63], v[224:227], v[40:43], v[48:63]
    ds_read_b64_tr_b16 v[32:33], v44 offset:54272
    ds_read_b64_tr_b16 v[34:35], v44 offset:54784
    v_mfma_f32_32x32x16_bf16 v[48:63], v[228:231], v[16:19], v[48:63]
    ds_read_b64_tr_b16 v[36:37], v44 offset:55296
    ds_read_b64_tr_b16 v[38:39], v44 offset:55808
    s_waitcnt lgkmcnt(6)
    v_mfma_f32_32x32x16_bf16 v[48:63], v[232:235], v[20:23], v[48:63]
    ds_read_b64_tr_b16 v[40:41], v44 offset:56320
    ds_read_b64_tr_b16 v[42:43], v44 offset:56832
    v_mfma_f32_32x32x16_bf16 v[48:63], v[236:239], v[24:27], v[48:63]
    s_waitcnt lgkmcnt(4)
    v_mfma_f32_32x32x16_bf16 v[48:63], v[240:243], v[28:31], v[48:63]
    s_waitcnt vmcnt(19)
    v_max3_i32 v13, v80, v84, v88
    v_cmp_le_i32 vcc, 0, v13
    v_mfma_f32_32x32x16_bf16 v[48:63], v[244:247], v[32:35], v[48:63]
    s_cbranch_vccnz L54
L55:
    s_waitcnt lgkmcnt(0)
    v_mfma_f32_32x32x16_bf16 v[48:63], v[248:251], v[36:39], v[48:63]
    v_mfma_f32_32x32x16_bf16 v[48:63], v[252:255], v[40:43], v[48:63]
    v_mfma_f32_32x32x16_bf16 v[16:31], a[0:3], v[80:83], 0
    s_nop 2
    v_mfma_f32_32x32x16_bf16 v[32:47], a[4:7], v[80:83], 0
    buffer_load_dwordx4 v[80:83], v3, s[60:63], s75 offen offset:0 sc1
    s_nop 2
    v_mfma_f32_32x32x16_bf16 v[16:31], a[8:11], v[84:87], v[16:31]
    s_waitcnt vmcnt(15)
    v_max3_i32 v13, v92, v96, v100
    v_cmp_le_i32 vcc, 0, v13
    s_nop 2
    v_mfma_f32_32x32x16_bf16 v[32:47], a[12:15], v[84:87], v[32:47]
    s_cbranch_vccnz L56
L57:
    buffer_load_dwordx4 v[84:87], v3, s[60:63], s75 offen offset:1024 sc1
    v_cvt_pk_bf16_f32 v120, -v48, -v49
    v_mfma_f32_32x32x16_bf16 v[16:31], a[16:19], v[88:91], v[16:31]
    v_cvt_pk_bf16_f32 v121, -v50, -v51
    v_cvt_pk_bf16_f32 v122, -v52, -v53
    v_cvt_pk_bf16_f32 v123, -v54, -v55
    v_cvt_pk_bf16_f32 v124, -v56, -v57
    v_mfma_f32_32x32x16_bf16 v[32:47], a[20:23], v[88:91], v[32:47]
    buffer_load_dwordx4 v[88:91], v3, s[60:63], s75 offen offset:2048 sc1
    v_cvt_pk_bf16_f32 v125, -v58, -v59
    v_cvt_pk_bf16_f32 v126, -v60, -v61
    v_cvt_pk_bf16_f32 v127, -v62, -v63
    v_mfma_f32_32x32x16_bf16 v[16:31], a[24:27], v[92:95], v[16:31]
    v_pk_max_u16 v120, v120, s3
    v_pk_max_u16 v121, v121, s3
    v_pk_max_u16 v122, v122, s3
    v_pk_max_u16 v123, v123, s3
    v_mfma_f32_32x32x16_bf16 v[32:47], a[28:31], v[92:95], v[32:47]
    v_pk_max_u16 v124, v124, s3
    v_pk_max_u16 v125, v125, s3
    v_pk_max_u16 v126, v126, s3
    v_pk_max_u16 v127, v127, s3
    buffer_store_dwordx4 v[120:123], v3, s[60:63], s83 offen offset:0 sc1
    v_mfma_f32_32x32x16_bf16 v[16:31], a[32:35], v[96:99], v[16:31]
    s_waitcnt vmcnt(15)
    v_max3_i32 v13, v104, v108, v112
    v_cmp_le_i32 vcc, 0, v13
    buffer_load_dwordx4 v[92:95], v3, s[60:63], s75 offen offset:3072 sc1
    s_add_u32 s75, s75, 4096
    v_mfma_f32_32x32x16_bf16 v[32:47], a[36:39], v[96:99], v[32:47]
    buffer_store_dwordx4 v[124:127], v3, s[60:63], s83 offen offset:1024 sc1
    v_mfma_f32_32x32x16_bf16 v[16:31], a[40:43], v[100:103], v[16:31]
    s_cbranch_vccnz L58
L59:
    buffer_load_dwordx4 v[96:99], v3, s[60:63], s75 offen offset:0 sc1
    v_mfma_f32_32x32x16_bf16 v[32:47], a[44:47], v[100:103], v[32:47]
    buffer_load_dwordx4 v[100:103], v3, s[60:63], s75 offen offset:1024 sc1
    s_barrier
    s_lshl_b32 s48, s43, 2
    s_add_u32 s48, s48, s34
    v_mfma_f32_32x32x16_bf16 v[16:31], a[48:51], v[104:107], v[16:31]
    s_lshl_b32 s49, s48, 10
    v_add_u32 v124, s49, v2
    ds_read_b64_tr_b16 v[128:129], v124 offset:0
    ds_read_b64_tr_b16 v[130:131], v124 offset:512
    v_mfma_f32_32x32x16_bf16 v[32:47], a[52:55], v[104:107], v[32:47]
    buffer_load_dwordx4 v[104:107], v3, s[60:63], s75 offen offset:2048 sc1
    ds_read_b64_tr_b16 v[132:133], v124 offset:57344
    ds_read_b64_tr_b16 v[134:135], v124 offset:57856
    v_and_b32 v138, 31, v1
    v_lshrrev_b32 v127, 2, v138
    v_mfma_f32_32x32x16_bf16 v[16:31], a[56:59], v[108:111], v[16:31]
    s_waitcnt vmcnt(17)
    v_accvgpr_read_b32 v14, a224
    v_accvgpr_read_b32 v142, a228
    v_max3_i32 v13, v116, v14, v142
    v_cmp_le_i32 vcc, 0, v13
    v_mfma_f32_32x32x16_bf16 v[32:47], a[60:63], v[108:111], v[32:47]
    s_cbranch_vccnz L60
L61:
    buffer_load_dwordx4 v[108:111], v3, s[60:63], s75 offen offset:3072 sc1
    s_add_u32 s75, s75, 4096
    v_mfma_f32_32x32x16_bf16 v[16:31], a[64:67], v[112:115], v[16:31]
    v_lshlrev_b32 v127, 4, v127
    v_and_b32 v139, 1, v138
    v_lshl_add_u32 v127, v139, 3, v127
    v_bfe_u32 v139, v138, 1, 1
    v_lshl_add_u32 v127, v139, 12, v127
    v_mfma_f32_32x32x16_bf16 v[32:47], a[68:71], v[112:115], v[32:47]
    buffer_load_dwordx4 v[112:115], v3, s[60:63], s75 offen offset:0 sc1
    s_lshl_b32 s82, s78, 7
    s_add_u32 s82, s82, 9224192
    s_add_u32 s83, s82, 8192
    buffer_load_dword v136, v127, s[60:63], s82 offen offset:4 sc1
    v_mfma_f32_32x32x16_bf16 v[16:31], a[72:75], v[116:119], v[16:31]
    s_xor_b32 s49, s34, 1
    s_mul_i32 s49, s49, 6144
    s_add_u32 s49, s49, 28672
    v_add_u32 v121, s49, v3
    s_xor_b32 s49, s34, 2
    v_mfma_f32_32x32x16_bf16 v[32:47], a[76:79], v[116:119], v[32:47]
    buffer_load_dwordx4 v[116:119], v3, s[60:63], s75 offen offset:1024 sc1
    s_mul_i32 s49, s49, 6144
    s_add_u32 s49, s49, 30720
    v_add_u32 v122, s49, v3
    s_xor_b32 s49, s34, 3
    v_mfma_f32_32x32x16_bf16 v[16:31], a[80:83], a[224:227], v[16:31]
    s_waitcnt vmcnt(19)
    v_accvgpr_read_b32 v13, a232
    v_accvgpr_read_b32 v14, a236
    v_max_i32 v13, v13, v14
    v_cmp_le_i32 vcc, 0, v13
    v_mfma_f32_32x32x16_bf16 v[32:47], a[84:87], a[224:227], v[32:47]
    s_cbranch_vccnz L62
L63:
    buffer_load_dwordx4 a[224:227], v3, s[60:63], s86 offen offset:0 sc1
    s_mul_i32 s49, s49, 6144
    v_mfma_f32_32x32x16_bf16 v[16:31], a[88:91], a[228:231], v[16:31]
    s_add_u32 s49, s49, 32768
    v_add_u32 v123, s49, v3
    s_mul_i32 s49, s34, 6144
    s_add_u32 s49, s49, 28672
    v_add_u32 v120, s49, v3
    v_mfma_f32_32x32x16_bf16 v[32:47], a[92:95], a[228:231], v[32:47]
    buffer_load_dwordx4 a[228:231], v3, s[60:63], s86 offen offset:1024 sc1
    v_lshrrev_b32 v139, 5, v1
    v_mul_u32_u24 v124, 896, v138
    v_lshl_add_u32 v124, v139, 4, v124
    s_lshl_b32 s48, s48, 5
    v_mfma_f32_32x32x16_bf16 v[16:31], a[96:99], a[232:235], v[16:31]
    s_waitcnt vmcnt(17)
    v_accvgpr_read_b32 v13, a240
    v_accvgpr_read_b32 v14, a244
    v_accvgpr_read_b32 v142, a248
    v_max3_i32 v13, v13, v14, v142
    v_mfma_f32_32x32x16_bf16 v[32:47], a[100:103], a[232:235], v[32:47]
    v_cmp_le_i32 vcc, 0, v13
    buffer_load_dwordx4 a[232:235], v3, s[60:63], s86 offen offset:2048 sc1
    s_mul_i32 s49, s78, 28672
    s_add_u32 s48, s48, s49
    v_add_u32 v124, s48, v124
    v_mfma_f32_32x32x16_bf16 v[16:31], a[104:107], a[236:239], v[16:31]
    s_cbranch_vccnz L64
L65:
    v_add_u32 v125, 917504, v124
    v_mul_u32_u24 v126, 144, v138
    v_mfma_f32_32x32x16_bf16 v[32:47], a[108:111], a[236:239], v[32:47]
    buffer_load_dwordx4 a[236:239], v3, s[60:63], s86 offen offset:3072 sc1
    s_add_u32 s86, s86, 4096
    v_lshl_add_u32 v126, v139, 4, v126
    s_lshl_b32 s48, s34, 5
    s_add_u32 s48, s48, 114688
    v_mfma_f32_32x32x16_bf16 v[16:31], a[112:115], a[240:243], v[16:31]
    v_add_u32 v126, s48, v126
    v_lshrrev_b32 v138, 7, v0
    v_and_b32 v139, 0x70, v0
    v_mul_u32_u24 v140, 144, v138
    v_add_u32 v140, v140, v139
    v_mfma_f32_32x32x16_bf16 v[32:47], a[116:119], a[240:243], v[32:47]
    buffer_load_dwordx4 a[240:243], v3, s[60:63], s86 offen offset:0 sc1
    v_add_u32 v140, 114688, v140
    v_mul_u32_u24 v141, 896, v138
    s_lshl_b32 s48, s43, 7
    s_add_u32 s48, s48, s49
    v_mfma_f32_32x32x16_bf16 v[16:31], a[120:123], a[244:247], v[16:31]
    s_waitcnt vmcnt(16)
    v_accvgpr_read_b32 v13, a252
    v_max3_i32 v13, v13, v80, v84
    v_cmp_le_i32 vcc, 0, v13
    v_add3_u32 v141, v141, v139, s48
    v_mfma_f32_32x32x16_bf16 v[32:47], a[124:127], a[244:247], v[32:47]
    s_cbranch_vccnz L66
L67:
    buffer_load_dwordx4 a[244:247], v3, s[60:63], s86 offen offset:1024 sc1
    v_add_u32 v143, 917504, v141
    v_mfma_f32_32x32x16_bf16 v[16:31], a[128:131], a[248:251], v[16:31]
    buffer_load_dword v137, v127, s[60:63], s83 offen offset:4 sc1
    v_mfma_f32_32x32x16_bf16 v[32:47], a[132:135], a[248:251], v[32:47]
    buffer_load_dwordx4 a[248:251], v3, s[60:63], s86 offen offset:2048 sc1
    v_mfma_f32_32x32x16_bf16 v[16:31], a[136:139], a[252:255], v[16:31]
    v_mfma_f32_32x32x16_bf16 v[32:47], a[140:143], a[252:255], v[32:47]
    buffer_load_dwordx4 a[252:255], v3, s[60:63], s86 offen offset:3072 sc1
    s_add_u32 s86, s86, 4096
    v_mfma_f32_32x32x16_bf16 v[16:31], a[144:147], v[80:83], v[16:31]
    s_waitcnt vmcnt(15)
    v_max3_i32 v13, v88, v92, v96
    v_cmp_le_i32 vcc, 0, v13
    v_mfma_f32_32x32x16_bf16 v[32:47], a[148:151], v[80:83], v[32:47]
    s_cbranch_vccnz L68
L69:
    buffer_load_dwordx4 v[80:83], v3, s[60:63], s86 offen offset:0 sc1
    v_mfma_f32_32x32x16_bf16 v[16:31], a[152:155], v[84:87], v[16:31]
    v_mfma_f32_32x32x16_bf16 v[32:47], a[156:159], v[84:87], v[32:47]
    buffer_load_dwordx4 v[84:87], v3, s[60:63], s86 offen offset:1024 sc1
    v_mfma_f32_32x32x16_bf16 v[16:31], a[160:163], v[88:91], v[16:31]
    v_mfma_f32_32x32x16_bf16 v[32:47], a[164:167], v[88:91], v[32:47]
    buffer_load_dwordx4 v[88:91], v3, s[60:63], s86 offen offset:2048 sc1
    v_mfma_f32_32x32x16_bf16 v[16:31], a[168:171], v[92:95], v[16:31]
    s_waitcnt vmcnt(15)
    v_max3_i32 v13, v100, v104, v108
    v_cmp_le_i32 vcc, 0, v13
    v_mfma_f32_32x32x16_bf16 v[32:47], a[172:175], v[92:95], v[32:47]
    s_cbranch_vccnz L70
L71:
    v_mfma_f32_32x32x16_bf16 v[16:31], a[176:179], v[96:99], v[16:31]
    buffer_load_dwordx4 v[92:95], v3, s[60:63], s86 offen offset:3072 sc1
    s_add_u32 s86, s86, 4096
    v_mfma_f32_32x32x16_bf16 v[32:47], a[180:183], v[96:99], v[32:47]
    v_mfma_f32_32x32x16_bf16 v[16:31], a[184:187], v[100:103], v[16:31]
    buffer_load_dwordx4 v[96:99], v3, s[60:63], s86 offen offset:0 sc1
    v_mfma_f32_32x32x16_bf16 v[32:47], a[188:191], v[100:103], v[32:47]
    v_mfma_f32_32x32x16_bf16 v[16:31], a[192:195], v[104:107], v[16:31]
    s_waitcnt vmcnt(14)
    v_max_i32 v13, v112, v116
    v_cmp_le_i32 vcc, 0, v13
    buffer_load_dwordx4 v[100:103], v3, s[60:63], s86 offen offset:1024 sc1
    v_mfma_f32_32x32x16_bf16 v[32:47], a[196:199], v[104:107], v[32:47]
    s_cbranch_vccnz L72
L73:
    v_mfma_f32_32x32x16_bf16 v[16:31], a[200:203], v[108:111], v[16:31]
    buffer_load_dwordx4 v[104:107], v3, s[60:63], s87 offen offset:0 sc1
    v_mfma_f32_32x32x16_bf16 v[32:47], a[204:207], v[108:111], v[32:47]
    v_mfma_f32_32x32x16_bf16 v[16:31], a[208:211], v[112:115], v[16:31]
    s_waitcnt vmcnt(13)
    v_accvgpr_read_b32 v13, a224
    v_accvgpr_read_b32 v14, a228
    v_accvgpr_read_b32 v142, a232
    v_max3_i32 v13, v13, v14, v142
    v_mfma_f32_32x32x16_bf16 v[32:47], a[212:215], v[112:115], v[32:47]
    v_cmp_le_i32 vcc, 0, v13
    buffer_load_dwordx4 v[108:111], v3, s[60:63], s87 offen offset:1024 sc1
    v_mfma_f32_32x32x16_bf16 v[16:31], a[216:219], v[116:119], v[16:31]
    s_cbranch_vccnz L74
L75:
    buffer_load_dwordx4 v[112:115], v3, s[60:63], s87 offen offset:2048 sc1
    v_mfma_f32_32x32x16_bf16 v[32:47], a[220:223], v[116:119], v[32:47]
    v_mfma_f32_32x32x16_bf16 v[48:63], a[0:3], a[224:227], 0
    buffer_load_dwordx4 v[116:119], v3, s[60:63], s87 offen offset:3072 sc1
    s_add_u32 s87, s87, 4096
    v_cmp_eq_u32 vcc, -1, v136
    v_mfma_f32_32x32x16_bf16 v[64:79], a[4:7], a[224:227], 0
    s_cbranch_vccnz L76
L77:
    v_sub_f32 v136, 0, v136
    s_waitcnt vmcnt(12)
    v_cmp_eq_u32 vcc, -1, v137
    v_mfma_f32_32x32x16_bf16 v[48:63], a[8:11], a[228:231], v[48:63]
    v_accvgpr_read_b32 v13, a236
    v_accvgpr_read_b32 v14, a240
    v_accvgpr_read_b32 v142, a244
    v_max3_i32 v13, v13, v14, v142
    v_mfma_f32_32x32x16_bf16 v[64:79], a[12:15], a[228:231], v[64:79]
    s_cbranch_vccnz L78
L79:
    v_cmp_le_i32 vcc, 0, v13
    buffer_load_dwordx4 a[224:227], v3, s[60:63], s87 offen offset:0 sc1
    v_mfma_f32_32x32x16_bf16 v[48:63], a[16:19], a[232:235], v[48:63]
    s_cbranch_vccnz L80
L81:
    buffer_load_dwordx4 a[228:231], v3, s[60:63], s87 offen offset:1024 sc1
    v_mfma_f32_32x32x16_bf16 v[64:79], a[20:23], a[232:235], v[64:79]
    v_sub_f32 v137, 0, v137
    v_mfma_f32_32x32x16_bf16 v[48:63], a[24:27], a[236:239], v[48:63]
    buffer_load_dwordx4 a[232:235], v3, s[60:63], s87 offen offset:2048 sc1
    ds_write_b128 v121, v[24:27] offset:0
    v_mfma_f32_32x32x16_bf16 v[64:79], a[28:31], a[236:239], v[64:79]
    v_mfma_f32_32x32x16_bf16 v[48:63], a[32:35], a[240:243], v[48:63]
    s_waitcnt vmcnt(12)
    v_accvgpr_read_b32 v13, a248
    v_accvgpr_read_b32 v14, a252
    v_max3_i32 v13, v13, v14, v80
    v_cmp_le_i32 vcc, 0, v13
    v_mfma_f32_32x32x16_bf16 v[64:79], a[36:39], a[240:243], v[64:79]
    s_cbranch_vccnz L82
L83:
    buffer_load_dwordx4 a[236:239], v3, s[60:63], s87 offen offset:3072 sc1
    s_add_u32 s87, s87, 4096
    v_mfma_f32_32x32x16_bf16 v[48:63], a[40:43], a[244:247], v[48:63]
    buffer_load_dwordx4 a[240:243], v3, s[60:63], s87 offen offset:0 sc1
    ds_write_b128 v121, v[28:31] offset:1024
    v_mfma_f32_32x32x16_bf16 v[64:79], a[44:47], a[244:247], v[64:79]
    v_mfma_f32_32x32x16_bf16 v[48:63], a[48:51], a[248:251], v[48:63]
    buffer_load_dwordx4 a[244:247], v3, s[60:63], s87 offen offset:1024 sc1
    ds_write_b128 v122, v[32:35] offset:0
    v_mfma_f32_32x32x16_bf16 v[64:79], a[52:55], a[248:251], v[64:79]
    v_mfma_f32_32x32x16_bf16 v[48:63], a[56:59], a[252:255], v[48:63]
    s_waitcnt vmcnt(12)
    v_max3_i32 v13, v84, v88, v92
    v_cmp_le_i32 vcc, 0, v13
    buffer_load_dwordx4 a[248:251], v3, s[60:63], s87 offen offset:2048 sc1
    v_mfma_f32_32x32x16_bf16 v[64:79], a[60:63], a[252:255], v[64:79]
    s_cbranch_vccnz L84
L85:
    ds_write_b128 v122, v[36:39] offset:1024
    v_mfma_f32_32x32x16_bf16 v[48:63], a[64:67], v[80:83], v[48:63]
    buffer_load_dwordx4 a[252:255], v3, s[60:63], s87 offen offset:3072 sc1
    s_add_u32 s87, s87, 4096
    v_mfma_f32_32x32x16_bf16 v[64:79], a[68:71], v[80:83], v[64:79]
    ds_write_b128 v123, v[40:43] offset:0
    v_mfma_f32_32x32x16_bf16 v[48:63], a[72:75], v[84:87], v[48:63]
    buffer_load_dwordx4 v[80:83], v3, s[60:63], s87 offen offset:0 sc1
    v_mfma_f32_32x32x16_bf16 v[64:79], a[76:79], v[84:87], v[64:79]
    ds_write_b128 v123, v[44:47] offset:1024
    v_mfma_f32_32x32x16_bf16 v[48:63], a[80:83], v[88:91], v[48:63]
    s_waitcnt vmcnt(13)
    v_max_i32 v13, v96, v100
    v_cmp_le_i32 vcc, 0, v13
    buffer_load_dwordx4 v[84:87], v3, s[60:63], s87 offen offset:1024 sc1
    v_mfma_f32_32x32x16_bf16 v[64:79], a[84:87], v[88:91], v[64:79]
    s_cbranch_vccnz L86
L87:
    s_waitcnt lgkmcnt(0)
    s_barrier
    v_mfma_f32_32x32x16_bf16 v[48:63], a[88:91], v[92:95], v[48:63]
    ds_read_b128 v[32:35], v120 offset:0
    ds_read_b128 v[36:39], v120 offset:1024
    v_mfma_f32_32x32x16_bf16 v[64:79], a[92:95], v[92:95], v[64:79]
    ds_read_b128 v[40:43], v120 offset:2048
    ds_read_b128 v[44:47], v120 offset:3072
    v_lshlrev_b32 v24, 16, v128
    v_and_b32 v25, s69, v128
    v_lshlrev_b32 v26, 16, v129
    v_mfma_f32_32x32x16_bf16 v[48:63], a[96:99], v[96:99], v[48:63]
    s_waitcnt vmcnt(11)
    v_max3_i32 v13, v104, v108, v112
    v_cmp_le_i32 vcc, 0, v13
    v_and_b32 v27, s69, v129
    v_lshlrev_b32 v28, 16, v130
    v_mfma_f32_32x32x16_bf16 v[64:79], a[100:103], v[96:99], v[64:79]
    s_cbranch_vccnz L88
L89:
    v_and_b32 v29, s69, v130
    v_lshlrev_b32 v30, 16, v131
    v_and_b32 v31, s69, v131
    v_mfma_f32_32x32x16_bf16 v[48:63], a[104:107], v[100:103], v[48:63]
    s_waitcnt lgkmcnt(2)
    v_add_f32 v16, v16, v32
    v_add_f32 v17, v17, v33
    v_add_f32 v18, v18, v34
    v_add_f32 v19, v19, v35
    v_mfma_f32_32x32x16_bf16 v[64:79], a[108:111], v[100:103], v[64:79]
    ds_read_b128 v[32:35], v120 offset:4096
    v_add_f32 v20, v20, v36
    v_add_f32 v21, v21, v37
    v_add_f32 v22, v22, v38
    v_add_f32 v23, v23, v39
    v_mfma_f32_32x32x16_bf16 v[48:63], a[112:115], v[104:107], v[48:63]
    ds_read_b128 v[36:39], v120 offset:5120
    s_waitcnt lgkmcnt(2)
    v_add_f32 v16, v16, v40
    v_add_f32 v17, v17, v41
    v_add_f32 v18, v18, v42
    v_mfma_f32_32x32x16_bf16 v[64:79], a[116:119], v[104:107], v[64:79]
    v_add_f32 v19, v19, v43
    v_add_f32 v20, v20, v44
    v_add_f32 v21, v21, v45
    v_add_f32 v22, v22, v46
    v_add_f32 v23, v23, v47
    s_waitcnt lgkmcnt(0)
    v_mfma_f32_32x32x16_bf16 v[48:63], a[120:123], v[108:111], v[48:63]
    s_waitcnt vmcnt(8)
    v_accvgpr_read_b32 v14, a224
    v_accvgpr_read_b32 v142, a228
    v_max3_i32 v13, v116, v14, v142
    v_cmp_le_i32 vcc, 0, v13
    v_mfma_f32_32x32x16_bf16 v[64:79], a[124:127], v[108:111], v[64:79]
    s_cbranch_vccnz L90
L91:
    v_add_f32 v16, v16, v32
    v_add_f32 v17, v17, v33
    v_add_f32 v18, v18, v34
    v_mfma_f32_32x32x16_bf16 v[48:63], a[128:131], v[112:115], v[48:63]
    v_add_f32 v19, v19, v35
    v_add_f32 v20, v20, v36
    v_add_f32 v21, v21, v37
    v_add_f32 v22, v22, v38
    v_add_f32 v23, v23, v39
    v_fmac_f32 v24, v16, v136
    v_mfma_f32_32x32x16_bf16 v[64:79], a[132:135], v[112:115], v[64:79]
    v_fmac_f32 v25, v17, v136
    v_fmac_f32 v26, v18, v136
    v_fmac_f32 v27, v19, v136
    v_fmac_f32 v28, v20, v136
    v_fmac_f32 v29, v21, v136
    v_fmac_f32 v30, v22, v136
    v_mfma_f32_32x32x16_bf16 v[48:63], a[136:139], v[116:119], v[48:63]
    s_waitcnt vmcnt(5)
    v_accvgpr_read_b32 v13, a232
    v_accvgpr_read_b32 v14, a236
    v_accvgpr_read_b32 v142, a240
    v_max3_i32 v13, v13, v14, v142
    v_mfma_f32_32x32x16_bf16 v[64:79], a[140:143], v[116:119], v[64:79]
    v_cmp_le_i32 vcc, 0, v13
    v_fmac_f32 v31, v23, v136
    v_cvt_pk_bf16_f32 v32, v24, v25
    v_cvt_pk_bf16_f32 v33, v26, v27
    v_cvt_pk_bf16_f32 v34, v28, v29
    v_mfma_f32_32x32x16_bf16 v[64:79], a[148:151], a[224:227], v[64:79]
    s_cbranch_vccnz L92
L93:
    v_cvt_pk_bf16_f32 v35, v30, v31
    v_permlane32_swap_b32 v32, v34
    v_mfma_f32_32x32x16_bf16 v[64:79], a[156:159], a[228:231], v[64:79]
    s_waitcnt vmcnt(2)
    v_accvgpr_read_b32 v13, a244
    v_accvgpr_read_b32 v14, a248
    v_accvgpr_read_b32 v142, a252
    v_max3_i32 v13, v13, v14, v142
    v_mfma_f32_32x32x16_bf16 v[64:79], a[164:167], a[232:235], v[64:79]
    v_cmp_le_i32 vcc, 0, v13
    v_permlane32_swap_b32 v33, v35
    v_mfma_f32_32x32x16_bf16 v[64:79], a[172:175], a[236:239], v[64:79]
    s_cbranch_vccnz L94
L95:
    ds_write_b128 v126, v[32:35] offset:0
    v_mfma_f32_32x32x16_bf16 v[64:79], a[180:183], a[240:243], v[64:79]
    s_waitcnt vmcnt(0)
    v_max_i32 v13, v80, v84
    v_cmp_le_i32 vcc, 0, v13
    v_mfma_f32_32x32x16_bf16 v[64:79], a[188:191], a[244:247], v[64:79]
    s_cbranch_vccnz L96
L97:
    s_waitcnt lgkmcnt(0)
    s_barrier
    v_mfma_f32_32x32x16_bf16 v[64:79], a[196:199], a[248:251], v[64:79]
    ds_read_b128 v[36:39], v140 offset:0
    v_mfma_f32_32x32x16_bf16 v[64:79], a[204:207], a[252:255], v[64:79]
    v_mfma_f32_32x32x16_bf16 v[64:79], a[212:215], v[80:83], v[64:79]
    v_mfma_f32_32x32x16_bf16 v[64:79], a[220:223], v[84:87], v[64:79]
    s_waitcnt lgkmcnt(0)
    global_store_dwordx4 v141, v[36:39], s[28:29] sc1
    v_mfma_f32_32x32x16_bf16 v[48:63], a[144:147], a[224:227], v[48:63]
    v_lshlrev_b32 v108, 16, v132
    v_and_b32 v109, s69, v132
    v_lshlrev_b32 v110, 16, v133
    v_and_b32 v111, s69, v133
    v_lshlrev_b32 v112, 16, v134
    v_and_b32 v113, s69, v134
    v_mfma_f32_32x32x16_bf16 v[48:63], a[152:155], a[228:231], v[48:63]
    v_lshlrev_b32 v114, 16, v135
    v_and_b32 v115, s69, v135
    v_mfma_f32_32x32x16_bf16 v[48:63], a[160:163], a[232:235], v[48:63]
    ds_write_b128 v122, v[64:67] offset:57344
    v_mfma_f32_32x32x16_bf16 v[48:63], a[168:171], a[236:239], v[48:63]
    v_mfma_f32_32x32x16_bf16 v[48:63], a[176:179], a[240:243], v[48:63]
    ds_write_b128 v122, v[68:71] offset:58368
    v_mfma_f32_32x32x16_bf16 v[48:63], a[184:187], a[244:247], v[48:63]
    v_mfma_f32_32x32x16_bf16 v[48:63], a[192:195], a[248:251], v[48:63]
    ds_write_b128 v123, v[72:75] offset:57344
    v_mfma_f32_32x32x16_bf16 v[48:63], a[200:203], a[252:255], v[48:63]
    v_mfma_f32_32x32x16_bf16 v[48:63], a[208:211], v[80:83], v[48:63]
    ds_write_b128 v123, v[76:79] offset:58368
    v_mfma_f32_32x32x16_bf16 v[48:63], a[216:219], v[84:87], v[48:63]
    s_nop 11
    ds_write_b128 v121, v[56:59] offset:57344
    ds_write_b128 v121, v[60:63] offset:58368
    v_pk_fma_f32 v[108:109], v[48:49], v[136:137], v[108:109] op_sel:[0,1,0]
    v_pk_fma_f32 v[110:111], v[50:51], v[136:137], v[110:111] op_sel:[0,1,0]
    v_pk_fma_f32 v[112:113], v[52:53], v[136:137], v[112:113] op_sel:[0,1,0]
    v_pk_fma_f32 v[114:115], v[54:55], v[136:137], v[114:115] op_sel:[0,1,0]
    s_waitcnt lgkmcnt(0)
    s_barrier
    ds_read_b128 v[56:59], v120 offset:57344
    ds_read_b128 v[60:63], v120 offset:58368
    ds_read_b128 v[64:67], v120 offset:59392
    ds_read_b128 v[68:71], v120 offset:60416
    ds_read_b128 v[72:75], v120 offset:61440
    ds_read_b128 v[76:79], v120 offset:62464
    s_waitcnt lgkmcnt(5)
    v_pk_fma_f32 v[108:109], v[56:57], v[136:137], v[108:109] op_sel:[0,1,0]
    v_pk_fma_f32 v[110:111], v[58:59], v[136:137], v[110:111] op_sel:[0,1,0]
    s_waitcnt lgkmcnt(4)
    v_pk_fma_f32 v[112:113], v[60:61], v[136:137], v[112:113] op_sel:[0,1,0]
    v_pk_fma_f32 v[114:115], v[62:63], v[136:137], v[114:115] op_sel:[0,1,0]
    s_waitcnt lgkmcnt(3)
    v_pk_fma_f32 v[108:109], v[64:65], v[136:137], v[108:109] op_sel:[0,1,0]
    v_pk_fma_f32 v[110:111], v[66:67], v[136:137], v[110:111] op_sel:[0,1,0]
    s_waitcnt lgkmcnt(2)
    v_pk_fma_f32 v[112:113], v[68:69], v[136:137], v[112:113] op_sel:[0,1,0]
    v_pk_fma_f32 v[114:115], v[70:71], v[136:137], v[114:115] op_sel:[0,1,0]
    s_waitcnt lgkmcnt(1)
    v_pk_fma_f32 v[108:109], v[72:73], v[136:137], v[108:109] op_sel:[0,1,0]
    v_pk_fma_f32 v[110:111], v[74:75], v[136:137], v[110:111] op_sel:[0,1,0]
    s_waitcnt lgkmcnt(0)
    v_pk_fma_f32 v[112:113], v[76:77], v[136:137], v[112:113] op_sel:[0,1,0]
    v_pk_fma_f32 v[114:115], v[78:79], v[136:137], v[114:115] op_sel:[0,1,0]
    v_cvt_pk_bf16_f32 v116, v108, v109
    v_cvt_pk_bf16_f32 v117, v110, v111
    v_cvt_pk_bf16_f32 v118, v112, v113
    v_cvt_pk_bf16_f32 v119, v114, v115
    s_nop 0
    v_permlane32_swap_b32 v116, v118
    v_permlane32_swap_b32 v117, v119
    global_store_dwordx4 v125, v[116:119], s[28:29]
    s_endpgm
L_helper:
    s_mov_b64 s[44:45], s[48:49]
    s_load_dwordx2 s[60:61], s[0:1], 112
    v_lshrrev_b32 v14, 6, v0
    s_and_b32 s35, s2, 7
    v_readfirstlane_b32 s34, v14
    s_lshl2_add_u32 s78, s35, s36
    v_bfe_u32 v44, v0, 4, 2
    v_and_b32 v18, 0xf0, v29
    s_lshl2_add_u32 s83, s78, s34
    s_mul_i32 s82, s83, 14336
    v_mul_u32_u24 v44, 896, v44
    v_add_u32 v18, v18, v44
    s_mov_b32 s90, 1835008
    s_mov_b32 s91, 0x20000
    s_mov_b32 s62, 134217728
    s_mov_b32 s63, 0x20000
    s_waitcnt lgkmcnt(0)
    buffer_load_dword v28, off, s[60:63], 0 sc1
    s_mov_b32 exec_lo, 0x3fff3fff
    s_mov_b32 exec_hi, 0x3fff3fff
    buffer_load_dwordx4 v[64:67], v18, s[88:91], s82 offen offset:0
    buffer_load_dwordx4 v[68:71], v18, s[88:91], s82 offen offset:224
    buffer_load_dwordx4 v[72:75], v18, s[88:91], s82 offen offset:448
    buffer_load_dwordx4 v[76:79], v18, s[88:91], s82 offen offset:672
    s_add_u32 s82, s82, 3584
    buffer_load_dwordx4 v[80:83], v18, s[88:91], s82 offen offset:0
    buffer_load_dwordx4 v[84:87], v18, s[88:91], s82 offen offset:224
    buffer_load_dwordx4 v[88:91], v18, s[88:91], s82 offen offset:448
    buffer_load_dwordx4 v[92:95], v18, s[88:91], s82 offen offset:672
    s_add_u32 s82, s82, 3584
    buffer_load_dwordx4 v[96:99], v18, s[88:91], s82 offen offset:0
    buffer_load_dwordx4 v[100:103], v18, s[88:91], s82 offen offset:224
    buffer_load_dwordx4 v[104:107], v18, s[88:91], s82 offen offset:448
    buffer_load_dwordx4 v[108:111], v18, s[88:91], s82 offen offset:672
    s_add_u32 s82, s82, 3584
    buffer_load_dwordx4 v[112:115], v18, s[88:91], s82 offen offset:0
    buffer_load_dwordx4 v[116:119], v18, s[88:91], s82 offen offset:224
    buffer_load_dwordx4 v[120:123], v18, s[88:91], s82 offen offset:448
    buffer_load_dwordx4 v[124:127], v18, s[88:91], s82 offen offset:672
    s_mov_b64 exec, -1
    s_mov_b32 s47, 0
    s_mul_i32 s68, s34, 7168
    s_mov_b32 s70, 0x3b124925
    s_mov_b32 s71, 0x3b124925
    s_mov_b32 s72, 0x3727c5ac
    s_mov_b32 s69, 0xffff0000
    s_mov_b32 s73, 0x3f803f80
    v_and_b32 v1, 63, v0
    v_lshlrev_b32 v3, 4, v1
    v_lshrrev_b32 v44, 4, v1
    v_lshrrev_b32 v16, 5, v1
    v_and_b32 v17, 31, v1
    v_lshlrev_b32 v2, 8, v16
    v_bfe_u32 v40, v1, 2, 2
    v_lshl_or_b32 v2, v40, 6, v2
    v_bfe_u32 v42, v1, 4, 1
    v_lshl_or_b32 v2, v42, 5, v2
    v_and_b32 v43, 3, v1
    v_lshl_or_b32 v2, v43, 3, v2
    v_mov_b32 v48, 0
    v_mov_b32 v49, 0
    v_mov_b32 v50, 0
    v_mov_b32 v51, 0
    v_mov_b32 v52, 0
    v_mov_b32 v53, 0
    v_mov_b32 v54, 0
    v_mov_b32 v55, 0
    v_mov_b32 v0, v29
    s_lshr_b32 s48, s83, 6
    s_lshl_b32 s48, s48, 13
    s_and_b32 s49, s83, 63
    s_lshl_b32 s49, s49, 6
    s_add_u32 s48, s48, s49
    s_add_u32 s82, s48, 196608
    v_lshlrev_b32 v19, 12, v16
    v_lshl_add_u32 v19, v42, 3, v19
    v_lshl_add_u32 v19, v43, 4, v19
    s_mov_b32 exec_lo, 0x3fff3fff
    s_mov_b32 exec_hi, 0x3fff3fff
    s_waitcnt vmcnt(15)
    v_dot2c_f32_bf16 v48, s73, v64
    v_dot2c_f32_bf16 v49, v64, v64
    v_dot2c_f32_bf16 v48, s73, v65
    v_dot2c_f32_bf16 v49, v65, v65
    v_dot2c_f32_bf16 v48, s73, v66
    v_dot2c_f32_bf16 v49, v66, v66
    v_dot2c_f32_bf16 v48, s73, v67
    v_dot2c_f32_bf16 v49, v67, v67
    s_waitcnt vmcnt(14)
    v_dot2c_f32_bf16 v48, s73, v68
    v_dot2c_f32_bf16 v49, v68, v68
    v_dot2c_f32_bf16 v48, s73, v69
    v_dot2c_f32_bf16 v49, v69, v69
    v_dot2c_f32_bf16 v48, s73, v70
    v_dot2c_f32_bf16 v49, v70, v70
    v_dot2c_f32_bf16 v48, s73, v71
    v_dot2c_f32_bf16 v49, v71, v71
    s_waitcnt vmcnt(13)
    v_dot2c_f32_bf16 v48, s73, v72
    v_dot2c_f32_bf16 v49, v72, v72
    v_dot2c_f32_bf16 v48, s73, v73
    v_dot2c_f32_bf16 v49, v73, v73
    v_dot2c_f32_bf16 v48, s73, v74
    v_dot2c_f32_bf16 v49, v74, v74
    v_dot2c_f32_bf16 v48, s73, v75
    v_dot2c_f32_bf16 v49, v75, v75
    s_waitcnt vmcnt(12)
    v_dot2c_f32_bf16 v48, s73, v76
    v_dot2c_f32_bf16 v49, v76, v76
    v_dot2c_f32_bf16 v48, s73, v77
    v_dot2c_f32_bf16 v49, v77, v77
    v_dot2c_f32_bf16 v48, s73, v78
    v_dot2c_f32_bf16 v49, v78, v78
    v_dot2c_f32_bf16 v48, s73, v79
    v_dot2c_f32_bf16 v49, v79, v79
    s_waitcnt vmcnt(11)
    v_dot2c_f32_bf16 v50, s73, v80
    v_dot2c_f32_bf16 v51, v80, v80
    v_dot2c_f32_bf16 v50, s73, v81
    v_dot2c_f32_bf16 v51, v81, v81
    v_dot2c_f32_bf16 v50, s73, v82
    v_dot2c_f32_bf16 v51, v82, v82
    v_dot2c_f32_bf16 v50, s73, v83
    v_dot2c_f32_bf16 v51, v83, v83
    s_waitcnt vmcnt(10)
    v_dot2c_f32_bf16 v50, s73, v84
    v_dot2c_f32_bf16 v51, v84, v84
    v_dot2c_f32_bf16 v50, s73, v85
    v_dot2c_f32_bf16 v51, v85, v85
    v_dot2c_f32_bf16 v50, s73, v86
    v_dot2c_f32_bf16 v51, v86, v86
    v_dot2c_f32_bf16 v50, s73, v87
    v_dot2c_f32_bf16 v51, v87, v87
    s_waitcnt vmcnt(9)
    v_dot2c_f32_bf16 v50, s73, v88
    v_dot2c_f32_bf16 v51, v88, v88
    v_dot2c_f32_bf16 v50, s73, v89
    v_dot2c_f32_bf16 v51, v89, v89
    v_dot2c_f32_bf16 v50, s73, v90
    v_dot2c_f32_bf16 v51, v90, v90
    v_dot2c_f32_bf16 v50, s73, v91
    v_dot2c_f32_bf16 v51, v91, v91
    s_waitcnt vmcnt(8)
    v_dot2c_f32_bf16 v50, s73, v92
    v_dot2c_f32_bf16 v51, v92, v92
    v_dot2c_f32_bf16 v50, s73, v93
    v_dot2c_f32_bf16 v51, v93, v93
    v_dot2c_f32_bf16 v50, s73, v94
    v_dot2c_f32_bf16 v51, v94, v94
    v_dot2c_f32_bf16 v50, s73, v95
    v_dot2c_f32_bf16 v51, v95, v95
    s_waitcnt vmcnt(7)
    v_dot2c_f32_bf16 v52, s73, v96
    v_dot2c_f32_bf16 v53, v96, v96
    v_dot2c_f32_bf16 v52, s73, v97
    v_dot2c_f32_bf16 v53, v97, v97
    v_dot2c_f32_bf16 v52, s73, v98
    v_dot2c_f32_bf16 v53, v98, v98
    v_dot2c_f32_bf16 v52, s73, v99
    v_dot2c_f32_bf16 v53, v99, v99
    s_waitcnt vmcnt(6)
    v_dot2c_f32_bf16 v52, s73, v100
    v_dot2c_f32_bf16 v53, v100, v100
    v_dot2c_f32_bf16 v52, s73, v101
    v_dot2c_f32_bf16 v53, v101, v101
    v_dot2c_f32_bf16 v52, s73, v102
    v_dot2c_f32_bf16 v53, v102, v102
    v_dot2c_f32_bf16 v52, s73, v103
    v_dot2c_f32_bf16 v53, v103, v103
    s_waitcnt vmcnt(5)
    v_dot2c_f32_bf16 v52, s73, v104
    v_dot2c_f32_bf16 v53, v104, v104
    v_dot2c_f32_bf16 v52, s73, v105
    v_dot2c_f32_bf16 v53, v105, v105
    v_dot2c_f32_bf16 v52, s73, v106
    v_dot2c_f32_bf16 v53, v106, v106
    v_dot2c_f32_bf16 v52, s73, v107
    v_dot2c_f32_bf16 v53, v107, v107
    s_waitcnt vmcnt(4)
    v_dot2c_f32_bf16 v52, s73, v108
    v_dot2c_f32_bf16 v53, v108, v108
    v_dot2c_f32_bf16 v52, s73, v109
    v_dot2c_f32_bf16 v53, v109, v109
    v_dot2c_f32_bf16 v52, s73, v110
    v_dot2c_f32_bf16 v53, v110, v110
    v_dot2c_f32_bf16 v52, s73, v111
    v_dot2c_f32_bf16 v53, v111, v111
    s_waitcnt vmcnt(3)
    v_dot2c_f32_bf16 v54, s73, v112
    v_dot2c_f32_bf16 v55, v112, v112
    v_dot2c_f32_bf16 v54, s73, v113
    v_dot2c_f32_bf16 v55, v113, v113
    v_dot2c_f32_bf16 v54, s73, v114
    v_dot2c_f32_bf16 v55, v114, v114
    v_dot2c_f32_bf16 v54, s73, v115
    v_dot2c_f32_bf16 v55, v115, v115
    s_waitcnt vmcnt(2)
    v_dot2c_f32_bf16 v54, s73, v116
    v_dot2c_f32_bf16 v55, v116, v116
    v_dot2c_f32_bf16 v54, s73, v117
    v_dot2c_f32_bf16 v55, v117, v117
    v_dot2c_f32_bf16 v54, s73, v118
    v_dot2c_f32_bf16 v55, v118, v118
    v_dot2c_f32_bf16 v54, s73, v119
    v_dot2c_f32_bf16 v55, v119, v119
    s_waitcnt vmcnt(1)
    v_dot2c_f32_bf16 v54, s73, v120
    v_dot2c_f32_bf16 v55, v120, v120
    v_dot2c_f32_bf16 v54, s73, v121
    v_dot2c_f32_bf16 v55, v121, v121
    v_dot2c_f32_bf16 v54, s73, v122
    v_dot2c_f32_bf16 v55, v122, v122
    v_dot2c_f32_bf16 v54, s73, v123
    v_dot2c_f32_bf16 v55, v123, v123
    s_waitcnt vmcnt(0)
    v_dot2c_f32_bf16 v54, s73, v124
    v_dot2c_f32_bf16 v55, v124, v124
    v_dot2c_f32_bf16 v54, s73, v125
    v_dot2c_f32_bf16 v55, v125, v125
    v_dot2c_f32_bf16 v54, s73, v126
    v_dot2c_f32_bf16 v55, v126, v126
    v_dot2c_f32_bf16 v54, s73, v127
    v_dot2c_f32_bf16 v55, v127, v127
    s_mov_b64 exec, -1
    v_add_f32_dpp v48, v48, v48 quad_perm:[1,0,3,2] row_mask:0xf bank_mask:0xf
    v_add_f32_dpp v49, v49, v49 quad_perm:[1,0,3,2] row_mask:0xf bank_mask:0xf
    v_add_f32_dpp v50, v50, v50 quad_perm:[1,0,3,2] row_mask:0xf bank_mask:0xf
    v_add_f32_dpp v51, v51, v51 quad_perm:[1,0,3,2] row_mask:0xf bank_mask:0xf
    v_add_f32_dpp v52, v52, v52 quad_perm:[1,0,3,2] row_mask:0xf bank_mask:0xf
    v_add_f32_dpp v53, v53, v53 quad_perm:[1,0,3,2] row_mask:0xf bank_mask:0xf
    v_add_f32_dpp v54, v54, v54 quad_perm:[1,0,3,2] row_mask:0xf bank_mask:0xf
    v_add_f32_dpp v55, v55, v55 quad_perm:[1,0,3,2] row_mask:0xf bank_mask:0xf
    v_add_f32_dpp v48, v48, v48 quad_perm:[2,3,0,1] row_mask:0xf bank_mask:0xf
    v_add_f32_dpp v49, v49, v49 quad_perm:[2,3,0,1] row_mask:0xf bank_mask:0xf
    v_add_f32_dpp v50, v50, v50 quad_perm:[2,3,0,1] row_mask:0xf bank_mask:0xf
    v_add_f32_dpp v51, v51, v51 quad_perm:[2,3,0,1] row_mask:0xf bank_mask:0xf
    v_add_f32_dpp v52, v52, v52 quad_perm:[2,3,0,1] row_mask:0xf bank_mask:0xf
    v_add_f32_dpp v53, v53, v53 quad_perm:[2,3,0,1] row_mask:0xf bank_mask:0xf
    v_add_f32_dpp v54, v54, v54 quad_perm:[2,3,0,1] row_mask:0xf bank_mask:0xf
    v_add_f32_dpp v55, v55, v55 quad_perm:[2,3,0,1] row_mask:0xf bank_mask:0xf
    v_add_f32_dpp v48, v48, v48 row_half_mirror row_mask:0xf bank_mask:0xf
    v_add_f32_dpp v49, v49, v49 row_half_mirror row_mask:0xf bank_mask:0xf
    v_add_f32_dpp v50, v50, v50 row_half_mirror row_mask:0xf bank_mask:0xf
    v_add_f32_dpp v51, v51, v51 row_half_mirror row_mask:0xf bank_mask:0xf
    v_add_f32_dpp v52, v52, v52 row_half_mirror row_mask:0xf bank_mask:0xf
    v_add_f32_dpp v53, v53, v53 row_half_mirror row_mask:0xf bank_mask:0xf
    v_add_f32_dpp v54, v54, v54 row_half_mirror row_mask:0xf bank_mask:0xf
    v_add_f32_dpp v55, v55, v55 row_half_mirror row_mask:0xf bank_mask:0xf
    v_add_f32_dpp v48, v48, v48 row_mirror row_mask:0xf bank_mask:0xf
    v_add_f32_dpp v49, v49, v49 row_mirror row_mask:0xf bank_mask:0xf
    v_add_f32_dpp v50, v50, v50 row_mirror row_mask:0xf bank_mask:0xf
    v_add_f32_dpp v51, v51, v51 row_mirror row_mask:0xf bank_mask:0xf
    v_add_f32_dpp v52, v52, v52 row_mirror row_mask:0xf bank_mask:0xf
    v_add_f32_dpp v53, v53, v53 row_mirror row_mask:0xf bank_mask:0xf
    v_add_f32_dpp v54, v54, v54 row_mirror row_mask:0xf bank_mask:0xf
    v_add_f32_dpp v55, v55, v55 row_mirror row_mask:0xf bank_mask:0xf
    v_cmp_eq_u32 vcc, 1, v43
    s_nop 1
    v_cndmask_b32 v48, v48, v50, vcc
    v_cndmask_b32 v49, v49, v51, vcc
    v_cmp_eq_u32 vcc, 2, v43
    s_nop 1
    v_cndmask_b32 v48, v48, v52, vcc
    v_cndmask_b32 v49, v49, v53, vcc
    v_cmp_eq_u32 vcc, 3, v43
    s_nop 1
    v_cndmask_b32 v48, v48, v54, vcc
    v_cndmask_b32 v49, v49, v55, vcc
    v_mul_f32 v48, s70, v48
    v_mul_f32 v49, s70, v49
    v_fma_f32 v49, -v48, v48, v49
    v_max_f32 v49, 0, v49
    v_add_f32 v49, s72, v49
    v_rsq_f32 v49, v49
    s_nop 0
    v_mul_f32_e64 v48, -v48, v49
    s_mov_b32 exec_lo, 0xf000f
    s_mov_b32 exec_hi, 0xf000f
    buffer_store_dwordx2 v[48:49], v19, s[60:63], s82 offen sc1
    s_mov_b64 exec, -1
    v_readfirstlane_b32 s38, v28
    s_add_u32 s38, s38, 16
    s_and_b32 s38, s38, 0xfffffff0
    s_waitcnt vmcnt(0)
    s_barrier
    s_cmp_lg_u32 s34, 0
    s_cbranch_scc1 L98
    s_getreg_b32 s48, hwreg(HW_REG_XCC_ID, 0, 4)
    s_or_b32 s48, s48, s38
    s_lshl_b32 s49, s2, 4
    s_add_u32 s49, s49, 229376
    v_mov_b32 v13, s48
    v_lshlrev_b32 v14, 12, v1
    s_mov_b64 exec, 0xff
    buffer_store_dword v13, v14, s[60:63], s49 offen sc1
    s_mov_b64 exec, -1
L98:
    v_mov_b32 v60, -1
    v_mov_b32 v61, -1
    v_mov_b32 v62, -1
    v_mov_b32 v63, -1
    s_lshl_b32 s75, s2, 12
    s_add_u32 s75, s75, 3145728
    s_mov_b32 s76, 15
L99:
    buffer_store_dwordx4 v[60:63], v0, s[60:63], s75 offen sc1
    s_add_u32 s75, s75, 131072
    s_sub_u32 s76, s76, 1
    s_cmp_lg_u32 s76, 0
    s_waitcnt vmcnt(40)
    s_cbranch_scc1 L99
    s_waitcnt vmcnt(0)
    s_barrier
    s_lshl_b32 s49, s2, 4
    s_add_u32 s49, s49, 180224
    v_mov_b32 v13, s38
    v_lshlrev_b32 v14, 10, v1
    s_cmp_lg_u32 s34, 0
    s_cbranch_scc1 L99x
    s_mov_b64 exec, 0xff
    buffer_store_dword v13, v14, s[60:63], s49 offen sc1
    s_mov_b64 exec, -1
L99x:
    s_lshl_b32 s75, s2, 12
    s_add_u32 s75, s75, 7340032
    s_mov_b32 s76, 18
L100:
    buffer_store_dwordx4 v[60:63], v0, s[60:63], s75 offen sc1
    s_add_u32 s75, s75, 131072
    s_sub_u32 s76, s76, 1
    s_cmp_lg_u32 s76, 0
    s_waitcnt vmcnt(40)
    s_cbranch_scc1 L100
    s_waitcnt vmcnt(0)
    s_barrier
    s_lshl_b32 s49, s2, 4
    s_add_u32 s49, s49, 172032
    v_mov_b32 v13, s38
    v_lshlrev_b32 v14, 10, v1
    s_cmp_lg_u32 s34, 0
    s_cbranch_scc1 L100x
    s_mov_b64 exec, 0xff
    buffer_store_dword v13, v14, s[60:63], s49 offen sc1
    s_mov_b64 exec, -1
L100x:
    v_and_b32 v17, 3, v1
    v_lshlrev_b32 v17, 8, v17
    s_lshr_b32 s49, s78, 1
    s_lshl_b32 s49, s49, 10
    s_and_b32 s48, s78, 1
    s_lshl_b32 s48, s48, 7
    s_add_u32 s49, s49, s48
    s_add_u32 s49, s49, 131072
    buffer_load_dword v19, v17, s[60:63], s49 offen
    s_lshl_b32 s96, s35, 10
    s_add_u32 s96, s96, 172032
    v_and_b32 v40, 0x1f0, v3
    buffer_load_dword v41, v40, s[60:63], s96 offen sc1
    s_waitcnt vmcnt(0)
    v_cmp_ne_u32 vcc, s38, v41
    s_cbranch_vccnz L101
L102:
    s_mul_i32 s80, s78, 28928
    s_add_u32 s80, s80, s68
    s_add_u32 s80, s80, 3145728
    s_lshl_b32 s81, s78, 7
    s_add_u32 s81, s81, 9191424
    s_mov_b32 s82, 0
    v_add_u32 v16, s68, v2
    v_and_b32 v20, 31, v1
    v_lshrrev_b32 v21, 5, v1
    v_lshlrev_b32 v18, 5, v20
    v_add_u32 v18, 28672, v18
    v_lshl_add_u32 v17, v21, 2, v18
    s_lshl_b32 s48, s34, 3
    v_add_u32 v17, s48, v17
    v_lshrrev_b32 v19, 2, v20
    v_lshlrev_b32 v19, 4, v19
    v_lshl_add_u32 v19, v21, 2, v19
    v_and_b32 v21, 1, v20
    v_lshl_add_u32 v19, v21, 3, v19
    v_bfe_u32 v21, v20, 1, 1
    v_lshl_add_u32 v19, v21, 12, v19
    s_mov_b32 s92, 0
    s_mov_b32 s93, -1
L_job:
    s_lshl2_add_u32 s84, s78, s82
    s_lshl_b32 s84, s84, 8
    s_add_u32 s84, s84, 98304
    s_add_u32 s83, s80, 4096
L103:
    buffer_load_dword v22, off, s[60:63], s83 offset:3068 sc1
    s_waitcnt vmcnt(0)
    v_cmp_eq_u32 vcc, -1, v22
    s_cbranch_vccz L104
    s_add_u32 s47, s47, 1
    s_cmp_lt_u32 s47, 262144
    s_cbranch_scc1 L103
L104:
L105:
    s_mov_b32 m0, s68
    s_nop 0
    buffer_load_dwordx4 v3, s[60:63], s80 offen offset:0 sc1 lds
    buffer_load_dwordx4 v3, s[60:63], s80 offen offset:1024 sc1 lds
    buffer_load_dwordx4 v3, s[60:63], s80 offen offset:2048 sc1 lds
    buffer_load_dwordx4 v3, s[60:63], s80 offen offset:3072 sc1 lds
    s_add_u32 m0, s68, 4096
    s_nop 0
    buffer_load_dwordx4 v3, s[60:63], s83 offen offset:0 sc1 lds
    buffer_load_dwordx4 v3, s[60:63], s83 offen offset:1024 sc1 lds
    buffer_load_dwordx4 v3, s[60:63], s83 offen offset:2048 sc1 lds
    v_mov_b32 v22, 0
    v_mov_b32 v23, 0
    v_mov_b32 v24, 0
    s_waitcnt vmcnt(6)
    ds_read_b64_tr_b16 v[32:33], v16 offset:0
    ds_read_b64_tr_b16 v[34:35], v16 offset:512
    s_waitcnt vmcnt(5)
    ds_read_b64_tr_b16 v[36:37], v16 offset:1024
    ds_read_b64_tr_b16 v[38:39], v16 offset:1536
    s_waitcnt vmcnt(4)
    ds_read_b64_tr_b16 v[40:41], v16 offset:2048
    ds_read_b64_tr_b16 v[42:43], v16 offset:2560
    s_waitcnt vmcnt(3)
    ds_read_b64_tr_b16 v[44:45], v16 offset:3072
    ds_read_b64_tr_b16 v[46:47], v16 offset:3584
    s_waitcnt vmcnt(2)
    ds_read_b64_tr_b16 v[48:49], v16 offset:4096
    ds_read_b64_tr_b16 v[50:51], v16 offset:4608
    s_waitcnt vmcnt(1)
    ds_read_b64_tr_b16 v[52:53], v16 offset:5120
    ds_read_b64_tr_b16 v[54:55], v16 offset:5632
    s_waitcnt vmcnt(0)
    ds_read_b64_tr_b16 v[56:57], v16 offset:6144
    ds_read_b64_tr_b16 v[58:59], v16 offset:6656
    s_waitcnt lgkmcnt(12)
    v_dot2c_f32_bf16 v22, s73, v32
    v_dot2c_f32_bf16 v23, v32, v32
    v_pk_max_u16 v24, v24, v32
    v_dot2c_f32_bf16 v22, s73, v33
    v_dot2c_f32_bf16 v23, v33, v33
    v_pk_max_u16 v24, v24, v33
    v_dot2c_f32_bf16 v22, s73, v34
    v_dot2c_f32_bf16 v23, v34, v34
    v_pk_max_u16 v24, v24, v34
    v_dot2c_f32_bf16 v22, s73, v35
    v_dot2c_f32_bf16 v23, v35, v35
    v_pk_max_u16 v24, v24, v35
    s_waitcnt lgkmcnt(10)
    v_dot2c_f32_bf16 v22, s73, v36
    v_dot2c_f32_bf16 v23, v36, v36
    v_pk_max_u16 v24, v24, v36
    v_dot2c_f32_bf16 v22, s73, v37
    v_dot2c_f32_bf16 v23, v37, v37
    v_pk_max_u16 v24, v24, v37
    v_dot2c_f32_bf16 v22, s73, v38
    v_dot2c_f32_bf16 v23, v38, v38
    v_pk_max_u16 v24, v24, v38
    v_dot2c_f32_bf16 v22, s73, v39
    v_dot2c_f32_bf16 v23, v39, v39
    v_pk_max_u16 v24, v24, v39
    s_waitcnt lgkmcnt(8)
    v_dot2c_f32_bf16 v22, s73, v40
    v_dot2c_f32_bf16 v23, v40, v40
    v_pk_max_u16 v24, v24, v40
    v_dot2c_f32_bf16 v22, s73, v41
    v_dot2c_f32_bf16 v23, v41, v41
    v_pk_max_u16 v24, v24, v41
    v_dot2c_f32_bf16 v22, s73, v42
    v_dot2c_f32_bf16 v23, v42, v42
    v_pk_max_u16 v24, v24, v42
    v_dot2c_f32_bf16 v22, s73, v43
    v_dot2c_f32_bf16 v23, v43, v43
    v_pk_max_u16 v24, v24, v43
    s_waitcnt lgkmcnt(6)
    v_dot2c_f32_bf16 v22, s73, v44
    v_dot2c_f32_bf16 v23, v44, v44
    v_pk_max_u16 v24, v24, v44
    v_dot2c_f32_bf16 v22, s73, v45
    v_dot2c_f32_bf16 v23, v45, v45
    v_pk_max_u16 v24, v24, v45
    v_dot2c_f32_bf16 v22, s73, v46
    v_dot2c_f32_bf16 v23, v46, v46
    v_pk_max_u16 v24, v24, v46
    v_dot2c_f32_bf16 v22, s73, v47
    v_dot2c_f32_bf16 v23, v47, v47
    v_pk_max_u16 v24, v24, v47
    s_waitcnt lgkmcnt(4)
    v_dot2c_f32_bf16 v22, s73, v48
    v_dot2c_f32_bf16 v23, v48, v48
    v_pk_max_u16 v24, v24, v48
    v_dot2c_f32_bf16 v22, s73, v49
    v_dot2c_f32_bf16 v23, v49, v49
    v_pk_max_u16 v24, v24, v49
    v_dot2c_f32_bf16 v22, s73, v50
    v_dot2c_f32_bf16 v23, v50, v50
    v_pk_max_u16 v24, v24, v50
    v_dot2c_f32_bf16 v22, s73, v51
    v_dot2c_f32_bf16 v23, v51, v51
    v_pk_max_u16 v24, v24, v51
    s_waitcnt lgkmcnt(2)
    v_dot2c_f32_bf16 v22, s73, v52
    v_dot2c_f32_bf16 v23, v52, v52
    v_pk_max_u16 v24, v24, v52
    v_dot2c_f32_bf16 v22, s73, v53
    v_dot2c_f32_bf16 v23, v53, v53
    v_pk_max_u16 v24, v24, v53
    v_dot2c_f32_bf16 v22, s73, v54
    v_dot2c_f32_bf16 v23, v54, v54
    v_pk_max_u16 v24, v24, v54
    v_dot2c_f32_bf16 v22, s73, v55
    v_dot2c_f32_bf16 v23, v55, v55
    v_pk_max_u16 v24, v24, v55
    s_waitcnt lgkmcnt(0)
    v_dot2c_f32_bf16 v22, s73, v56
    v_dot2c_f32_bf16 v23, v56, v56
    v_pk_max_u16 v24, v24, v56
    v_dot2c_f32_bf16 v22, s73, v57
    v_dot2c_f32_bf16 v23, v57, v57
    v_pk_max_u16 v24, v24, v57
    v_dot2c_f32_bf16 v22, s73, v58
    v_dot2c_f32_bf16 v23, v58, v58
    v_pk_max_u16 v24, v24, v58
    v_dot2c_f32_bf16 v22, s73, v59
    v_dot2c_f32_bf16 v23, v59, v59
    v_pk_max_u16 v24, v24, v59
    v_lshrrev_b32 v25, 16, v24
    v_pk_max_u16 v24, v24, v25
    v_and_b32 v24, 0xffff, v24
    v_cmp_eq_u32 vcc, 0xffff, v24
    s_cbranch_vccz L106
    s_add_u32 s47, s47, 1
    s_cmp_lt_u32 s47, 262144
    s_cbranch_scc1 L105
L106:
    v_permlane32_swap_b32 v22, v23
    v_add_f32 v22, v22, v23
    ds_write_b32 v17, v22
    s_waitcnt lgkmcnt(0)
    s_barrier
    s_cmp_lg_u32 s34, 0
    s_cbranch_scc1 L107
    ds_read_b128 v[24:27], v18
    ds_read_b128 v[28:31], v18 offset:16
    s_waitcnt lgkmcnt(0)
    v_pk_add_f32 v[24:25], v[24:25], v[26:27]
    v_pk_add_f32 v[28:29], v[28:29], v[30:31]
    v_pk_add_f32 v[24:25], v[24:25], v[28:29]
    v_pk_mul_f32 v[24:25], v[24:25], s[70:71]
    v_fma_f32 v25, -v24, v24, v25
    v_max_f32 v25, 0, v25
    v_add_f32 v25, s72, v25
    v_rsq_f32 v25, v25
    s_nop 0
    v_cndmask_b32 v24, v24, v25, s[92:93]
    buffer_store_dword v24, v19, s[60:63], s81 offen sc1
L107:
    v_xor_b32 v17, 1024, v17
    v_xor_b32 v18, 1024, v18
    s_add_u32 s80, s80, 925696
    s_add_u32 s81, s81, 8192
    s_add_u32 s82, s82, 1
    s_bitcmp1_b32 s82, 0
    s_cbranch_scc1 L_job
    s_cmp_eq_u32 s82, 4
    s_cbranch_scc1 L_jobs_done
    s_add_u32 s80, s80, 245760
    s_add_u32 s81, s81, 16384
    s_sub_u32 s75, s80, s68
    buffer_store_dwordx4 v[60:63], v0, s[60:63], s75 offen sc1
    s_add_u32 s75, s75, 4096
    buffer_store_dwordx4 v[60:63], v0, s[60:63], s75 offen sc1
    s_add_u32 s75, s75, 4096
    buffer_store_dwordx4 v[60:63], v0, s[60:63], s75 offen sc1
    s_add_u32 s75, s75, 4096
    buffer_store_dwordx4 v[60:63], v0, s[60:63], s75 offen sc1
    s_add_u32 s75, s75, 4096
    buffer_store_dwordx4 v[60:63], v0, s[60:63], s75 offen sc1
    s_add_u32 s75, s75, 4096
    buffer_store_dwordx4 v[60:63], v0, s[60:63], s75 offen sc1
    s_add_u32 s75, s75, 4096
    buffer_store_dwordx4 v[60:63], v0, s[60:63], s75 offen sc1
    s_add_u32 s75, s75, 901120
    buffer_store_dwordx4 v[60:63], v0, s[60:63], s75 offen sc1
    s_add_u32 s75, s75, 4096
    buffer_store_dwordx4 v[60:63], v0, s[60:63], s75 offen sc1
    s_add_u32 s75, s75, 4096
    buffer_store_dwordx4 v[60:63], v0, s[60:63], s75 offen sc1
    s_add_u32 s75, s75, 4096
    buffer_store_dwordx4 v[60:63], v0, s[60:63], s75 offen sc1
    s_add_u32 s75, s75, 4096
    buffer_store_dwordx4 v[60:63], v0, s[60:63], s75 offen sc1
    s_add_u32 s75, s75, 4096
    buffer_store_dwordx4 v[60:63], v0, s[60:63], s75 offen sc1
    s_add_u32 s75, s75, 4096
    buffer_store_dwordx4 v[60:63], v0, s[60:63], s75 offen sc1
    s_add_u32 s75, s75, 4096
    s_waitcnt vmcnt(0)
    s_barrier
    s_lshr_b32 s49, s34, 1
    s_and_b32 s51, s34, 1
    s_lshl_b32 s48, s49, 5
    s_add_u32 s48, s48, s78
    s_lshl1_add_u32 s48, s48, s51
    s_mul_i32 s48, s48, 3584
    s_add_u32 s48, s48, 9240576
    s_lshl_b32 s50, s49, 13
    s_add_u32 s50, s50, s81
    s_sub_u32 s50, s50, 16384
    s_lshl_b32 s51, s51, 6
    s_add_u32 s50, s50, s51
    v_and_b32 v26, 0x30, v3
    v_bfe_u32 v27, v1, 4, 1
    v_lshl_add_u32 v26, v27, 12, v26
    v_lshrrev_b32 v27, 5, v1
    v_lshl_add_u32 v26, v27, 3, v26
    v_mov_b32 v64, 0
    v_mov_b32 v65, 0
    v_mov_b32 v66, 0
    v_mov_b32 v67, 0
    v_mov_b32 v68, 0
    v_mov_b32 v69, 0
    v_mov_b32 v70, 0
    v_mov_b32 v71, 0
    v_mov_b32 v72, 0
    v_mov_b32 v73, 0
    v_mov_b32 v74, 0
    v_mov_b32 v75, 0
    v_mov_b32 v76, 0
    v_mov_b32 v77, 0
    v_mov_b32 v78, 0
    v_mov_b32 v79, 0
    v_mov_b32 v80, 0
    v_mov_b32 v81, 0
    v_mov_b32 v82, 0
    v_mov_b32 v83, 0
    v_mov_b32 v84, 0
    v_mov_b32 v85, 0
    v_mov_b32 v86, 0
    v_mov_b32 v87, 0
    v_mov_b32 v88, 0
    v_mov_b32 v89, 0
    v_mov_b32 v90, 0
    v_mov_b32 v91, 0
    v_mov_b32 v92, 0
    v_mov_b32 v93, 0
    v_mov_b32 v94, 0
    v_mov_b32 v95, 0
L108:
    s_mov_b32 exec_hi, 0x00ffffff
    buffer_load_dwordx4 v[64:67], v3, s[60:63], s48 offen offset:0 sc1
    buffer_load_dwordx4 v[68:71], v3, s[60:63], s48 offen offset:896 sc1
    buffer_load_dwordx4 v[72:75], v3, s[60:63], s48 offen offset:1792 sc1
    buffer_load_dwordx4 v[76:79], v3, s[60:63], s48 offen offset:2688 sc1
    s_mov_b32 exec_hi, -1
    s_waitcnt vmcnt(0)
    v_pk_add_f32 v[32:33], v[64:65], v[68:69]
    v_pk_add_f32 v[34:35], v[66:67], v[70:71]
    v_pk_add_f32 v[36:37], v[72:73], v[76:77]
    v_pk_add_f32 v[38:39], v[74:75], v[78:79]
    v_pk_add_f32 v[32:33], v[32:33], v[36:37]
    v_pk_add_f32 v[34:35], v[34:35], v[38:39]
    s_nop 0
    v_permlane32_swap_b32 v32, v33
    v_permlane32_swap_b32 v34, v35
    v_add_f32 v32, v32, v33
    v_add_f32 v34, v34, v35
    s_nop 1
    v_permlane16_swap_b32 v32, v34
    v_add_f32 v32, v32, v34
    v_cmp_u_f32 vcc, v32, v32
    s_nop 0
    v_add_f32_dpp v32, v32, v32 row_ror:8 row_mask:0xf bank_mask:0xf
    v_mul_f32 v32, s70, v32
    s_cbranch_vccz L109
    s_add_u32 s47, s47, 1
    s_cmp_lt_u32 s47, 262144
    s_cbranch_scc1 L108
L109:
    s_nop 0
    v_mov_b32_dpp v33, v32 row_ror:4 row_mask:0xf bank_mask:0xf
    v_fma_f32 v33, -v32, v32, v33
    v_max_f32 v33, 0, v33
    v_add_f32 v33, s72, v33
    v_rsq_f32 v33, v33
    s_mov_b32 exec_lo, 0xf000f
    s_mov_b32 exec_hi, 0xf000f
    v_mul_f32_e64 v32, -v32, v33
    buffer_store_dwordx2 v[32:33], v26, s[60:63], s50 offen sc1
    s_mov_b64 exec, -1
    s_branch L_job
L_jobs_done:
    s_branch L_end
L8:
    buffer_load_dword v14, v13, s[60:63], s96 offen sc1
    s_waitcnt vmcnt(0)
    v_cmp_ne_u32 vcc, s38, v14
    s_cbranch_vccz L9
    s_add_u32 s47, s47, 1
    s_cmp_lt_u32 s47, 262144
    s_cbranch_scc1 L8
    s_branch L9
L10:
    s_mov_b32 s97, m0
    s_add_u32 m0, s68, 0
    s_xor_b32 s77, s78, 0
    s_mul_i32 s77, s77, 28928
    s_add_u32 s77, s77, s68
    s_add_u32 s77, s77, 3145728
    buffer_load_dwordx4 v3, s[60:63], s77 offen offset:0 sc1 lds
    buffer_load_dwordx4 v3, s[60:63], s77 offen offset:1024 sc1 lds
    buffer_load_dwordx4 v3, s[60:63], s77 offen offset:2048 sc1 lds
    buffer_load_dwordx4 v3, s[60:63], s77 offen offset:3072 sc1 lds
    s_add_u32 m0, s68, 4096
    s_add_u32 s77, s77, 4096
    buffer_load_dwordx4 v3, s[60:63], s77 offen offset:0 sc1 lds
    buffer_load_dwordx4 v3, s[60:63], s77 offen offset:1024 sc1 lds
    buffer_load_dwordx4 v3, s[60:63], s77 offen offset:2048 sc1 lds
    s_mov_b32 m0, s97
    s_waitcnt vmcnt(0)
    ds_read_b32 v128, v132 offset:0
    ds_read_b32 v129, v132 offset:32
    ds_read_b32 v130, v133 offset:0
    ds_read_b32 v131, v133 offset:32
    s_waitcnt lgkmcnt(0)
    v_max3_u32 v128, v128, v129, v130
    v_max_u32 v128, v128, v131
    v_cmp_eq_u32 vcc, -1, v128
    s_cbranch_vccz L11
    s_add_u32 s47, s47, 1
    s_cmp_lt_u32 s47, 262144
    s_cbranch_scc1 L10
    s_branch L11
L12:
    s_mov_b32 s97, m0
    s_add_u32 m0, s68, 28672
    s_xor_b32 s77, s78, 1
    s_mul_i32 s77, s77, 28928
    s_add_u32 s77, s77, s68
    s_add_u32 s77, s77, 3145728
    buffer_load_dwordx4 v3, s[60:63], s77 offen offset:0 sc1 lds
    buffer_load_dwordx4 v3, s[60:63], s77 offen offset:1024 sc1 lds
    buffer_load_dwordx4 v3, s[60:63], s77 offen offset:2048 sc1 lds
    buffer_load_dwordx4 v3, s[60:63], s77 offen offset:3072 sc1 lds
    s_add_u32 m0, s68, 32768
    s_add_u32 s77, s77, 4096
    buffer_load_dwordx4 v3, s[60:63], s77 offen offset:0 sc1 lds
    buffer_load_dwordx4 v3, s[60:63], s77 offen offset:1024 sc1 lds
    buffer_load_dwordx4 v3, s[60:63], s77 offen offset:2048 sc1 lds
    s_mov_b32 m0, s97
    s_waitcnt vmcnt(0)
    ds_read_b32 v128, v132 offset:28672
    ds_read_b32 v129, v132 offset:28704
    ds_read_b32 v130, v133 offset:28672
    ds_read_b32 v131, v133 offset:28704
    s_waitcnt lgkmcnt(0)
    v_max3_u32 v128, v128, v129, v130
    v_max_u32 v128, v128, v131
    v_cmp_eq_u32 vcc, -1, v128
    s_cbranch_vccz L13
    s_add_u32 s47, s47, 1
    s_cmp_lt_u32 s47, 262144
    s_cbranch_scc1 L12
    s_branch L13
L14:
    s_mov_b32 s97, m0
    s_add_u32 m0, s68, 57344
    s_xor_b32 s77, s78, 0
    s_mul_i32 s77, s77, 28928
    s_add_u32 s77, s77, s68
    s_add_u32 s77, s77, 4071424
    buffer_load_dwordx4 v3, s[60:63], s77 offen offset:0 sc1 lds
    buffer_load_dwordx4 v3, s[60:63], s77 offen offset:1024 sc1 lds
    buffer_load_dwordx4 v3, s[60:63], s77 offen offset:2048 sc1 lds
    buffer_load_dwordx4 v3, s[60:63], s77 offen offset:3072 sc1 lds
    s_add_u32 m0, s68, 61440
    s_add_u32 s77, s77, 4096
    buffer_load_dwordx4 v3, s[60:63], s77 offen offset:0 sc1 lds
    buffer_load_dwordx4 v3, s[60:63], s77 offen offset:1024 sc1 lds
    buffer_load_dwordx4 v3, s[60:63], s77 offen offset:2048 sc1 lds
    s_mov_b32 m0, s97
    s_waitcnt vmcnt(0)
    ds_read_b32 v128, v132 offset:0
    ds_read_b32 v129, v132 offset:32
    ds_read_b32 v130, v133 offset:0
    ds_read_b32 v131, v133 offset:32
    s_waitcnt lgkmcnt(0)
    v_max3_u32 v128, v128, v129, v130
    v_max_u32 v128, v128, v131
    v_cmp_eq_u32 vcc, -1, v128
    s_cbranch_vccz L15
    s_add_u32 s47, s47, 1
    s_cmp_lt_u32 s47, 262144
    s_cbranch_scc1 L14
    s_branch L15
L16:
    buffer_store_dword v142, off, s[60:63], s4 offset:0 sc1
    s_branch L17
L18:
    s_mov_b32 s97, m0
    s_add_u32 m0, s68, 86016
    s_xor_b32 s77, s78, 1
    s_mul_i32 s77, s77, 28928
    s_add_u32 s77, s77, s68
    s_add_u32 s77, s77, 4071424
    buffer_load_dwordx4 v3, s[60:63], s77 offen offset:0 sc1 lds
    buffer_load_dwordx4 v3, s[60:63], s77 offen offset:1024 sc1 lds
    buffer_load_dwordx4 v3, s[60:63], s77 offen offset:2048 sc1 lds
    buffer_load_dwordx4 v3, s[60:63], s77 offen offset:3072 sc1 lds
    s_add_u32 m0, s68, 90112
    s_add_u32 s77, s77, 4096
    buffer_load_dwordx4 v3, s[60:63], s77 offen offset:0 sc1 lds
    buffer_load_dwordx4 v3, s[60:63], s77 offen offset:1024 sc1 lds
    buffer_load_dwordx4 v3, s[60:63], s77 offen offset:2048 sc1 lds
    s_mov_b32 m0, s97
    s_waitcnt vmcnt(0)
    ds_read_b32 v128, v132 offset:28672
    ds_read_b32 v129, v132 offset:28704
    ds_read_b32 v130, v133 offset:28672
    ds_read_b32 v131, v133 offset:28704
    s_waitcnt lgkmcnt(0)
    v_max3_u32 v128, v128, v129, v130
    v_max_u32 v128, v128, v131
    v_cmp_eq_u32 vcc, -1, v128
    s_cbranch_vccz L19
    s_add_u32 s47, s47, 1
    s_cmp_lt_u32 s47, 262144
    s_cbranch_scc1 L18
    s_branch L19
L20:
    buffer_store_dword v142, off, s[60:63], s4 offset:256 sc1
    s_branch L21
L22:
    buffer_load_dword v14, v13, s[60:63], s5 offen offset:0 sc1
    s_waitcnt vmcnt(0)
    v_cmp_ne_u32 vcc, s38, v14
    s_cbranch_vccz L23
    s_add_u32 s47, s47, 1
    s_cmp_lt_u32 s47, 262144
    s_cbranch_scc1 L22
    s_branch L23
L24:
    buffer_load_dword v46, v45, s[60:63], s96 offen sc1
    s_waitcnt vmcnt(0)
    v_cmp_ne_u32 vcc, s38, v46
    s_cbranch_vccz L25
    s_add_u32 s47, s47, 1
    s_cmp_lt_u32 s47, 262144
    s_cbranch_scc1 L24
    s_branch L25
L26:
    buffer_store_dword v142, off, s[60:63], s4 offset:512 sc1
    s_branch L27
L28:
    buffer_load_dword v14, v13, s[60:63], s6 offen offset:256 sc1
    s_waitcnt vmcnt(0)
    v_cmp_ne_u32 vcc, s38, v14
    s_cbranch_vccz L29
    s_add_u32 s47, s47, 1
    s_cmp_lt_u32 s47, 262144
    s_cbranch_scc1 L28
    s_branch L29
L30:
    buffer_store_dword v142, off, s[60:63], s4 offset:768 sc1
    s_branch L31
L32:
    buffer_load_dword v14, v13, s[60:63], s5 offen offset:512 sc1
    s_waitcnt vmcnt(0)
    v_cmp_ne_u32 vcc, s38, v14
    s_cbranch_vccz L33
    s_add_u32 s47, s47, 1
    s_cmp_lt_u32 s47, 262144
    s_cbranch_scc1 L32
    s_branch L33
L34:
    buffer_load_dword v14, v13, s[60:63], s6 offen offset:768 sc1
    s_waitcnt vmcnt(0)
    v_cmp_ne_u32 vcc, s38, v14
    s_cbranch_vccz L35
    s_add_u32 s47, s47, 1
    s_cmp_lt_u32 s47, 262144
    s_cbranch_scc1 L34
    s_branch L35
L36:
    buffer_load_dword v136, v127, s[60:63], s82 offen offset:4 sc1
    s_waitcnt vmcnt(0)
    v_cmp_eq_u32 vcc, -1, v136
    s_cbranch_vccz L37
    s_add_u32 s47, s47, 1
    s_cmp_lt_u32 s47, 262144
    s_cbranch_scc1 L36
    s_branch L37
L38:
    buffer_load_dword v137, v127, s[60:63], s83 offen offset:4 sc1
    s_waitcnt vmcnt(0)
    v_cmp_eq_u32 vcc, -1, v137
    s_cbranch_vccz L39
    s_add_u32 s47, s47, 1
    s_cmp_lt_u32 s47, 262144
    s_cbranch_scc1 L38
    s_branch L39
L40:
    buffer_store_dword v138, v143, s[60:63], s84 offen sc1
    s_branch L40x
L41:
    buffer_store_dword v138, v143, s[60:63], s85 offen sc1
    s_branch L41x
L42:
    buffer_load_dwordx4 v[96:99], v0, s[60:63], s86 offen sc1
    buffer_load_dwordx4 v[100:103], v0, s[60:63], s87 offen sc1
    buffer_load_dwordx2 v[104:105], v11, s[60:63], s96 offen sc1
    buffer_load_dwordx2 v[106:107], v11, s[60:63], s96 offen offset:64 sc1
    s_waitcnt vmcnt(0)
    v_max3_u32 v136, v96, v97, v98
    v_max3_u32 v136, v136, v99, v100
    v_max3_u32 v136, v136, v101, v102
    v_max3_u32 v136, v136, v103, v104
    v_max3_u32 v136, v136, v105, v106
    v_max_u32 v136, v136, v107
    v_cmp_eq_u32 vcc, -1, v136
    s_cbranch_vccz L43
    s_add_u32 s47, s47, 1
    s_cmp_lt_u32 s47, 262144
    s_cbranch_scc1 L42
    s_branch L43
L44:
    buffer_load_dwordx4 v[124:127], v0, s[60:63], s86 offen sc1
    buffer_load_dwordx4 v[128:131], v0, s[60:63], s87 offen sc1
    buffer_load_dwordx2 v[132:133], v11, s[60:63], s96 offen sc1
    buffer_load_dwordx2 v[134:135], v11, s[60:63], s96 offen offset:64 sc1
    s_waitcnt vmcnt(0)
    v_max3_u32 v136, v124, v125, v126
    v_max3_u32 v136, v136, v127, v128
    v_max3_u32 v136, v136, v129, v130
    v_max3_u32 v136, v136, v131, v132
    v_max3_u32 v136, v136, v133, v134
    v_max_u32 v136, v136, v135
    v_cmp_eq_u32 vcc, -1, v136
    s_cbranch_vccz L45
    s_add_u32 s47, s47, 1
    s_cmp_lt_u32 s47, 262144
    s_cbranch_scc1 L44
    s_branch L45
L46:
    s_mov_b32 s97, m0
    s_add_u32 m0, s68, 0
    s_xor_b32 s77, s78, 0
    s_mul_i32 s77, s77, 28928
    s_add_u32 s77, s77, s68
    s_add_u32 s77, s77, 5242880
    buffer_load_dwordx4 v3, s[60:63], s77 offen offset:0 sc1 lds
    buffer_load_dwordx4 v3, s[60:63], s77 offen offset:1024 sc1 lds
    buffer_load_dwordx4 v3, s[60:63], s77 offen offset:2048 sc1 lds
    buffer_load_dwordx4 v3, s[60:63], s77 offen offset:3072 sc1 lds
    s_add_u32 m0, s68, 4096
    s_add_u32 s77, s77, 4096
    buffer_load_dwordx4 v3, s[60:63], s77 offen offset:0 sc1 lds
    buffer_load_dwordx4 v3, s[60:63], s77 offen offset:1024 sc1 lds
    buffer_load_dwordx4 v3, s[60:63], s77 offen offset:2048 sc1 lds
    s_mov_b32 m0, s97
    s_waitcnt vmcnt(0)
    ds_read_b32 v128, v132 offset:0
    ds_read_b32 v129, v132 offset:32
    ds_read_b32 v130, v133 offset:0
    ds_read_b32 v131, v133 offset:32
    s_waitcnt lgkmcnt(0)
    v_max3_u32 v128, v128, v129, v130
    v_max_u32 v128, v128, v131
    v_cmp_eq_u32 vcc, -1, v128
    s_cbranch_vccz L47
    s_add_u32 s47, s47, 1
    s_cmp_lt_u32 s47, 262144
    s_cbranch_scc1 L46
    s_branch L47
L48:
    s_mov_b32 s97, m0
    s_add_u32 m0, s68, 28672
    s_xor_b32 s77, s78, 1
    s_mul_i32 s77, s77, 28928
    s_add_u32 s77, s77, s68
    s_add_u32 s77, s77, 5242880
    buffer_load_dwordx4 v3, s[60:63], s77 offen offset:0 sc1 lds
    buffer_load_dwordx4 v3, s[60:63], s77 offen offset:1024 sc1 lds
    buffer_load_dwordx4 v3, s[60:63], s77 offen offset:2048 sc1 lds
    buffer_load_dwordx4 v3, s[60:63], s77 offen offset:3072 sc1 lds
    s_add_u32 m0, s68, 32768
    s_add_u32 s77, s77, 4096
    buffer_load_dwordx4 v3, s[60:63], s77 offen offset:0 sc1 lds
    buffer_load_dwordx4 v3, s[60:63], s77 offen offset:1024 sc1 lds
    buffer_load_dwordx4 v3, s[60:63], s77 offen offset:2048 sc1 lds
    s_mov_b32 m0, s97
    s_waitcnt vmcnt(0)
    ds_read_b32 v128, v132 offset:28672
    ds_read_b32 v129, v132 offset:28704
    ds_read_b32 v130, v133 offset:28672
    ds_read_b32 v131, v133 offset:28704
    s_waitcnt lgkmcnt(0)
    v_max3_u32 v128, v128, v129, v130
    v_max_u32 v128, v128, v131
    v_cmp_eq_u32 vcc, -1, v128
    s_cbranch_vccz L49
    s_add_u32 s47, s47, 1
    s_cmp_lt_u32 s47, 262144
    s_cbranch_scc1 L48
    s_branch L49
L50:
    s_mov_b32 s97, m0
    s_add_u32 m0, s68, 57344
    s_xor_b32 s77, s78, 0
    s_mul_i32 s77, s77, 28928
    s_add_u32 s77, s77, s68
    s_add_u32 s77, s77, 6168576
    buffer_load_dwordx4 v3, s[60:63], s77 offen offset:0 sc1 lds
    buffer_load_dwordx4 v3, s[60:63], s77 offen offset:1024 sc1 lds
    buffer_load_dwordx4 v3, s[60:63], s77 offen offset:2048 sc1 lds
    buffer_load_dwordx4 v3, s[60:63], s77 offen offset:3072 sc1 lds
    s_add_u32 m0, s68, 61440
    s_add_u32 s77, s77, 4096
    buffer_load_dwordx4 v3, s[60:63], s77 offen offset:0 sc1 lds
    buffer_load_dwordx4 v3, s[60:63], s77 offen offset:1024 sc1 lds
    buffer_load_dwordx4 v3, s[60:63], s77 offen offset:2048 sc1 lds
    s_mov_b32 m0, s97
    s_waitcnt vmcnt(0)
    ds_read_b32 v128, v132 offset:0
    ds_read_b32 v129, v132 offset:32
    ds_read_b32 v130, v133 offset:0
    ds_read_b32 v131, v133 offset:32
    s_waitcnt lgkmcnt(0)
    v_max3_u32 v128, v128, v129, v130
    v_max_u32 v128, v128, v131
    v_cmp_eq_u32 vcc, -1, v128
    s_cbranch_vccz L51
    s_add_u32 s47, s47, 1
    s_cmp_lt_u32 s47, 262144
    s_cbranch_scc1 L50
    s_branch L51
L52:
    s_mov_b32 s97, m0
    s_add_u32 m0, s68, 86016
    s_xor_b32 s77, s78, 1
    s_mul_i32 s77, s77, 28928
    s_add_u32 s77, s77, s68
    s_add_u32 s77, s77, 6168576
    buffer_load_dwordx4 v3, s[60:63], s77 offen offset:0 sc1 lds
    buffer_load_dwordx4 v3, s[60:63], s77 offen offset:1024 sc1 lds
    buffer_load_dwordx4 v3, s[60:63], s77 offen offset:2048 sc1 lds
    buffer_load_dwordx4 v3, s[60:63], s77 offen offset:3072 sc1 lds
    s_add_u32 m0, s68, 90112
    s_add_u32 s77, s77, 4096
    buffer_load_dwordx4 v3, s[60:63], s77 offen offset:0 sc1 lds
    buffer_load_dwordx4 v3, s[60:63], s77 offen offset:1024 sc1 lds
    buffer_load_dwordx4 v3, s[60:63], s77 offen offset:2048 sc1 lds
    s_mov_b32 m0, s97
    s_waitcnt vmcnt(0)
    ds_read_b32 v128, v132 offset:28672
    ds_read_b32 v129, v132 offset:28704
    ds_read_b32 v130, v133 offset:28672
    ds_read_b32 v131, v133 offset:28704
    s_waitcnt lgkmcnt(0)
    v_max3_u32 v128, v128, v129, v130
    v_max_u32 v128, v128, v131
    v_cmp_eq_u32 vcc, -1, v128
    s_cbranch_vccz L53
    s_add_u32 s47, s47, 1
    s_cmp_lt_u32 s47, 262144
    s_cbranch_scc1 L52
    s_branch L53
L54:
    s_waitcnt vmcnt(0)
    s_add_u32 s77, s74, -12288
    buffer_load_dwordx4 v[80:83], v3, s[60:63], s77 offen offset:0 sc1
    buffer_load_dwordx4 v[84:87], v3, s[60:63], s77 offen offset:1024 sc1
    buffer_load_dwordx4 v[88:91], v3, s[60:63], s77 offen offset:2048 sc1
    buffer_load_dwordx4 v[92:95], v3, s[60:63], s77 offen offset:3072 sc1
    s_add_u32 s77, s74, -8192
    buffer_load_dwordx4 v[96:99], v3, s[60:63], s77 offen offset:0 sc1
    buffer_load_dwordx4 v[100:103], v3, s[60:63], s77 offen offset:1024 sc1
    buffer_load_dwordx4 v[104:107], v3, s[60:63], s77 offen offset:2048 sc1
    buffer_load_dwordx4 v[108:111], v3, s[60:63], s77 offen offset:3072 sc1
    s_add_u32 s77, s74, -4096
    buffer_load_dwordx4 v[112:115], v3, s[60:63], s77 offen offset:0 sc1
    s_waitcnt vmcnt(0)
    v_max3_i32 v13, v80, v84, v88
    v_cmp_le_i32 vcc, 0, v13
    s_cbranch_vccz L55
    s_add_u32 s47, s47, 1
    s_cmp_lt_u32 s47, 262144
    s_cbranch_scc1 L54
    s_branch L55
L56:
    s_waitcnt vmcnt(0)
    s_add_u32 s77, s74, -12288
    buffer_load_dwordx4 v[92:95], v3, s[60:63], s77 offen offset:3072 sc1
    s_add_u32 s77, s74, -8192
    buffer_load_dwordx4 v[96:99], v3, s[60:63], s77 offen offset:0 sc1
    buffer_load_dwordx4 v[100:103], v3, s[60:63], s77 offen offset:1024 sc1
    buffer_load_dwordx4 v[104:107], v3, s[60:63], s77 offen offset:2048 sc1
    buffer_load_dwordx4 v[108:111], v3, s[60:63], s77 offen offset:3072 sc1
    s_add_u32 s77, s74, -4096
    buffer_load_dwordx4 v[112:115], v3, s[60:63], s77 offen offset:0 sc1
    buffer_load_dwordx4 v[116:119], v3, s[60:63], s77 offen offset:1024 sc1
    buffer_load_dwordx4 a[224:227], v3, s[60:63], s77 offen offset:2048 sc1
    buffer_load_dwordx4 a[228:231], v3, s[60:63], s77 offen offset:3072 sc1
    s_waitcnt vmcnt(0)
    v_max3_i32 v13, v92, v96, v100
    v_cmp_le_i32 vcc, 0, v13
    s_cbranch_vccz L57
    s_add_u32 s47, s47, 1
    s_cmp_lt_u32 s47, 262144
    s_cbranch_scc1 L56
    s_branch L57
L58:
    s_waitcnt vmcnt(0)
    s_add_u32 s77, s74, -8192
    buffer_load_dwordx4 v[104:107], v3, s[60:63], s77 offen offset:2048 sc1
    buffer_load_dwordx4 v[108:111], v3, s[60:63], s77 offen offset:3072 sc1
    s_add_u32 s77, s74, -4096
    buffer_load_dwordx4 v[112:115], v3, s[60:63], s77 offen offset:0 sc1
    buffer_load_dwordx4 v[116:119], v3, s[60:63], s77 offen offset:1024 sc1
    buffer_load_dwordx4 a[224:227], v3, s[60:63], s77 offen offset:2048 sc1
    buffer_load_dwordx4 a[228:231], v3, s[60:63], s77 offen offset:3072 sc1
    s_add_u32 s77, s74, 0
    buffer_load_dwordx4 a[232:235], v3, s[60:63], s77 offen offset:0 sc1
    buffer_load_dwordx4 a[236:239], v3, s[60:63], s77 offen offset:1024 sc1
    s_waitcnt vmcnt(0)
    v_max3_i32 v13, v104, v108, v112
    v_cmp_le_i32 vcc, 0, v13
    s_cbranch_vccz L59
    s_add_u32 s47, s47, 1
    s_cmp_lt_u32 s47, 262144
    s_cbranch_scc1 L58
    s_branch L59
L60:
    s_waitcnt vmcnt(0)
    s_add_u32 s77, s74, -4096
    buffer_load_dwordx4 v[116:119], v3, s[60:63], s77 offen offset:1024 sc1
    buffer_load_dwordx4 a[224:227], v3, s[60:63], s77 offen offset:2048 sc1
    buffer_load_dwordx4 a[228:231], v3, s[60:63], s77 offen offset:3072 sc1
    s_add_u32 s77, s74, 0
    buffer_load_dwordx4 a[232:235], v3, s[60:63], s77 offen offset:0 sc1
    buffer_load_dwordx4 a[236:239], v3, s[60:63], s77 offen offset:1024 sc1
    s_waitcnt vmcnt(0)
    v_accvgpr_read_b32 v14, a224
    v_accvgpr_read_b32 v142, a228
    v_max3_i32 v13, v116, v14, v142
    v_cmp_le_i32 vcc, 0, v13
    s_cbranch_vccz L61
    s_add_u32 s47, s47, 1
    s_cmp_lt_u32 s47, 262144
    s_cbranch_scc1 L60
    s_branch L61
L62:
    s_waitcnt vmcnt(0)
    s_add_u32 s77, s74, 0
    buffer_load_dwordx4 a[232:235], v3, s[60:63], s77 offen offset:0 sc1
    buffer_load_dwordx4 a[236:239], v3, s[60:63], s77 offen offset:1024 sc1
    s_waitcnt vmcnt(0)
    v_accvgpr_read_b32 v13, a232
    v_accvgpr_read_b32 v14, a236
    v_max_i32 v13, v13, v14
    v_cmp_le_i32 vcc, 0, v13
    s_cbranch_vccz L63
    s_add_u32 s47, s47, 1
    s_cmp_lt_u32 s47, 262144
    s_cbranch_scc1 L62
    s_branch L63
L64:
    s_waitcnt vmcnt(0)
    s_add_u32 s77, s75, -12288
    buffer_load_dwordx4 a[240:243], v3, s[60:63], s77 offen offset:0 sc1
    buffer_load_dwordx4 a[244:247], v3, s[60:63], s77 offen offset:1024 sc1
    buffer_load_dwordx4 a[248:251], v3, s[60:63], s77 offen offset:2048 sc1
    buffer_load_dwordx4 a[252:255], v3, s[60:63], s77 offen offset:3072 sc1
    s_add_u32 s77, s75, -8192
    buffer_load_dwordx4 v[80:83], v3, s[60:63], s77 offen offset:0 sc1
    buffer_load_dwordx4 v[84:87], v3, s[60:63], s77 offen offset:1024 sc1
    buffer_load_dwordx4 v[88:91], v3, s[60:63], s77 offen offset:2048 sc1
    buffer_load_dwordx4 v[92:95], v3, s[60:63], s77 offen offset:3072 sc1
    s_add_u32 s77, s75, -4096
    buffer_load_dwordx4 v[96:99], v3, s[60:63], s77 offen offset:0 sc1
    s_waitcnt vmcnt(0)
    v_accvgpr_read_b32 v13, a240
    v_accvgpr_read_b32 v14, a244
    v_accvgpr_read_b32 v142, a248
    v_max3_i32 v13, v13, v14, v142
    v_cmp_le_i32 vcc, 0, v13
    s_cbranch_vccz L65
    s_add_u32 s47, s47, 1
    s_cmp_lt_u32 s47, 262144
    s_cbranch_scc1 L64
    s_branch L65
L66:
    s_waitcnt vmcnt(0)
    s_add_u32 s77, s75, -12288
    buffer_load_dwordx4 a[252:255], v3, s[60:63], s77 offen offset:3072 sc1
    s_add_u32 s77, s75, -8192
    buffer_load_dwordx4 v[80:83], v3, s[60:63], s77 offen offset:0 sc1
    buffer_load_dwordx4 v[84:87], v3, s[60:63], s77 offen offset:1024 sc1
    buffer_load_dwordx4 v[88:91], v3, s[60:63], s77 offen offset:2048 sc1
    buffer_load_dwordx4 v[92:95], v3, s[60:63], s77 offen offset:3072 sc1
    s_add_u32 s77, s75, -4096
    buffer_load_dwordx4 v[96:99], v3, s[60:63], s77 offen offset:0 sc1
    buffer_load_dwordx4 v[100:103], v3, s[60:63], s77 offen offset:1024 sc1
    buffer_load_dwordx4 v[104:107], v3, s[60:63], s77 offen offset:2048 sc1
    buffer_load_dwordx4 v[108:111], v3, s[60:63], s77 offen offset:3072 sc1
    s_waitcnt vmcnt(0)
    v_accvgpr_read_b32 v13, a252
    v_max3_i32 v13, v13, v80, v84
    v_cmp_le_i32 vcc, 0, v13
    s_cbranch_vccz L67
    s_add_u32 s47, s47, 1
    s_cmp_lt_u32 s47, 262144
    s_cbranch_scc1 L66
    s_branch L67
L68:
    s_waitcnt vmcnt(0)
    s_add_u32 s77, s75, -8192
    buffer_load_dwordx4 v[88:91], v3, s[60:63], s77 offen offset:2048 sc1
    buffer_load_dwordx4 v[92:95], v3, s[60:63], s77 offen offset:3072 sc1
    s_add_u32 s77, s75, -4096
    buffer_load_dwordx4 v[96:99], v3, s[60:63], s77 offen offset:0 sc1
    buffer_load_dwordx4 v[100:103], v3, s[60:63], s77 offen offset:1024 sc1
    buffer_load_dwordx4 v[104:107], v3, s[60:63], s77 offen offset:2048 sc1
    buffer_load_dwordx4 v[108:111], v3, s[60:63], s77 offen offset:3072 sc1
    s_add_u32 s77, s75, 0
    buffer_load_dwordx4 v[112:115], v3, s[60:63], s77 offen offset:0 sc1
    buffer_load_dwordx4 v[116:119], v3, s[60:63], s77 offen offset:1024 sc1
    s_waitcnt vmcnt(0)
    v_max3_i32 v13, v88, v92, v96
    v_cmp_le_i32 vcc, 0, v13
    s_cbranch_vccz L69
    s_add_u32 s47, s47, 1
    s_cmp_lt_u32 s47, 262144
    s_cbranch_scc1 L68
    s_branch L69
L70:
    s_waitcnt vmcnt(0)
    s_add_u32 s77, s75, -4096
    buffer_load_dwordx4 v[100:103], v3, s[60:63], s77 offen offset:1024 sc1
    buffer_load_dwordx4 v[104:107], v3, s[60:63], s77 offen offset:2048 sc1
    buffer_load_dwordx4 v[108:111], v3, s[60:63], s77 offen offset:3072 sc1
    s_add_u32 s77, s75, 0
    buffer_load_dwordx4 v[112:115], v3, s[60:63], s77 offen offset:0 sc1
    buffer_load_dwordx4 v[116:119], v3, s[60:63], s77 offen offset:1024 sc1
    s_waitcnt vmcnt(0)
    v_max3_i32 v13, v100, v104, v108
    v_cmp_le_i32 vcc, 0, v13
    s_cbranch_vccz L71
    s_add_u32 s47, s47, 1
    s_cmp_lt_u32 s47, 262144
    s_cbranch_scc1 L70
    s_branch L71
L72:
    s_waitcnt vmcnt(0)
    s_add_u32 s77, s75, 0
    buffer_load_dwordx4 v[112:115], v3, s[60:63], s77 offen offset:0 sc1
    buffer_load_dwordx4 v[116:119], v3, s[60:63], s77 offen offset:1024 sc1
    s_waitcnt vmcnt(0)
    v_max_i32 v13, v112, v116
    v_cmp_le_i32 vcc, 0, v13
    s_cbranch_vccz L73
    s_add_u32 s47, s47, 1
    s_cmp_lt_u32 s47, 262144
    s_cbranch_scc1 L72
    s_branch L73
L74:
    s_waitcnt vmcnt(0)
    s_add_u32 s77, s86, -12288
    buffer_load_dwordx4 a[224:227], v3, s[60:63], s77 offen offset:0 sc1
    buffer_load_dwordx4 a[228:231], v3, s[60:63], s77 offen offset:1024 sc1
    buffer_load_dwordx4 a[232:235], v3, s[60:63], s77 offen offset:2048 sc1
    buffer_load_dwordx4 a[236:239], v3, s[60:63], s77 offen offset:3072 sc1
    s_add_u32 s77, s86, -8192
    buffer_load_dwordx4 a[240:243], v3, s[60:63], s77 offen offset:0 sc1
    buffer_load_dwordx4 a[244:247], v3, s[60:63], s77 offen offset:1024 sc1
    buffer_load_dwordx4 a[248:251], v3, s[60:63], s77 offen offset:2048 sc1
    buffer_load_dwordx4 a[252:255], v3, s[60:63], s77 offen offset:3072 sc1
    s_add_u32 s77, s86, -4096
    buffer_load_dwordx4 v[80:83], v3, s[60:63], s77 offen offset:0 sc1
    s_waitcnt vmcnt(0)
    v_accvgpr_read_b32 v13, a224
    v_accvgpr_read_b32 v14, a228
    v_accvgpr_read_b32 v142, a232
    v_max3_i32 v13, v13, v14, v142
    v_cmp_le_i32 vcc, 0, v13
    s_cbranch_vccz L75
    s_add_u32 s47, s47, 1
    s_cmp_lt_u32 s47, 262144
    s_cbranch_scc1 L74
    s_branch L75
L76:
    buffer_load_dword v136, v127, s[60:63], s82 offen offset:4 sc1
    s_waitcnt vmcnt(0)
    v_cmp_eq_u32 vcc, -1, v136
    s_cbranch_vccz L77
    s_add_u32 s47, s47, 1
    s_cmp_lt_u32 s47, 262144
    s_cbranch_scc1 L76
    s_branch L77
L78:
    buffer_load_dword v137, v127, s[60:63], s83 offen offset:4 sc1
    s_waitcnt vmcnt(0)
    v_cmp_eq_u32 vcc, -1, v137
    s_cbranch_vccz L79
    s_add_u32 s47, s47, 1
    s_cmp_lt_u32 s47, 262144
    s_cbranch_scc1 L78
    s_branch L79
L80:
    s_waitcnt vmcnt(0)
    s_add_u32 s77, s86, -12288
    buffer_load_dwordx4 a[236:239], v3, s[60:63], s77 offen offset:3072 sc1
    s_add_u32 s77, s86, -8192
    buffer_load_dwordx4 a[240:243], v3, s[60:63], s77 offen offset:0 sc1
    buffer_load_dwordx4 a[244:247], v3, s[60:63], s77 offen offset:1024 sc1
    buffer_load_dwordx4 a[248:251], v3, s[60:63], s77 offen offset:2048 sc1
    buffer_load_dwordx4 a[252:255], v3, s[60:63], s77 offen offset:3072 sc1
    s_add_u32 s77, s86, -4096
    buffer_load_dwordx4 v[80:83], v3, s[60:63], s77 offen offset:0 sc1
    buffer_load_dwordx4 v[84:87], v3, s[60:63], s77 offen offset:1024 sc1
    buffer_load_dwordx4 v[88:91], v3, s[60:63], s77 offen offset:2048 sc1
    buffer_load_dwordx4 v[92:95], v3, s[60:63], s77 offen offset:3072 sc1
    s_waitcnt vmcnt(0)
    v_accvgpr_read_b32 v13, a236
    v_accvgpr_read_b32 v14, a240
    v_accvgpr_read_b32 v142, a244
    v_max3_i32 v13, v13, v14, v142
    v_cmp_le_i32 vcc, 0, v13
    s_cbranch_vccz L81
    s_add_u32 s47, s47, 1
    s_cmp_lt_u32 s47, 262144
    s_cbranch_scc1 L80
    s_branch L81
L82:
    s_waitcnt vmcnt(0)
    s_add_u32 s77, s86, -8192
    buffer_load_dwordx4 a[248:251], v3, s[60:63], s77 offen offset:2048 sc1
    buffer_load_dwordx4 a[252:255], v3, s[60:63], s77 offen offset:3072 sc1
    s_add_u32 s77, s86, -4096
    buffer_load_dwordx4 v[80:83], v3, s[60:63], s77 offen offset:0 sc1
    buffer_load_dwordx4 v[84:87], v3, s[60:63], s77 offen offset:1024 sc1
    buffer_load_dwordx4 v[88:91], v3, s[60:63], s77 offen offset:2048 sc1
    buffer_load_dwordx4 v[92:95], v3, s[60:63], s77 offen offset:3072 sc1
    s_add_u32 s77, s86, 0
    buffer_load_dwordx4 v[96:99], v3, s[60:63], s77 offen offset:0 sc1
    buffer_load_dwordx4 v[100:103], v3, s[60:63], s77 offen offset:1024 sc1
    s_waitcnt vmcnt(0)
    v_accvgpr_read_b32 v13, a248
    v_accvgpr_read_b32 v14, a252
    v_max3_i32 v13, v13, v14, v80
    v_cmp_le_i32 vcc, 0, v13
    s_cbranch_vccz L83
    s_add_u32 s47, s47, 1
    s_cmp_lt_u32 s47, 262144
    s_cbranch_scc1 L82
    s_branch L83
L84:
    s_waitcnt vmcnt(0)
    s_add_u32 s77, s86, -4096
    buffer_load_dwordx4 v[84:87], v3, s[60:63], s77 offen offset:1024 sc1
    buffer_load_dwordx4 v[88:91], v3, s[60:63], s77 offen offset:2048 sc1
    buffer_load_dwordx4 v[92:95], v3, s[60:63], s77 offen offset:3072 sc1
    s_add_u32 s77, s86, 0
    buffer_load_dwordx4 v[96:99], v3, s[60:63], s77 offen offset:0 sc1
    buffer_load_dwordx4 v[100:103], v3, s[60:63], s77 offen offset:1024 sc1
    s_waitcnt vmcnt(0)
    v_max3_i32 v13, v84, v88, v92
    v_cmp_le_i32 vcc, 0, v13
    s_cbranch_vccz L85
    s_add_u32 s47, s47, 1
    s_cmp_lt_u32 s47, 262144
    s_cbranch_scc1 L84
    s_branch L85
L86:
    s_waitcnt vmcnt(0)
    s_add_u32 s77, s86, 0
    buffer_load_dwordx4 v[96:99], v3, s[60:63], s77 offen offset:0 sc1
    buffer_load_dwordx4 v[100:103], v3, s[60:63], s77 offen offset:1024 sc1
    s_waitcnt vmcnt(0)
    v_max_i32 v13, v96, v100
    v_cmp_le_i32 vcc, 0, v13
    s_cbranch_vccz L87
    s_add_u32 s47, s47, 1
    s_cmp_lt_u32 s47, 262144
    s_cbranch_scc1 L86
    s_branch L87
L88:
    s_waitcnt vmcnt(0)
    s_add_u32 s77, s87, -12288
    buffer_load_dwordx4 v[104:107], v3, s[60:63], s77 offen offset:0 sc1
    buffer_load_dwordx4 v[108:111], v3, s[60:63], s77 offen offset:1024 sc1
    buffer_load_dwordx4 v[112:115], v3, s[60:63], s77 offen offset:2048 sc1
    buffer_load_dwordx4 v[116:119], v3, s[60:63], s77 offen offset:3072 sc1
    s_add_u32 s77, s87, -8192
    buffer_load_dwordx4 a[224:227], v3, s[60:63], s77 offen offset:0 sc1
    buffer_load_dwordx4 a[228:231], v3, s[60:63], s77 offen offset:1024 sc1
    buffer_load_dwordx4 a[232:235], v3, s[60:63], s77 offen offset:2048 sc1
    buffer_load_dwordx4 a[236:239], v3, s[60:63], s77 offen offset:3072 sc1
    s_add_u32 s77, s87, -4096
    buffer_load_dwordx4 a[240:243], v3, s[60:63], s77 offen offset:0 sc1
    s_waitcnt vmcnt(0)
    v_max3_i32 v13, v104, v108, v112
    v_cmp_le_i32 vcc, 0, v13
    s_cbranch_vccz L89
    s_add_u32 s47, s47, 1
    s_cmp_lt_u32 s47, 262144
    s_cbranch_scc1 L88
    s_branch L89
L90:
    s_waitcnt vmcnt(0)
    s_add_u32 s77, s87, -12288
    buffer_load_dwordx4 v[116:119], v3, s[60:63], s77 offen offset:3072 sc1
    s_add_u32 s77, s87, -8192
    buffer_load_dwordx4 a[224:227], v3, s[60:63], s77 offen offset:0 sc1
    buffer_load_dwordx4 a[228:231], v3, s[60:63], s77 offen offset:1024 sc1
    buffer_load_dwordx4 a[232:235], v3, s[60:63], s77 offen offset:2048 sc1
    buffer_load_dwordx4 a[236:239], v3, s[60:63], s77 offen offset:3072 sc1
    s_add_u32 s77, s87, -4096
    buffer_load_dwordx4 a[240:243], v3, s[60:63], s77 offen offset:0 sc1
    buffer_load_dwordx4 a[244:247], v3, s[60:63], s77 offen offset:1024 sc1
    buffer_load_dwordx4 a[248:251], v3, s[60:63], s77 offen offset:2048 sc1
    buffer_load_dwordx4 a[252:255], v3, s[60:63], s77 offen offset:3072 sc1
    s_waitcnt vmcnt(0)
    v_accvgpr_read_b32 v14, a224
    v_accvgpr_read_b32 v142, a228
    v_max3_i32 v13, v116, v14, v142
    v_cmp_le_i32 vcc, 0, v13
    s_cbranch_vccz L91
    s_add_u32 s47, s47, 1
    s_cmp_lt_u32 s47, 262144
    s_cbranch_scc1 L90
    s_branch L91
L92:
    s_waitcnt vmcnt(0)
    s_add_u32 s77, s87, -8192
    buffer_load_dwordx4 a[232:235], v3, s[60:63], s77 offen offset:2048 sc1
    buffer_load_dwordx4 a[236:239], v3, s[60:63], s77 offen offset:3072 sc1
    s_add_u32 s77, s87, -4096
    buffer_load_dwordx4 a[240:243], v3, s[60:63], s77 offen offset:0 sc1
    buffer_load_dwordx4 a[244:247], v3, s[60:63], s77 offen offset:1024 sc1
    buffer_load_dwordx4 a[248:251], v3, s[60:63], s77 offen offset:2048 sc1
    buffer_load_dwordx4 a[252:255], v3, s[60:63], s77 offen offset:3072 sc1
    s_add_u32 s77, s87, 0
    buffer_load_dwordx4 v[80:83], v3, s[60:63], s77 offen offset:0 sc1
    buffer_load_dwordx4 v[84:87], v3, s[60:63], s77 offen offset:1024 sc1
    s_waitcnt vmcnt(0)
    v_accvgpr_read_b32 v13, a232
    v_accvgpr_read_b32 v14, a236
    v_accvgpr_read_b32 v142, a240
    v_max3_i32 v13, v13, v14, v142
    v_cmp_le_i32 vcc, 0, v13
    s_cbranch_vccz L93
    s_add_u32 s47, s47, 1
    s_cmp_lt_u32 s47, 262144
    s_cbranch_scc1 L92
    s_branch L93
L94:
    s_waitcnt vmcnt(0)
    s_add_u32 s77, s87, -4096
    buffer_load_dwordx4 a[244:247], v3, s[60:63], s77 offen offset:1024 sc1
    buffer_load_dwordx4 a[248:251], v3, s[60:63], s77 offen offset:2048 sc1
    buffer_load_dwordx4 a[252:255], v3, s[60:63], s77 offen offset:3072 sc1
    s_add_u32 s77, s87, 0
    buffer_load_dwordx4 v[80:83], v3, s[60:63], s77 offen offset:0 sc1
    buffer_load_dwordx4 v[84:87], v3, s[60:63], s77 offen offset:1024 sc1
    s_waitcnt vmcnt(0)
    v_accvgpr_read_b32 v13, a244
    v_accvgpr_read_b32 v14, a248
    v_accvgpr_read_b32 v142, a252
    v_max3_i32 v13, v13, v14, v142
    v_cmp_le_i32 vcc, 0, v13
    s_cbranch_vccz L95
    s_add_u32 s47, s47, 1
    s_cmp_lt_u32 s47, 262144
    s_cbranch_scc1 L94
    s_branch L95
L96:
    s_waitcnt vmcnt(0)
    s_add_u32 s77, s87, 0
    buffer_load_dwordx4 v[80:83], v3, s[60:63], s77 offen offset:0 sc1
    buffer_load_dwordx4 v[84:87], v3, s[60:63], s77 offen offset:1024 sc1
    s_waitcnt vmcnt(0)
    v_max_i32 v13, v80, v84
    v_cmp_le_i32 vcc, 0, v13
    s_cbranch_vccz L97
    s_add_u32 s47, s47, 1
    s_cmp_lt_u32 s47, 262144
    s_cbranch_scc1 L96
    s_branch L97
L101:
    buffer_load_dword v41, v40, s[60:63], s96 offen sc1
    s_waitcnt vmcnt(0)
    v_cmp_ne_u32 vcc, s38, v41
    s_cbranch_vccz L102
    s_add_u32 s47, s47, 1
    s_cmp_lt_u32 s47, 262144
    s_cbranch_scc1 L101
    s_branch L102
L_end:
    s_endpgm
    .fill 1024, 4, 0xbf800000
L_codeend:
    s_endpgm

.section .rodata,"a"
.p2align 6
.amdhsa_kernel interleave_layers__ssm_conv_s4__dense_activation_relu__prompt_kernel
  .amdhsa_next_free_vgpr 512
  .amdhsa_next_free_sgpr 102
  .amdhsa_accum_offset 256
  .amdhsa_group_segment_fixed_size 0
  .amdhsa_kernarg_size 120
  .amdhsa_user_sgpr_count 2
  .amdhsa_user_sgpr_kernarg_segment_ptr 1
  .amdhsa_system_sgpr_workgroup_id_x 1
  .amdhsa_float_denorm_mode_32 3
.end_amdhsa_kernel
```
